```python
import torch

def _softmax(x, axis=-1):
    return torch.softmax(x, dim=axis)
def _gelu(x):
    return torch.nn.functional.gelu(x, approximate="tanh")
def _silu(x):
    return torch.nn.functional.silu(x)
def _sigmoid(x):
    return torch.sigmoid(x)
def _layernorm(x, axis=-1, eps=1e-5):
    m = x.mean(dim=axis, keepdim=True)
    v = x.var(dim=axis, keepdim=True, unbiased=False)
    return (x - m) / torch.sqrt(v + eps)
def _scatter_add(tgt, idx, src, axis=0):
    return tgt.clone().index_add_(axis, idx, src)
def _segment_sum(src, seg, n):
    out = torch.zeros((n,) + src.shape[1:], dtype=src.dtype)
    return out.index_add_(0, seg, src)
def _pad(x, pw):
    flat = tuple(v for pair in reversed(pw) for v in pair)
    return torch.nn.functional.pad(x, flat)

kernel_name = 'parallel_sum__linear_attn_block__swiglu_ffn__prompt'

def setup_inputs():

    _w = (lambda a: (lambda t: t.to(torch.bfloat16) if t.is_floating_point() else t)(torch.as_tensor(a)))
    def _A_setup():
        B, S, D = 1, 2048, 512
        return {
            "x": _w((lambda *s: torch.randn(*s, dtype=torch.bfloat16) * 0.05)(B, S, D)),
            "wqkv": _w((lambda *s: torch.randn(*s, dtype=torch.bfloat16) * 0.2)(D, 3 * D)),
            "wo": _w((lambda *s: torch.randn(*s, dtype=torch.bfloat16) * 0.2)(D, D)),
        }
    _A_in = _A_setup()

    def _B_setup():
        B, S, D, F = 1, 2048, 512, 1792
        return {
            "x": _w((lambda *s: torch.randn(*s, dtype=torch.bfloat16) * 0.05)(B, S, D)),
            "w_gate": _w((lambda *s: torch.randn(*s, dtype=torch.bfloat16) * 0.05)(D, F)),
            "w_up": _w((lambda *s: torch.randn(*s, dtype=torch.bfloat16) * 0.05)(D, F)),
            "w_down": _w((lambda *s: torch.randn(*s, dtype=torch.bfloat16) * 0.05)(F, D)),
        }
    _B_in = _B_setup()

    return {
        "A_x": _A_in["x"],
        "A_wqkv": _A_in["wqkv"],
        "A_wo": _A_in["wo"],
        "B_x": _B_in["x"],
        "B_w_gate": _B_in["w_gate"],
        "B_w_up": _B_in["w_up"],
        "B_w_down": _B_in["w_down"],
    }

def reference(A_x, A_wqkv, A_wo, B_x, B_w_gate, B_w_up, B_w_down):
    def _A_ref(x, wqkv, wo):
        B, S, D = x.shape
        H = 32; Dh = D // H
        qkv = (lambda x, *d: x.permute(*d))((x @ wqkv).reshape(B, S, 3, H, Dh), 2, 0, 3, 1, 4)
        q, k, v = qkv[0], qkv[1], qkv[2]
        phi = lambda t: torch.where(t > 0, t + 1, torch.exp(t)) + 1e-6
        pq, pk = phi(q), phi(k)
        kv = torch.einsum("bhsd,bhse->bhde", pk, v)
        z = torch.einsum("bhsd->bhd", pk)
        num = torch.einsum("bhqd,bhde->bhqe", pq, kv)
        den = torch.einsum("bhqd,bhd->bhq", pq, z)[..., None] + 1e-6
        o = num / den
        return (lambda x, *d: x.permute(*d))(o, 0, 2, 1, 3).reshape(B, S, D) @ wo

    def _B_ref(x, w_gate, w_up, w_down):
        g = _silu(x @ w_gate)
        u = x @ w_up
        return (g * u) @ w_down

    x = A_x
    xn = _layernorm(x, axis=-1)
    return x + _A_ref(xn, A_wqkv, A_wo) + _B_ref(xn, B_w_gate, B_w_up, B_w_down)
```

```asm
; @launch grid=(256,1,1) block=(512,1,1) lds=163840
.amdgcn_target "amdgcn-amd-amdhsa--gfx950"
.text
.globl parallel_sum__linear_attn_block__swiglu_ffn__prompt_kernel
.p2align 8
.type parallel_sum__linear_attn_block__swiglu_ffn__prompt_kernel,@function
parallel_sum__linear_attn_block__swiglu_ffn__prompt_kernel:
    s_cmp_ge_u32 s2, 256
    s_cbranch_scc1 L_end
    s_load_dwordx16 s[16:31], s[0:1], 0
    s_load_dwordx4 s[32:35], s[0:1], 64
    v_lshrrev_b32 v1, 6, v0
    s_getpc_b64 s[98:99]
L_pc:
    s_lshr_b32 s96, s2, 3
    s_mul_i32 s96, s96, 0x900
    v_mul_u32_u24 v2, 9, v0
    v_lshrrev_b32 v2, 1, v2
    v_and_b32 v2, 0xf80, v2
    v_add_u32 v2, s96, v2
    v_min_u32 v2, L_last-L_pc, v2
    global_load_dword v9, v2, s[98:99]
    v_readfirstlane_b32 s3, v1
    s_and_b32 s8, s2, 1
    s_bfe_u32 s9, s2, 0x20001
    s_bfe_u32 s10, s2, 0x30003
    s_lshr_b32 s11, s2, 6
    s_lshl_b32 s4, s8, 3
    s_add_u32 s4, s4, s10
    s_and_b32 s12, s11, 1
    s_lshl_b32 s5, s9, 1
    s_lshl_b32 s36, s8, 2
    s_add_u32 s36, s36, s5
    s_add_u32 s5, s5, s12
    s_lshl_b32 s6, s8, 2
    s_add_u32 s6, s6, s9
    s_lshl_b32 s6, s6, 2
    s_add_u32 s36, s36, 2
    s_and_b32 s12, s10, 3
    s_add_u32 s6, s6, s12
    s_bfe_u32 s7, s2, 0x20005
    s_lshl_b32 s7, s7, 1
    s_lshr_b32 s12, s2, 7
    s_add_u32 s7, s7, s12
    s_mov_b32 s37, 400000
    s_cmp_lt_u32 s3, 4
    s_cbranch_scc1 L_compute
    v_and_b32 v0, 63, v0
    s_sub_u32 s3, s3, 4
    s_lshl_b32 s77, s3, 11
    v_lshrrev_b32 v21, 3, v0
    v_and_b32 v22, 7, v0
    v_lshrrev_b32 v23, 4, v0
    v_xor_b32 v24, v22, v23
    v_lshlrev_b32 v24, 4, v24
    v_lshl_add_u32 v2, v21, 10, v24
    v_xor_b32 v3, 64, v2
    v_add_u32 v3, 7168, v3
    s_lshl_b32 s79, s4, 2
    s_add_u32 s79, s79, s3
    s_lshl_b32 s79, s79, 15
    s_movk_i32 s85, 0x3ff
    s_lshl_b32 s84, s36, 7
    s_and_b32 s84, s84, s85
    s_add_u32 s78, s79, s84
    s_mov_b32 m0, s77
    s_mov_b32 s42, 0x200000
    s_mov_b32 s43, 0x20000
    s_waitcnt lgkmcnt(0)
    s_mov_b64 s[40:41], s[16:17]
    s_addk_i32 m0, 0x2000
    s_nop 0
    buffer_load_dwordx4 v2, s[40:43], s78 offen  lds
    buffer_load_dwordx4 v3, s[40:43], s78 offen offset:1024  lds
    s_addk_i32 m0, 0x2000
    s_addk_i32 s78, 128
    buffer_load_dwordx4 v2, s[40:43], s78 offen  lds
    buffer_load_dwordx4 v3, s[40:43], s78 offen offset:1024  lds
    s_addk_i32 m0, 0x2000
    s_addk_i32 s78, 0x3f80
    buffer_load_dwordx4 v2, s[40:43], s78 offen  lds
    buffer_load_dwordx4 v3, s[40:43], s78 offen offset:1024  lds
    s_addk_i32 m0, 0x2000
    s_addk_i32 s78, 128
    buffer_load_dwordx4 v2, s[40:43], s78 offen  lds
    buffer_load_dwordx4 v3, s[40:43], s78 offen offset:1024  lds
    s_addk_i32 m0, 0x2000
    s_addk_i32 s84, 256
    s_and_b32 s84, s84, s85
    s_add_u32 s78, s79, s84
    buffer_load_dwordx4 v2, s[40:43], s78 offen  lds
    buffer_load_dwordx4 v3, s[40:43], s78 offen offset:1024  lds
    s_addk_i32 m0, 0x2000
    s_addk_i32 s78, 128
    buffer_load_dwordx4 v2, s[40:43], s78 offen  lds
    buffer_load_dwordx4 v3, s[40:43], s78 offen offset:1024  lds
    s_addk_i32 m0, 0x2000
    s_addk_i32 s84, 256
    s_and_b32 s84, s84, s85
    s_add_u32 s78, s79, s84
    buffer_load_dwordx4 v2, s[40:43], s78 offen  lds
    buffer_load_dwordx4 v3, s[40:43], s78 offen offset:1024  lds
    s_mov_b32 s46, 0x180000
    s_mov_b32 s47, 0x20000
    s_mov_b32 s50, 0x1c0000
    s_mov_b32 s51, 0x20000
    s_mov_b32 s54, 0x1c0000
    s_mov_b32 s55, 0x20000
    s_lshl_b32 s76, s3, 4
    v_add_u32 v21, s76, v21
    s_lshl_b32 s80, s5, 7
    v_lshlrev_b32 v25, 1, v23
    v_and_b32 v25, 2, v25
    v_xor_b32 v24, v22, v25
    v_lshlrev_b32 v24, 4, v24
    v_xor_b32 v26, 64, v24
    v_mul_u32_u24 v25, 3072, v21
    v_add_u32 v4, v25, v24
    v_add_u32 v5, v25, v26
    v_add_u32 v5, 23552, v5
    v_mul_u32_u24 v25, 3584, v21
    v_add_u32 v6, v25, v24
    v_add_u32 v7, v25, v26
    v_add_u32 v7, 27648, v7
    s_mov_b64 s[44:45], s[18:19]
    s_mov_b64 s[48:49], s[24:25]
    s_mov_b64 s[52:53], s[26:27]
    s_xor_b32 s0, s80, 128
    s_xor_b32 s1, s80, 512
    s_mov_b64 s[56:57], s[28:29]
    s_mov_b32 s58, 0x1c0000
    s_mov_b32 s59, 0x20000
    s_mov_b64 s[60:61], s[20:21]
    s_mov_b32 s62, 0x80000
    s_mov_b32 s63, 0x20000
    s_mov_b64 s[64:65], s[34:35]
    s_mov_b32 s66, 0x2000000
    s_mov_b32 s67, 0x20000
    s_mov_b64 s[72:73], s[32:33]
    s_mov_b32 s74, 0x100
    s_mov_b32 s75, 0x20000
    v_lshlrev_b32 v25, 1, v23
    v_xor_b32 v24, v22, v25
    v_lshlrev_b32 v24, 4, v24
    v_lshl_add_u32 v16, v21, 10, v24
    v_add_u32 v17, 7168, v16
    v_lshrrev_b32 v25, 2, v0
    s_lshl_b32 s76, s3, 5
    v_add_u32 v25, s76, v25
    v_mul_u32_u24 v25, 3584, v25
    v_and_b32 v26, 3, v0
    v_and_b32 v27, 2, v23
    v_xor_b32 v27, v26, v27
    v_lshl_add_u32 v10, v27, 4, v25
    v_add_u32 v11, 56320, v10
    v_lshlrev_b32 v27, 4, v0
    s_and_b32 s76, s3, 2
    s_lshl_b32 s76, s76, 7
    s_and_b32 s82, s3, 1
    s_lshl_b32 s82, s82, 11
    s_add_u32 s76, s76, s82
    v_lshl_add_u32 v14, v26, 9, s76
    v_lshlrev_b32 v18, 10, v26
    v_lshrrev_b32 v25, 1, v26
    v_lshlrev_b32 v25, 10, v25
    v_and_b32 v15, 1, v26
    v_lshl_add_u32 v15, v15, 7, v25
    s_lshl_b32 s81, s7, 7
    s_mul_i32 s83, s6, 18432
    s_add_u32 s83, s83, 0x1000
    s_and_b32 s76, s6, 1
    s_lshl_b32 s69, s76, 16
    s_add_u32 s69, s69, s81
    s_and_b32 s71, s6, 30
    s_lshr_b32 s70, s3, 1
    s_add_u32 s71, s71, s70
    s_mul_i32 s71, s71, 36
    s_add_u32 s71, s71, s76
    s_lshl_b32 s71, s71, 1
    s_and_b32 s70, s3, 1
    s_add_u32 s71, s71, s70
    s_lshl_b32 s71, s71, 8
    s_add_u32 s71, s71, 0x1000
    s_lshl_b32 s86, s2, 2
    s_add_u32 s86, s86, s3
    s_lshr_b32 s87, s2, 3
    s_lshl_b32 s87, s87, 2
    s_add_u32 s87, s87, s3
    v_lshlrev_b32 v28, 7, v0
    v_lshlrev_b32 v30, 10, v0
    s_lshl_b32 s38, s5, 4
    s_add_u32 s38, s38, s4
    s_mul_i32 s82, s38, 6144
    s_add_u32 s82, s82, 0x100000
    s_mul_i32 s38, s38, 384
    s_add_u32 s38, s38, 0x1d0000
    s_xor_b32 s39, s5, 4
    s_lshl_b32 s39, s39, 2
    s_add_u32 s39, s39, s3
    s_mul_i32 s39, s39, 1536
    s_add_u32 s39, s39, 0x1d0000
    v_and_b32 v41, 15, v0
    v_lshl_add_u32 v42, v23, 7, v27
    v_mul_u32_u24 v40, 384, v23
    v_lshrrev_b32 v39, 2, v0
    v_mul_u32_u24 v39, 384, v39
    v_lshl_add_u32 v39, v26, 3, v39
    v_lshlrev_b32 v38, 2, v23
    v_lshl_add_u32 v38, v41, 4, v38
    v_lshlrev_b32 v37, 2, v0
    v_mov_b32 v36, 0xff
    s_mul_i32 s76, s3, 576
    v_lshl_add_u32 v43, v0, 3, s76
    v_lshl_add_u32 v44, v23, 3, s76
    s_waitcnt vmcnt(10)
    s_barrier
    s_addk_i32 m0, 0x2000
    s_addk_i32 s78, 128
    buffer_load_dwordx4 v2, s[40:43], s78 offen  lds
    buffer_load_dwordx4 v3, s[40:43], s78 offen offset:1024  lds
    s_addk_i32 m0, 0x2000
    s_addk_i32 s84, 256
    s_and_b32 s84, s84, s85
    s_add_u32 s78, s79, s84
    buffer_load_dwordx4 v2, s[40:43], s78 offen  lds
    buffer_load_dwordx4 v3, s[40:43], s78 offen offset:1024  lds
    s_addk_i32 m0, 0x2000
    s_addk_i32 s78, 128
    buffer_load_dwordx4 v2, s[40:43], s78 offen  lds
    buffer_load_dwordx4 v3, s[40:43], s78 offen offset:1024  lds
    s_addk_i32 m0, 0x2000
    s_addk_i32 s79, 0x4000
    s_addk_i32 s84, 256
    s_addk_i32 s84, 256
    s_and_b32 s84, s84, s85
    s_add_u32 s78, s79, s84
    buffer_load_dwordx4 v2, s[40:43], s78 offen  lds
    buffer_load_dwordx4 v3, s[40:43], s78 offen offset:1024  lds
    s_waitcnt vmcnt(10)
    s_barrier
    s_addk_i32 m0, 0x2000
    s_addk_i32 s78, 128
    buffer_load_dwordx4 v2, s[40:43], s78 offen  lds
    buffer_load_dwordx4 v3, s[40:43], s78 offen offset:1024  lds
    s_addk_i32 m0, 0x2000
    s_addk_i32 s84, 256
    s_and_b32 s84, s84, s85
    s_add_u32 s78, s79, s84
    buffer_load_dwordx4 v2, s[40:43], s78 offen  lds
    buffer_load_dwordx4 v3, s[40:43], s78 offen offset:1024  lds
    s_waitcnt vmcnt(10)
    s_barrier
    s_addk_i32 m0, 0x2000
    s_addk_i32 s78, 128
    buffer_load_dwordx4 v2, s[40:43], s78 offen  lds
    buffer_load_dwordx4 v3, s[40:43], s78 offen offset:1024  lds
    s_addk_i32 m0, 0x2000
    s_addk_i32 s84, 256
    s_and_b32 s84, s84, s85
    s_add_u32 s78, s79, s84
    buffer_load_dwordx4 v2, s[40:43], s78 offen  lds
    buffer_load_dwordx4 v3, s[40:43], s78 offen offset:1024  lds
    s_waitcnt vmcnt(10)
    s_barrier
    s_addk_i32 m0, 0x2000
    s_addk_i32 s78, 128
    buffer_load_dwordx4 v2, s[40:43], s78 offen  lds
    buffer_load_dwordx4 v3, s[40:43], s78 offen offset:1024  lds
    s_cmp_ge_u32 s2, 128
    s_cbranch_scc1 L_loadF
L_loadA:
    s_add_u32 s84, s36, 0
    s_and_b32 s84, s84, 7
    s_mul_i32 s84, s84, 196608
    s_add_u32 s84, s84, s80
    s_add_u32 m0, s77, 139264
    s_add_u32 s78, s84, 1024
    buffer_load_dwordx4 v4, s[44:47], s78 offen  lds
    buffer_load_dwordx4 v5, s[44:47], s78 offen offset:1024  lds
    s_and_b32 s76, s4, 7
    s_mul_i32 s76, s76, 196608
    s_add_u32 s76, s76, s80
    s_mov_b32 exec_lo, 0x01010101
    s_mov_b32 exec_hi, 0x01010101
    buffer_load_dword v140, v4, s[44:47], s76 offen offset:1024
    buffer_load_dword v141, v5, s[44:47], s76 offen offset:2048
    s_mov_b64 exec, -1
    s_waitcnt vmcnt(10)
    s_barrier
    s_lshl_b32 s76, s4, 2
    s_sub_u32 s76, s76, s3
    s_mul_i32 s76, s76, 24576
    s_mov_b32 exec_lo, 0x01010101
    s_mov_b32 exec_hi, 0x01010101
    s_add_u32 s76, s76, s80
    v_add_u32 v29, s76, v4
    buffer_load_dword v142, v29, s[44:47], 0 offen offset:2048
    s_mov_b64 exec, -1
    s_add_u32 s84, s36, 1
    s_and_b32 s84, s84, 7
    s_mul_i32 s84, s84, 196608
    s_add_u32 s84, s84, s80
    s_add_u32 m0, s77, 147456
    s_add_u32 s78, s84, 1024
    buffer_load_dwordx4 v4, s[44:47], s78 offen  lds
    buffer_load_dwordx4 v5, s[44:47], s78 offen offset:1024  lds
    s_add_u32 s84, s36, 2
    s_and_b32 s84, s84, 7
    s_mul_i32 s84, s84, 196608
    s_add_u32 s84, s84, s80
    s_add_u32 m0, s77, 155648
    s_add_u32 s78, s84, 1024
    buffer_load_dwordx4 v4, s[44:47], s78 offen  lds
    buffer_load_dwordx4 v5, s[44:47], s78 offen offset:1024  lds
    s_add_u32 s84, s36, 3
    s_and_b32 s84, s84, 7
    s_mul_i32 s84, s84, 196608
    s_add_u32 s84, s84, s80
    s_add_u32 m0, s77, 8192
    s_add_u32 s78, s84, 1024
    buffer_load_dwordx4 v4, s[44:47], s78 offen  lds
    buffer_load_dwordx4 v5, s[44:47], s78 offen offset:1024  lds
    s_waitcnt vmcnt(11)
    s_barrier
    s_add_u32 s84, s36, 4
    s_and_b32 s84, s84, 7
    s_mul_i32 s84, s84, 196608
    s_add_u32 s84, s84, s80
    s_add_u32 m0, s77, 16384
    s_add_u32 s78, s84, 1024
    buffer_load_dwordx4 v4, s[44:47], s78 offen  lds
    buffer_load_dwordx4 v5, s[44:47], s78 offen offset:1024  lds
    s_add_u32 s84, s36, 5
    s_and_b32 s84, s84, 7
    s_mul_i32 s84, s84, 196608
    s_add_u32 s84, s84, s80
    s_add_u32 m0, s77, 24576
    s_add_u32 s78, s84, 1024
    buffer_load_dwordx4 v4, s[44:47], s78 offen  lds
    buffer_load_dwordx4 v5, s[44:47], s78 offen offset:1024  lds
    s_add_u32 s84, s36, 6
    s_and_b32 s84, s84, 7
    s_mul_i32 s84, s84, 196608
    s_add_u32 s84, s84, s80
    s_add_u32 m0, s77, 32768
    s_add_u32 s78, s84, 1024
    buffer_load_dwordx4 v4, s[44:47], s78 offen  lds
    buffer_load_dwordx4 v5, s[44:47], s78 offen offset:1024  lds
    s_waitcnt vmcnt(10)
    s_barrier
    s_add_u32 s84, s36, 7
    s_and_b32 s84, s84, 7
    s_mul_i32 s84, s84, 196608
    s_add_u32 s84, s84, s80
    s_add_u32 m0, s77, 40960
    s_add_u32 s78, s84, 1024
    buffer_load_dwordx4 v4, s[44:47], s78 offen  lds
    buffer_load_dwordx4 v5, s[44:47], s78 offen offset:1024  lds
    s_add_u32 s84, s36, 0
    s_and_b32 s84, s84, 7
    s_mul_i32 s84, s84, 196608
    s_add_u32 s84, s84, s80
    s_add_u32 m0, s77, 49152
    s_add_u32 s78, s84, 2048
    buffer_load_dwordx4 v4, s[44:47], s78 offen  lds
    buffer_load_dwordx4 v5, s[44:47], s78 offen offset:1024  lds
    s_add_u32 s84, s36, 1
    s_and_b32 s84, s84, 7
    s_mul_i32 s84, s84, 196608
    s_add_u32 s84, s84, s80
    s_add_u32 m0, s77, 57344
    s_add_u32 s78, s84, 2048
    buffer_load_dwordx4 v4, s[44:47], s78 offen  lds
    buffer_load_dwordx4 v5, s[44:47], s78 offen offset:1024  lds
    s_add_u32 s84, s36, 2
    s_and_b32 s84, s84, 7
    s_mul_i32 s84, s84, 196608
    s_add_u32 s84, s84, s80
    s_add_u32 m0, s77, 65536
    s_add_u32 s78, s84, 2048
    buffer_load_dwordx4 v4, s[44:47], s78 offen  lds
    buffer_load_dwordx4 v5, s[44:47], s78 offen offset:1024  lds
    s_waitcnt vmcnt(12)
    s_barrier
    s_add_u32 s84, s36, 3
    s_and_b32 s84, s84, 7
    s_mul_i32 s84, s84, 196608
    s_add_u32 s84, s84, s80
    s_add_u32 m0, s77, 73728
    s_add_u32 s78, s84, 2048
    buffer_load_dwordx4 v4, s[44:47], s78 offen  lds
    buffer_load_dwordx4 v5, s[44:47], s78 offen offset:1024  lds
    s_add_u32 s84, s36, 4
    s_and_b32 s84, s84, 7
    s_mul_i32 s84, s84, 196608
    s_add_u32 s84, s84, s80
    s_add_u32 m0, s77, 81920
    s_add_u32 s78, s84, 2048
    buffer_load_dwordx4 v4, s[44:47], s78 offen  lds
    buffer_load_dwordx4 v5, s[44:47], s78 offen offset:1024  lds
    s_add_u32 s84, s36, 5
    s_and_b32 s84, s84, 7
    s_mul_i32 s84, s84, 196608
    s_add_u32 s84, s84, s80
    s_add_u32 m0, s77, 90112
    s_add_u32 s78, s84, 2048
    buffer_load_dwordx4 v4, s[44:47], s78 offen  lds
    buffer_load_dwordx4 v5, s[44:47], s78 offen offset:1024  lds
    s_add_u32 s84, s36, 6
    s_and_b32 s84, s84, 7
    s_mul_i32 s84, s84, 196608
    s_add_u32 s84, s84, s80
    s_add_u32 m0, s77, 98304
    s_add_u32 s78, s84, 2048
    buffer_load_dwordx4 v4, s[44:47], s78 offen  lds
    buffer_load_dwordx4 v5, s[44:47], s78 offen offset:1024  lds
    s_add_u32 s84, s36, 7
    s_and_b32 s84, s84, 7
    s_mul_i32 s84, s84, 196608
    s_add_u32 s84, s84, s80
    s_add_u32 m0, s77, 106496
    s_add_u32 s78, s84, 2048
    buffer_load_dwordx4 v4, s[44:47], s78 offen  lds
    buffer_load_dwordx4 v5, s[44:47], s78 offen offset:1024  lds
    s_add_u32 s84, s36, 0
    s_and_b32 s84, s84, 7
    s_mul_i32 s84, s84, 229376
    s_add_u32 s84, s84, s0
    s_add_u32 m0, s77, 114688
    s_add_u32 s78, s84, 2048
    buffer_load_dwordx4 v6, s[48:51], s78 offen  lds
    buffer_load_dwordx4 v7, s[48:51], s78 offen offset:1024  lds
    s_waitcnt vmcnt(14)
    s_barrier
    buffer_load_dword v13, off, s[72:75], 0 sc1
    s_and_b32 s76, s4, 7
    s_mul_i32 s76, s76, 229376
    s_add_u32 s76, s76, s0
    s_mov_b32 exec_lo, 0x01010101
    s_mov_b32 exec_hi, 0x01010101
    buffer_load_dword v143, v6, s[48:51], s76 offen offset:2048
    buffer_load_dword v144, v7, s[48:51], s76 offen offset:3072
    s_mov_b64 exec, -1
    s_and_b32 s76, s4, 7
    s_mul_i32 s76, s76, 196608
    s_add_u32 s76, s76, s1
    s_mov_b32 exec_lo, 0x01010101
    s_mov_b32 exec_hi, 0x01010101
    buffer_load_dword v145, v4, s[44:47], s76 offen offset:0
    buffer_load_dword v146, v5, s[44:47], s76 offen offset:1024
    s_mov_b64 exec, -1
    s_mul_i32 s76, s86, 1792
    s_mov_b64 exec, 0x3fff
    buffer_load_dword v147, v28, s[56:59], s76 offen
    s_mul_i32 s76, s86, 512
    s_mov_b64 exec, 0xf
    buffer_load_dword v148, v28, s[60:63], s76 offen
    s_mov_b64 exec, -1
    s_and_b32 s76, s4, 7
    s_mul_i32 s76, s76, 229376
    s_add_u32 s76, s76, s0
    s_mov_b32 exec_lo, 0x01010101
    s_mov_b32 exec_hi, 0x01010101
    buffer_load_dword v149, v6, s[52:55], s76 offen offset:2048
    buffer_load_dword v150, v7, s[52:55], s76 offen offset:3072
    s_mov_b64 exec, -1
    s_waitcnt vmcnt(15)
    s_barrier
    s_add_u32 s84, s36, 1
    s_and_b32 s84, s84, 7
    s_mul_i32 s84, s84, 229376
    s_add_u32 s84, s84, s0
    s_add_u32 m0, s77, 122880
    s_add_u32 s78, s84, 2048
    buffer_load_dwordx4 v6, s[48:51], s78 offen  lds
    buffer_load_dwordx4 v7, s[48:51], s78 offen offset:1024  lds
    s_add_u32 s84, s36, 2
    s_and_b32 s84, s84, 7
    s_mul_i32 s84, s84, 229376
    s_add_u32 s84, s84, s0
    s_add_u32 m0, s77, 131072
    s_add_u32 s78, s84, 2048
    buffer_load_dwordx4 v6, s[48:51], s78 offen  lds
    buffer_load_dwordx4 v7, s[48:51], s78 offen offset:1024  lds
    s_add_u32 s84, s36, 3
    s_and_b32 s84, s84, 7
    s_mul_i32 s84, s84, 229376
    s_add_u32 s84, s84, s0
    s_add_u32 m0, s77, 139264
    s_add_u32 s78, s84, 2048
    buffer_load_dwordx4 v6, s[48:51], s78 offen  lds
    buffer_load_dwordx4 v7, s[48:51], s78 offen offset:1024  lds
    s_add_u32 s84, s36, 4
    s_and_b32 s84, s84, 7
    s_mul_i32 s84, s84, 229376
    s_add_u32 s84, s84, s0
    s_add_u32 m0, s77, 147456
    s_add_u32 s78, s84, 2048
    buffer_load_dwordx4 v6, s[48:51], s78 offen  lds
    buffer_load_dwordx4 v7, s[48:51], s78 offen offset:1024  lds
    s_add_u32 s84, s36, 5
    s_and_b32 s84, s84, 7
    s_mul_i32 s84, s84, 229376
    s_add_u32 s84, s84, s0
    s_add_u32 m0, s77, 155648
    s_add_u32 s78, s84, 2048
    buffer_load_dwordx4 v6, s[48:51], s78 offen  lds
    buffer_load_dwordx4 v7, s[48:51], s78 offen offset:1024  lds
    s_waitcnt vmcnt(18)
    v_cmp_eq_u32 vcc, 0, v13
    s_cbranch_vccz Lc_3001
Lp_3002:
    buffer_load_dword v13, off, s[72:75], 0 sc1
    s_sub_u32 s37, s37, 1
    s_cbranch_scc1 L_end
    s_waitcnt vmcnt(0)
    v_cmp_eq_u32 vcc, 0, v13
    s_cbranch_vccnz Lp_3002
Lc_3001:
    s_waitcnt vmcnt(8)
    s_barrier
    s_add_u32 s84, s36, 6
    s_and_b32 s84, s84, 7
    s_mul_i32 s84, s84, 229376
    s_add_u32 s84, s84, s0
    s_add_u32 m0, s77, 8192
    s_add_u32 s78, s84, 2048
    buffer_load_dwordx4 v6, s[48:51], s78 offen  lds
    buffer_load_dwordx4 v7, s[48:51], s78 offen offset:1024  lds
    s_add_u32 s84, s36, 7
    s_and_b32 s84, s84, 7
    s_mul_i32 s84, s84, 229376
    s_add_u32 s84, s84, s0
    s_add_u32 m0, s77, 16384
    s_add_u32 s78, s84, 2048
    buffer_load_dwordx4 v6, s[48:51], s78 offen  lds
    buffer_load_dwordx4 v7, s[48:51], s78 offen offset:1024  lds
    s_add_u32 s84, s36, 0
    s_and_b32 s84, s84, 7
    s_mul_i32 s84, s84, 229376
    s_add_u32 s84, s84, s0
    s_add_u32 m0, s77, 24576
    s_add_u32 s78, s84, 2048
    buffer_load_dwordx4 v6, s[52:55], s78 offen  lds
    buffer_load_dwordx4 v7, s[52:55], s78 offen offset:1024  lds
    s_add_u32 s84, s36, 1
    s_and_b32 s84, s84, 7
    s_mul_i32 s84, s84, 229376
    s_add_u32 s84, s84, s0
    s_add_u32 m0, s77, 32768
    s_add_u32 s78, s84, 2048
    buffer_load_dwordx4 v6, s[52:55], s78 offen  lds
    buffer_load_dwordx4 v7, s[52:55], s78 offen offset:1024  lds
    s_add_u32 s84, s36, 2
    s_and_b32 s84, s84, 7
    s_mul_i32 s84, s84, 229376
    s_add_u32 s84, s84, s0
    s_add_u32 m0, s77, 40960
    s_add_u32 s78, s84, 2048
    buffer_load_dwordx4 v6, s[52:55], s78 offen  lds
    buffer_load_dwordx4 v7, s[52:55], s78 offen offset:1024  lds
    s_add_u32 s84, s36, 3
    s_and_b32 s84, s84, 7
    s_mul_i32 s84, s84, 229376
    s_add_u32 s84, s84, s0
    s_add_u32 m0, s77, 49152
    s_add_u32 s78, s84, 2048
    buffer_load_dwordx4 v6, s[52:55], s78 offen  lds
    buffer_load_dwordx4 v7, s[52:55], s78 offen offset:1024  lds
    s_add_u32 s84, s36, 4
    s_and_b32 s84, s84, 7
    s_mul_i32 s84, s84, 229376
    s_add_u32 s84, s84, s0
    s_add_u32 m0, s77, 57344
    s_add_u32 s78, s84, 2048
    buffer_load_dwordx4 v6, s[52:55], s78 offen  lds
    buffer_load_dwordx4 v7, s[52:55], s78 offen offset:1024  lds
    s_add_u32 s84, s36, 5
    s_and_b32 s84, s84, 7
    s_mul_i32 s84, s84, 229376
    s_add_u32 s84, s84, s0
    s_add_u32 m0, s77, 65536
    s_add_u32 s78, s84, 2048
    buffer_load_dwordx4 v6, s[52:55], s78 offen  lds
    buffer_load_dwordx4 v7, s[52:55], s78 offen offset:1024  lds
    s_waitcnt vmcnt(16)
    s_barrier
    s_mul_i32 s76, s87, 14336
    s_mov_b64 exec, 0x3fff
    buffer_load_dword v151, v30, s[56:59], s76 offen offset:384
    s_mul_i32 s76, s87, 4096
    s_mov_b64 exec, 0xf
    buffer_load_dword v152, v30, s[60:63], s76 offen offset:384
    s_mov_b64 exec, -1
    s_barrier
    s_add_u32 s84, s36, 6
    s_and_b32 s84, s84, 7
    s_mul_i32 s84, s84, 229376
    s_add_u32 s84, s84, s0
    s_add_u32 m0, s77, 73728
    s_add_u32 s78, s84, 2048
    buffer_load_dwordx4 v6, s[52:55], s78 offen  lds
    buffer_load_dwordx4 v7, s[52:55], s78 offen offset:1024  lds
    s_add_u32 s84, s36, 7
    s_and_b32 s84, s84, 7
    s_mul_i32 s84, s84, 229376
    s_add_u32 s84, s84, s0
    s_add_u32 m0, s77, 81920
    s_add_u32 s78, s84, 2048
    buffer_load_dwordx4 v6, s[52:55], s78 offen  lds
    buffer_load_dwordx4 v7, s[52:55], s78 offen offset:1024  lds
    s_add_u32 s84, s36, 0
    s_and_b32 s84, s84, 7
    s_mul_i32 s84, s84, 196608
    s_add_u32 s84, s84, s1
    s_add_u32 m0, s77, 90112
    s_add_u32 s78, s84, 0
    buffer_load_dwordx4 v4, s[44:47], s78 offen  lds
    buffer_load_dwordx4 v5, s[44:47], s78 offen offset:1024  lds
    s_waitcnt vmcnt(16)
    s_barrier
    s_add_u32 s84, s36, 1
    s_and_b32 s84, s84, 7
    s_mul_i32 s84, s84, 196608
    s_add_u32 s84, s84, s1
    s_add_u32 m0, s77, 114688
    s_add_u32 s78, s84, 0
    buffer_load_dwordx4 v4, s[44:47], s78 offen  lds
    buffer_load_dwordx4 v5, s[44:47], s78 offen offset:1024  lds
    s_add_u32 s84, s36, 2
    s_and_b32 s84, s84, 7
    s_mul_i32 s84, s84, 196608
    s_add_u32 s84, s84, s1
    s_add_u32 m0, s77, 122880
    s_add_u32 s78, s84, 0
    buffer_load_dwordx4 v4, s[44:47], s78 offen  lds
    buffer_load_dwordx4 v5, s[44:47], s78 offen offset:1024  lds
    s_add_u32 s84, s36, 3
    s_and_b32 s84, s84, 7
    s_mul_i32 s84, s84, 196608
    s_add_u32 s84, s84, s1
    s_add_u32 m0, s77, 131072
    s_add_u32 s78, s84, 0
    buffer_load_dwordx4 v4, s[44:47], s78 offen  lds
    buffer_load_dwordx4 v5, s[44:47], s78 offen offset:1024  lds
    s_add_u32 s84, s36, 4
    s_and_b32 s84, s84, 7
    s_mul_i32 s84, s84, 196608
    s_add_u32 s84, s84, s1
    s_add_u32 m0, s77, 98304
    s_add_u32 s78, s84, 0
    buffer_load_dwordx4 v4, s[44:47], s78 offen  lds
    buffer_load_dwordx4 v5, s[44:47], s78 offen offset:1024  lds
    s_add_u32 s84, s36, 5
    s_and_b32 s84, s84, 7
    s_mul_i32 s84, s84, 196608
    s_add_u32 s84, s84, s1
    s_add_u32 m0, s77, 106496
    s_add_u32 s78, s84, 0
    buffer_load_dwordx4 v4, s[44:47], s78 offen  lds
    buffer_load_dwordx4 v5, s[44:47], s78 offen offset:1024  lds
    s_waitcnt vmcnt(18)
    s_barrier
    s_add_u32 s84, s36, 6
    s_and_b32 s84, s84, 7
    s_mul_i32 s84, s84, 196608
    s_add_u32 s84, s84, s1
    s_add_u32 m0, s77, 139264
    s_add_u32 s78, s84, 0
    buffer_load_dwordx4 v4, s[44:47], s78 offen  lds
    buffer_load_dwordx4 v5, s[44:47], s78 offen offset:1024  lds
    s_add_u32 s84, s36, 7
    s_and_b32 s84, s84, 7
    s_mul_i32 s84, s84, 196608
    s_add_u32 s84, s84, s1
    s_add_u32 m0, s77, 147456
    s_add_u32 s78, s84, 0
    buffer_load_dwordx4 v4, s[44:47], s78 offen  lds
    buffer_load_dwordx4 v5, s[44:47], s78 offen offset:1024  lds
    s_add_u32 m0, s77, 155648
    s_add_u32 s78, s69, 0
    buffer_load_dwordx4 v16, s[56:59], s78 offen  lds
    buffer_load_dwordx4 v17, s[56:59], s78 offen offset:1024  lds
    s_add_u32 m0, s77, 8192
    s_add_u32 s78, s69, 131072
    buffer_load_dwordx4 v16, s[56:59], s78 offen  lds
    buffer_load_dwordx4 v17, s[56:59], s78 offen offset:1024  lds
    s_cmp_lg_u32 s3, 0
    s_cbranch_scc1 Ln_3004
    s_add_u32 s78, s82, 0
    buffer_load_dwordx4 v[64:67], v42, s[64:67], s78 offen sc1
    s_add_u32 s78, s82, 1536
    buffer_load_dwordx4 v[68:71], v42, s[64:67], s78 offen sc1
    s_add_u32 s78, s82, 3072
    buffer_load_dwordx4 v[72:75], v42, s[64:67], s78 offen sc1
    s_add_u32 s78, s82, 4608
    buffer_load_dwordx4 v[76:79], v42, s[64:67], s78 offen sc1
    s_branch Le_3003
Ln_3004:
    s_cmp_lg_u32 s3, 1
    s_cbranch_scc1 Le_3003
    buffer_load_dword v64, v39, s[64:67], s82 offen offset:256 sc1
Le_3003:
    s_waitcnt vmcnt(16)
    s_barrier
    s_setprio 2
    s_cmp_lg_u32 s3, 0
    s_cbranch_scc1 Ln_3027
    s_waitcnt vmcnt(0)
    v_and_b32 v33, 0xff, v13
    v_xor_b32 v64, v33, v64
    v_xor_b32 v68, v33, v68
    v_xor_b32 v72, v33, v72
    v_xor_b32 v76, v33, v76
    v_mov_b32 v32, v64
    v_or3_b32 v32, v32, v68, v72
    v_or3_b32 v32, v32, v76, v76
    v_and_b32 v32, 0xff, v32
    v_cmp_ne_u32 vcc, 0, v32
    s_cbranch_vccz Lc_3008
Lr_3007:
    s_add_u32 s78, s82, 0
    buffer_load_dwordx4 v[64:67], v42, s[64:67], s78 offen sc1
    s_add_u32 s78, s82, 1536
    buffer_load_dwordx4 v[68:71], v42, s[64:67], s78 offen sc1
    s_add_u32 s78, s82, 3072
    buffer_load_dwordx4 v[72:75], v42, s[64:67], s78 offen sc1
    s_add_u32 s78, s82, 4608
    buffer_load_dwordx4 v[76:79], v42, s[64:67], s78 offen sc1
    s_sub_u32 s37, s37, 1
    s_cbranch_scc1 L_end
    s_waitcnt vmcnt(0)
    v_and_b32 v33, 0xff, v13
    v_xor_b32 v64, v33, v64
    v_xor_b32 v68, v33, v68
    v_xor_b32 v72, v33, v72
    v_xor_b32 v76, v33, v76
    v_mov_b32 v32, v64
    v_or3_b32 v32, v32, v68, v72
    v_or3_b32 v32, v32, v76, v76
    v_and_b32 v32, 0xff, v32
    v_cmp_ne_u32 vcc, 0, v32
    s_cbranch_vccnz Lr_3007
Lc_3008:
    s_nop 0
    v_add_f32 v64, v64, v68
    v_add_f32 v65, v65, v69
    v_add_f32 v66, v66, v70
    v_add_f32 v67, v67, v71
    v_add_f32 v72, v72, v76
    v_add_f32 v73, v73, v77
    v_add_f32 v74, v74, v78
    v_add_f32 v75, v75, v79
    v_add_f32 v64, v64, v72
    v_add_f32 v65, v65, v73
    v_add_f32 v66, v66, v74
    v_add_f32 v67, v67, v75
    s_nop 0
    v_permlane32_swap_b32 v64, v66
    v_permlane32_swap_b32 v65, v67
    v_add_f32 v64, v64, v66
    v_add_f32 v65, v65, v67
    s_nop 1
    v_permlane16_swap_b32 v64, v65
    v_add_f32 v64, v64, v65
    v_bfi_b32 v64, v36, v13, v64
    buffer_store_dword v64, v38, s[64:67], s38 offen sc1
    s_branch Le_3026
Ln_3027:
    s_cmp_lg_u32 s3, 1
    s_cbranch_scc1 Le_3026
    s_waitcnt vmcnt(0)
    v_and_b32 v33, 0xff, v13
    v_xor_b32 v64, v33, v64
    v_mov_b32 v32, v64
    v_and_b32 v32, 0xff, v32
    v_cmp_ne_u32 vcc, 0, v32
    s_cbranch_vccz Lc_3018
Lr_3017:
    buffer_load_dword v64, v39, s[64:67], s82 offen offset:256 sc1
    s_sub_u32 s37, s37, 1
    s_cbranch_scc1 L_end
    s_waitcnt vmcnt(0)
    v_and_b32 v33, 0xff, v13
    v_xor_b32 v64, v33, v64
    v_mov_b32 v32, v64
    v_and_b32 v32, 0xff, v32
    v_cmp_ne_u32 vcc, 0, v32
    s_cbranch_vccnz Lr_3017
Lc_3018:
    s_nop 0
    v_add_f32_dpp v64, v64, v64 row_ror:4 row_mask:0xf bank_mask:0xf
    s_nop 1
    v_add_f32_dpp v64, v64, v64 row_ror:8 row_mask:0xf bank_mask:0xf
    v_mov_b32 v65, v64
    s_nop 1
    v_permlane32_swap_b32 v64, v65
    v_add_f32 v64, v64, v65
    v_mov_b32 v65, v64
    s_nop 1
    v_permlane16_swap_b32 v64, v65
    v_add_f32 v64, v64, v65
    v_mul_f32 v64, 0x3fb8aa3b, v64
    v_bfi_b32 v64, v36, v13, v64
    s_mov_b32 exec_hi, 0
    buffer_store_dword v64, v37, s[64:67], s38 offen offset:256 sc1
    s_mov_b32 exec_hi, -1
Le_3026:
    s_setprio 0
    s_add_u32 m0, s77, 16384
    s_add_u32 s78, s69, 262144
    buffer_load_dwordx4 v16, s[56:59], s78 offen  lds
    buffer_load_dwordx4 v17, s[56:59], s78 offen offset:1024  lds
    s_add_u32 m0, s77, 24576
    s_add_u32 s78, s69, 393216
    buffer_load_dwordx4 v16, s[56:59], s78 offen  lds
    buffer_load_dwordx4 v17, s[56:59], s78 offen offset:1024  lds
    s_add_u32 m0, s77, 32768
    s_add_u32 s78, s69, 1572864
    buffer_load_dwordx4 v16, s[56:59], s78 offen  lds
    buffer_load_dwordx4 v17, s[56:59], s78 offen offset:1024  lds
    s_add_u32 m0, s77, 40960
    s_add_u32 s78, s69, 1703936
    buffer_load_dwordx4 v16, s[56:59], s78 offen  lds
    buffer_load_dwordx4 v17, s[56:59], s78 offen offset:1024  lds
    s_add_u32 m0, s77, 49152
    s_add_u32 s78, s69, 1048576
    buffer_load_dwordx4 v16, s[56:59], s78 offen  lds
    buffer_load_dwordx4 v17, s[56:59], s78 offen offset:1024  lds
    s_waitcnt vmcnt(18)
    s_barrier
    s_add_u32 s76, s71, 0
    s_mov_b64 exec, 15
    buffer_load_dword v200, v18, s[64:67], s76 offen sc1
    s_mov_b64 exec, -1
    s_add_u32 m0, s77, 57344
    s_add_u32 s78, s69, 1179648
    buffer_load_dwordx4 v16, s[56:59], s78 offen  lds
    buffer_load_dwordx4 v17, s[56:59], s78 offen offset:1024  lds
    s_add_u32 m0, s77, 65536
    s_add_u32 s78, s69, 1310720
    buffer_load_dwordx4 v16, s[56:59], s78 offen  lds
    buffer_load_dwordx4 v17, s[56:59], s78 offen offset:1024  lds
    s_add_u32 m0, s77, 73728
    s_add_u32 s78, s69, 1441792
    buffer_load_dwordx4 v16, s[56:59], s78 offen  lds
    buffer_load_dwordx4 v17, s[56:59], s78 offen offset:1024  lds
    s_add_u32 m0, s77, 81920
    s_add_u32 s78, s69, 524288
    buffer_load_dwordx4 v16, s[56:59], s78 offen  lds
    buffer_load_dwordx4 v17, s[56:59], s78 offen offset:1024  lds
    s_add_u32 s76, s71, 0
    s_mov_b64 exec, 15
    s_waitcnt vmcnt(8)
    v_cmp_ne_u32 vcc, v13, v200
    s_cbranch_vccz Lc_3030
Lp_3031:
    buffer_load_dword v200, v18, s[64:67], s76 offen sc1
    s_sub_u32 s37, s37, 1
    s_cbranch_scc1 L_end
    s_waitcnt vmcnt(0)
    v_cmp_ne_u32 vcc, v13, v200
    s_cbranch_vccnz Lp_3031
Lc_3030:
Lc_3029:
    s_mov_b64 exec, -1
    s_barrier
    buffer_load_dwordx4 v[80:83], v42, s[64:67], s39 offen sc1
    buffer_load_dwordx4 v[84:87], v40, s[64:67], s39 offen offset:256 sc1
    s_add_u32 m0, s77, 90112
    s_add_u32 s78, s69, 655360
    buffer_load_dwordx4 v16, s[56:59], s78 offen  lds
    buffer_load_dwordx4 v17, s[56:59], s78 offen offset:1024  lds
    s_add_u32 m0, s77, 114688
    s_add_u32 s78, s69, 786432
    buffer_load_dwordx4 v16, s[56:59], s78 offen  lds
    buffer_load_dwordx4 v17, s[56:59], s78 offen offset:1024  lds
    s_add_u32 m0, s77, 122880
    s_add_u32 s78, s69, 917504
    buffer_load_dwordx4 v16, s[56:59], s78 offen  lds
    buffer_load_dwordx4 v17, s[56:59], s78 offen offset:1024  lds
    s_add_u32 m0, s77, 131072
    s_add_u32 s78, s81, 0
    buffer_load_dwordx4 v16, s[60:63], s78 offen  lds
    buffer_load_dwordx4 v17, s[60:63], s78 offen offset:1024  lds
    s_setprio 2
    s_waitcnt vmcnt(8)
    v_and_b32 v33, 0xff, v13
    v_xor_b32 v80, v33, v80
    v_xor_b32 v81, v33, v81
    v_xor_b32 v82, v33, v82
    v_xor_b32 v83, v33, v83
    v_xor_b32 v84, v33, v84
    v_xor_b32 v85, v33, v85
    v_xor_b32 v86, v33, v86
    v_xor_b32 v87, v33, v87
    v_mov_b32 v32, v80
    v_or3_b32 v32, v32, v81, v82
    v_or3_b32 v32, v32, v83, v84
    v_or3_b32 v32, v32, v85, v86
    v_or3_b32 v32, v32, v87, v87
    v_and_b32 v32, 0xff, v32
    v_cmp_ne_u32 vcc, 0, v32
    s_cbranch_vccz Lc_3034
Lr_3033:
    buffer_load_dwordx4 v[80:83], v42, s[64:67], s39 offen sc1
    buffer_load_dwordx4 v[84:87], v40, s[64:67], s39 offen offset:256 sc1
    s_sub_u32 s37, s37, 1
    s_cbranch_scc1 L_end
    s_waitcnt vmcnt(0)
    v_and_b32 v33, 0xff, v13
    v_xor_b32 v80, v33, v80
    v_xor_b32 v81, v33, v81
    v_xor_b32 v82, v33, v82
    v_xor_b32 v83, v33, v83
    v_xor_b32 v84, v33, v84
    v_xor_b32 v85, v33, v85
    v_xor_b32 v86, v33, v86
    v_xor_b32 v87, v33, v87
    v_mov_b32 v32, v80
    v_or3_b32 v32, v32, v81, v82
    v_or3_b32 v32, v32, v83, v84
    v_or3_b32 v32, v32, v85, v86
    v_or3_b32 v32, v32, v87, v87
    v_and_b32 v32, 0xff, v32
    v_cmp_ne_u32 vcc, 0, v32
    s_cbranch_vccnz Lr_3033
Lc_3034:
    s_nop 0
    v_cvt_pk_bf16_f32 v88, v80, v81
    v_cvt_pk_bf16_f32 v89, v82, v83
    v_cvt_pk_bf16_f32 v90, v84, v85
    v_cvt_pk_bf16_f32 v91, v86, v87
    ds_write_b64 v43, v[88:89] offset:1024
    ds_write_b64 v44, v[90:91] offset:1536
    s_setprio 0
    s_add_u32 s76, s71, 12288
    s_mov_b64 exec, 15
    buffer_load_dword v204, v15, s[64:67], s76 offen sc1
    s_mov_b64 exec, -1
    s_waitcnt lgkmcnt(0)
    s_barrier
    s_add_u32 m0, s77, 98304
    s_add_u32 s78, s81, 65536
    buffer_load_dwordx4 v16, s[60:63], s78 offen  lds
    buffer_load_dwordx4 v17, s[60:63], s78 offen offset:1024  lds
    s_add_u32 m0, s77, 106496
    s_add_u32 s78, s81, 131072
    buffer_load_dwordx4 v16, s[60:63], s78 offen  lds
    buffer_load_dwordx4 v17, s[60:63], s78 offen offset:1024  lds
    s_add_u32 m0, s77, 139264
    s_add_u32 s78, s81, 196608
    buffer_load_dwordx4 v16, s[60:63], s78 offen  lds
    buffer_load_dwordx4 v17, s[60:63], s78 offen offset:1024  lds
    s_add_u32 m0, s77, 147456
    s_add_u32 s78, s81, 262144
    buffer_load_dwordx4 v16, s[60:63], s78 offen  lds
    buffer_load_dwordx4 v17, s[60:63], s78 offen offset:1024  lds
    s_add_u32 s76, s71, 12288
    s_mov_b64 exec, 15
    s_waitcnt vmcnt(8)
    v_cmp_ne_u32 vcc, v13, v204
    s_cbranch_vccz Lc_3043
Lp_3044:
    buffer_load_dword v204, v15, s[64:67], s76 offen sc1
    s_sub_u32 s37, s37, 1
    s_cbranch_scc1 L_end
    s_waitcnt vmcnt(0)
    v_cmp_ne_u32 vcc, v13, v204
    s_cbranch_vccnz Lp_3044
Lc_3043:
Lc_3042:
    s_mov_b64 exec, -1
    s_barrier
    s_add_u32 s76, s71, 8192
    s_mov_b64 exec, 15
    buffer_load_dword v208, v18, s[64:67], s76 offen sc1
    s_mov_b64 exec, -1
    s_add_u32 m0, s77, 155648
    s_add_u32 s78, s81, 327680
    buffer_load_dwordx4 v16, s[60:63], s78 offen  lds
    buffer_load_dwordx4 v17, s[60:63], s78 offen offset:1024  lds
    s_barrier
    s_add_u32 m0, s77, 8192
    s_add_u32 s78, s81, 393216
    buffer_load_dwordx4 v16, s[60:63], s78 offen  lds
    buffer_load_dwordx4 v17, s[60:63], s78 offen offset:1024  lds
    s_add_u32 s76, s71, 8192
    s_mov_b64 exec, 15
    s_waitcnt vmcnt(4)
    v_cmp_ne_u32 vcc, v13, v208
    s_cbranch_vccz Lc_3046
Lp_3047:
    buffer_load_dword v208, v18, s[64:67], s76 offen sc1
    s_sub_u32 s37, s37, 1
    s_cbranch_scc1 L_end
    s_waitcnt vmcnt(0)
    v_cmp_ne_u32 vcc, v13, v208
    s_cbranch_vccnz Lp_3047
Lc_3046:
Lc_3045:
    s_mov_b64 exec, -1
    s_barrier
    s_add_u32 m0, s77, 16384
    s_add_u32 s78, s81, 458752
    buffer_load_dwordx4 v16, s[60:63], s78 offen  lds
    buffer_load_dwordx4 v17, s[60:63], s78 offen offset:1024  lds
    s_barrier
    s_add_u32 s76, s71, 4096
    s_mov_b64 exec, 15
    buffer_load_dword v212, v18, s[64:67], s76 offen sc1
    s_mov_b64 exec, -1
    s_add_u32 s76, s71, 4096
    s_mov_b64 exec, 15
    s_waitcnt vmcnt(0)
    v_cmp_ne_u32 vcc, v13, v212
    s_cbranch_vccz Lc_3049
Lp_3050:
    buffer_load_dword v212, v18, s[64:67], s76 offen sc1
    s_sub_u32 s37, s37, 1
    s_cbranch_scc1 L_end
    s_waitcnt vmcnt(0)
    v_cmp_ne_u32 vcc, v13, v212
    s_cbranch_vccnz Lp_3050
Lc_3049:
Lc_3048:
    s_mov_b64 exec, -1
    s_barrier
    s_add_u32 s76, s83, 14336
    s_mov_b64 exec, 15
    buffer_load_dword v216, v14, s[64:67], s76 offen sc1
    s_mov_b64 exec, -1
    s_add_u32 s76, s83, 14336
    s_mov_b64 exec, 15
    s_waitcnt vmcnt(0)
    v_cmp_ne_u32 vcc, v13, v216
    s_cbranch_vccz Lc_3052
Lp_3053:
    buffer_load_dword v216, v14, s[64:67], s76 offen sc1
    s_sub_u32 s37, s37, 1
    s_cbranch_scc1 L_end
    s_waitcnt vmcnt(0)
    v_cmp_ne_u32 vcc, v13, v216
    s_cbranch_vccnz Lp_3053
Lc_3052:
Lc_3051:
    s_mov_b64 exec, -1
    s_barrier
    s_endpgm
L_loadF:
    s_add_u32 s84, s36, 0
    s_and_b32 s84, s84, 7
    s_mul_i32 s84, s84, 229376
    s_add_u32 s84, s84, s80
    s_add_u32 m0, s77, 139264
    s_add_u32 s78, s84, 0
    buffer_load_dwordx4 v6, s[48:51], s78 offen  lds
    buffer_load_dwordx4 v7, s[48:51], s78 offen offset:1024  lds
    s_and_b32 s76, s4, 7
    s_mul_i32 s76, s76, 229376
    s_add_u32 s76, s76, s80
    s_mov_b32 exec_lo, 0x01010101
    s_mov_b32 exec_hi, 0x01010101
    buffer_load_dword v140, v6, s[48:51], s76 offen offset:0
    buffer_load_dword v141, v7, s[48:51], s76 offen offset:1024
    s_mov_b64 exec, -1
    s_waitcnt vmcnt(10)
    s_barrier
    s_lshl_b32 s76, s4, 2
    s_sub_u32 s76, s76, s3
    s_mul_i32 s76, s76, 28672
    s_mov_b32 exec_lo, 0x01010101
    s_mov_b32 exec_hi, 0x01010101
    s_add_u32 s76, s76, s80
    v_add_u32 v29, s76, v6
    buffer_load_dword v142, v29, s[52:55], 0 offen offset:0
    s_mov_b64 exec, -1
    s_add_u32 s84, s36, 1
    s_and_b32 s84, s84, 7
    s_mul_i32 s84, s84, 229376
    s_add_u32 s84, s84, s80
    s_add_u32 m0, s77, 147456
    s_add_u32 s78, s84, 0
    buffer_load_dwordx4 v6, s[48:51], s78 offen  lds
    buffer_load_dwordx4 v7, s[48:51], s78 offen offset:1024  lds
    s_add_u32 s84, s36, 2
    s_and_b32 s84, s84, 7
    s_mul_i32 s84, s84, 229376
    s_add_u32 s84, s84, s80
    s_add_u32 m0, s77, 155648
    s_add_u32 s78, s84, 0
    buffer_load_dwordx4 v6, s[48:51], s78 offen  lds
    buffer_load_dwordx4 v7, s[48:51], s78 offen offset:1024  lds
    s_add_u32 s84, s36, 3
    s_and_b32 s84, s84, 7
    s_mul_i32 s84, s84, 229376
    s_add_u32 s84, s84, s80
    s_add_u32 m0, s77, 0
    s_add_u32 s78, s84, 0
    buffer_load_dwordx4 v6, s[48:51], s78 offen  lds
    buffer_load_dwordx4 v7, s[48:51], s78 offen offset:1024  lds
    s_waitcnt vmcnt(11)
    s_barrier
    s_add_u32 s84, s36, 4
    s_and_b32 s84, s84, 7
    s_mul_i32 s84, s84, 229376
    s_add_u32 s84, s84, s80
    s_add_u32 m0, s77, 8192
    s_add_u32 s78, s84, 0
    buffer_load_dwordx4 v6, s[48:51], s78 offen  lds
    buffer_load_dwordx4 v7, s[48:51], s78 offen offset:1024  lds
    s_add_u32 s84, s36, 5
    s_and_b32 s84, s84, 7
    s_mul_i32 s84, s84, 229376
    s_add_u32 s84, s84, s80
    s_add_u32 m0, s77, 16384
    s_add_u32 s78, s84, 0
    buffer_load_dwordx4 v6, s[48:51], s78 offen  lds
    buffer_load_dwordx4 v7, s[48:51], s78 offen offset:1024  lds
    s_add_u32 s84, s36, 6
    s_and_b32 s84, s84, 7
    s_mul_i32 s84, s84, 229376
    s_add_u32 s84, s84, s80
    s_add_u32 m0, s77, 24576
    s_add_u32 s78, s84, 0
    buffer_load_dwordx4 v6, s[48:51], s78 offen  lds
    buffer_load_dwordx4 v7, s[48:51], s78 offen offset:1024  lds
    s_waitcnt vmcnt(10)
    s_barrier
    s_add_u32 s84, s36, 7
    s_and_b32 s84, s84, 7
    s_mul_i32 s84, s84, 229376
    s_add_u32 s84, s84, s80
    s_add_u32 m0, s77, 32768
    s_add_u32 s78, s84, 0
    buffer_load_dwordx4 v6, s[48:51], s78 offen  lds
    buffer_load_dwordx4 v7, s[48:51], s78 offen offset:1024  lds
    s_add_u32 s84, s36, 0
    s_and_b32 s84, s84, 7
    s_mul_i32 s84, s84, 229376
    s_add_u32 s84, s84, s80
    s_add_u32 m0, s77, 40960
    s_add_u32 s78, s84, 0
    buffer_load_dwordx4 v6, s[52:55], s78 offen  lds
    buffer_load_dwordx4 v7, s[52:55], s78 offen offset:1024  lds
    s_add_u32 s84, s36, 1
    s_and_b32 s84, s84, 7
    s_mul_i32 s84, s84, 229376
    s_add_u32 s84, s84, s80
    s_add_u32 m0, s77, 49152
    s_add_u32 s78, s84, 0
    buffer_load_dwordx4 v6, s[52:55], s78 offen  lds
    buffer_load_dwordx4 v7, s[52:55], s78 offen offset:1024  lds
    s_add_u32 s84, s36, 2
    s_and_b32 s84, s84, 7
    s_mul_i32 s84, s84, 229376
    s_add_u32 s84, s84, s80
    s_add_u32 m0, s77, 57344
    s_add_u32 s78, s84, 0
    buffer_load_dwordx4 v6, s[52:55], s78 offen  lds
    buffer_load_dwordx4 v7, s[52:55], s78 offen offset:1024  lds
    s_waitcnt vmcnt(12)
    s_barrier
    s_add_u32 s84, s36, 3
    s_and_b32 s84, s84, 7
    s_mul_i32 s84, s84, 229376
    s_add_u32 s84, s84, s80
    s_add_u32 m0, s77, 65536
    s_add_u32 s78, s84, 0
    buffer_load_dwordx4 v6, s[52:55], s78 offen  lds
    buffer_load_dwordx4 v7, s[52:55], s78 offen offset:1024  lds
    s_add_u32 s84, s36, 4
    s_and_b32 s84, s84, 7
    s_mul_i32 s84, s84, 229376
    s_add_u32 s84, s84, s80
    s_add_u32 m0, s77, 73728
    s_add_u32 s78, s84, 0
    buffer_load_dwordx4 v6, s[52:55], s78 offen  lds
    buffer_load_dwordx4 v7, s[52:55], s78 offen offset:1024  lds
    s_add_u32 s84, s36, 5
    s_and_b32 s84, s84, 7
    s_mul_i32 s84, s84, 229376
    s_add_u32 s84, s84, s80
    s_add_u32 m0, s77, 81920
    s_add_u32 s78, s84, 0
    buffer_load_dwordx4 v6, s[52:55], s78 offen  lds
    buffer_load_dwordx4 v7, s[52:55], s78 offen offset:1024  lds
    s_add_u32 s84, s36, 6
    s_and_b32 s84, s84, 7
    s_mul_i32 s84, s84, 229376
    s_add_u32 s84, s84, s80
    s_add_u32 m0, s77, 90112
    s_add_u32 s78, s84, 0
    buffer_load_dwordx4 v6, s[52:55], s78 offen  lds
    buffer_load_dwordx4 v7, s[52:55], s78 offen offset:1024  lds
    s_add_u32 s84, s36, 7
    s_and_b32 s84, s84, 7
    s_mul_i32 s84, s84, 229376
    s_add_u32 s84, s84, s80
    s_add_u32 m0, s77, 98304
    s_add_u32 s78, s84, 0
    buffer_load_dwordx4 v6, s[52:55], s78 offen  lds
    buffer_load_dwordx4 v7, s[52:55], s78 offen offset:1024  lds
    s_lshl_b32 s79, s5, 6
    s_add_u32 s84, s36, 0
    s_and_b32 s84, s84, 7
    s_mul_i32 s84, s84, 229376
    s_add_u32 s84, s84, s79
    s_add_u32 m0, s77, 106496
    s_add_u32 s78, s84, 3072
    buffer_load_dwordx4 v10, s[48:51], s78 offen  lds
    buffer_load_dwordx4 v11, s[48:51], s78 offen offset:1024  lds
    s_waitcnt vmcnt(14)
    s_barrier
    s_lshl_b32 s76, s4, 2
    s_sub_u32 s76, s76, s3
    s_mul_i32 s76, s76, 28672
    s_mov_b32 exec_lo, 0x01010101
    s_mov_b32 exec_hi, 0x01010101
    s_lshr_b32 s84, s5, 1
    s_lshl_b32 s84, s84, 7
    s_add_u32 s76, s76, s84
    v_add_u32 v29, s76, v6
    buffer_load_dword v143, v29, s[48:51], 0 offen offset:3072
    buffer_load_dword v144, v29, s[52:55], 0 offen offset:3072
    s_mov_b64 exec, -1
    s_add_u32 s84, s36, 2
    s_and_b32 s84, s84, 7
    s_mul_i32 s84, s84, 229376
    s_add_u32 s84, s84, s79
    s_add_u32 m0, s77, 114688
    s_add_u32 s78, s84, 3072
    buffer_load_dwordx4 v10, s[48:51], s78 offen  lds
    buffer_load_dwordx4 v11, s[48:51], s78 offen offset:1024  lds
    s_add_u32 s84, s36, 4
    s_and_b32 s84, s84, 7
    s_mul_i32 s84, s84, 229376
    s_add_u32 s84, s84, s79
    s_add_u32 m0, s77, 122880
    s_add_u32 s78, s84, 3072
    buffer_load_dwordx4 v10, s[48:51], s78 offen  lds
    buffer_load_dwordx4 v11, s[48:51], s78 offen offset:1024  lds
    s_lshl_b32 s76, s4, 2
    s_sub_u32 s76, s76, s3
    s_mul_i32 s76, s76, 28672
    s_mov_b32 exec_lo, 0x01010101
    s_mov_b32 exec_hi, 0x01010101
    s_add_u32 s76, s76, s0
    v_add_u32 v29, s76, v6
    buffer_load_dword v145, v29, s[48:51], 0 offen offset:1024
    s_mov_b64 exec, -1
    s_and_b32 s76, s4, 7
    s_mul_i32 s76, s76, 229376
    s_add_u32 s76, s76, s0
    s_mov_b32 exec_lo, 0x01010101
    s_mov_b32 exec_hi, 0x01010101
    buffer_load_dword v146, v6, s[52:55], s76 offen offset:1024
    buffer_load_dword v147, v7, s[52:55], s76 offen offset:2048
    s_mov_b64 exec, -1
    s_mul_i32 s76, s86, 1792
    s_mov_b64 exec, 0x3fff
    buffer_load_dword v148, v28, s[56:59], s76 offen
    s_mul_i32 s76, s86, 512
    s_mov_b64 exec, 0xf
    buffer_load_dword v149, v28, s[60:63], s76 offen
    s_mov_b64 exec, -1
    s_waitcnt vmcnt(17)
    s_barrier
    s_add_u32 s84, s36, 6
    s_and_b32 s84, s84, 7
    s_mul_i32 s84, s84, 229376
    s_add_u32 s84, s84, s79
    s_add_u32 m0, s77, 131072
    s_add_u32 s78, s84, 3072
    buffer_load_dwordx4 v10, s[48:51], s78 offen  lds
    buffer_load_dwordx4 v11, s[48:51], s78 offen offset:1024  lds
    buffer_load_dword v13, off, s[72:75], 0 sc1
    s_waitcnt vmcnt(14)
    s_barrier
    s_add_u32 s84, s36, 0
    s_and_b32 s84, s84, 7
    s_mul_i32 s84, s84, 229376
    s_add_u32 s84, s84, s79
    s_add_u32 m0, s77, 139264
    s_add_u32 s78, s84, 3072
    buffer_load_dwordx4 v10, s[52:55], s78 offen  lds
    buffer_load_dwordx4 v11, s[52:55], s78 offen offset:1024  lds
    s_add_u32 s84, s36, 2
    s_and_b32 s84, s84, 7
    s_mul_i32 s84, s84, 229376
    s_add_u32 s84, s84, s79
    s_add_u32 m0, s77, 147456
    s_add_u32 s78, s84, 3072
    buffer_load_dwordx4 v10, s[52:55], s78 offen  lds
    buffer_load_dwordx4 v11, s[52:55], s78 offen offset:1024  lds
    s_add_u32 s84, s36, 4
    s_and_b32 s84, s84, 7
    s_mul_i32 s84, s84, 229376
    s_add_u32 s84, s84, s79
    s_add_u32 m0, s77, 155648
    s_add_u32 s78, s84, 3072
    buffer_load_dwordx4 v10, s[52:55], s78 offen  lds
    buffer_load_dwordx4 v11, s[52:55], s78 offen offset:1024  lds
    s_add_u32 s84, s36, 6
    s_and_b32 s84, s84, 7
    s_mul_i32 s84, s84, 229376
    s_add_u32 s84, s84, s79
    s_add_u32 m0, s77, 0
    s_add_u32 s78, s84, 3072
    buffer_load_dwordx4 v10, s[52:55], s78 offen  lds
    buffer_load_dwordx4 v11, s[52:55], s78 offen offset:1024  lds
    s_add_u32 s84, s36, 0
    s_and_b32 s84, s84, 7
    s_mul_i32 s84, s84, 229376
    s_add_u32 s84, s84, s0
    s_add_u32 m0, s77, 8192
    s_add_u32 s78, s84, 1024
    buffer_load_dwordx4 v6, s[48:51], s78 offen  lds
    buffer_load_dwordx4 v7, s[48:51], s78 offen offset:1024  lds
    s_add_u32 s84, s36, 1
    s_and_b32 s84, s84, 7
    s_mul_i32 s84, s84, 229376
    s_add_u32 s84, s84, s0
    s_add_u32 m0, s77, 16384
    s_add_u32 s78, s84, 1024
    buffer_load_dwordx4 v6, s[48:51], s78 offen  lds
    buffer_load_dwordx4 v7, s[48:51], s78 offen offset:1024  lds
    s_waitcnt vmcnt(10)
    s_barrier
    s_add_u32 s84, s36, 2
    s_and_b32 s84, s84, 7
    s_mul_i32 s84, s84, 229376
    s_add_u32 s84, s84, s0
    s_add_u32 m0, s77, 24576
    s_add_u32 s78, s84, 1024
    buffer_load_dwordx4 v6, s[48:51], s78 offen  lds
    buffer_load_dwordx4 v7, s[48:51], s78 offen offset:1024  lds
    s_add_u32 s84, s36, 3
    s_and_b32 s84, s84, 7
    s_mul_i32 s84, s84, 229376
    s_add_u32 s84, s84, s0
    s_add_u32 m0, s77, 32768
    s_add_u32 s78, s84, 1024
    buffer_load_dwordx4 v6, s[48:51], s78 offen  lds
    buffer_load_dwordx4 v7, s[48:51], s78 offen offset:1024  lds
    s_add_u32 s84, s36, 4
    s_and_b32 s84, s84, 7
    s_mul_i32 s84, s84, 229376
    s_add_u32 s84, s84, s0
    s_add_u32 m0, s77, 40960
    s_add_u32 s78, s84, 1024
    buffer_load_dwordx4 v6, s[48:51], s78 offen  lds
    buffer_load_dwordx4 v7, s[48:51], s78 offen offset:1024  lds
    s_add_u32 s84, s36, 5
    s_and_b32 s84, s84, 7
    s_mul_i32 s84, s84, 229376
    s_add_u32 s84, s84, s0
    s_add_u32 m0, s77, 49152
    s_add_u32 s78, s84, 1024
    buffer_load_dwordx4 v6, s[48:51], s78 offen  lds
    buffer_load_dwordx4 v7, s[48:51], s78 offen offset:1024  lds
    s_add_u32 s84, s36, 6
    s_and_b32 s84, s84, 7
    s_mul_i32 s84, s84, 229376
    s_add_u32 s84, s84, s0
    s_add_u32 m0, s77, 57344
    s_add_u32 s78, s84, 1024
    buffer_load_dwordx4 v6, s[48:51], s78 offen  lds
    buffer_load_dwordx4 v7, s[48:51], s78 offen offset:1024  lds
    s_add_u32 s84, s36, 7
    s_and_b32 s84, s84, 7
    s_mul_i32 s84, s84, 229376
    s_add_u32 s84, s84, s0
    s_add_u32 m0, s77, 65536
    s_add_u32 s78, s84, 1024
    buffer_load_dwordx4 v6, s[48:51], s78 offen  lds
    buffer_load_dwordx4 v7, s[48:51], s78 offen offset:1024  lds
    s_add_u32 s84, s36, 0
    s_and_b32 s84, s84, 7
    s_mul_i32 s84, s84, 229376
    s_add_u32 s84, s84, s0
    s_add_u32 m0, s77, 73728
    s_add_u32 s78, s84, 1024
    buffer_load_dwordx4 v6, s[52:55], s78 offen  lds
    buffer_load_dwordx4 v7, s[52:55], s78 offen offset:1024  lds
    s_add_u32 s84, s36, 1
    s_and_b32 s84, s84, 7
    s_mul_i32 s84, s84, 229376
    s_add_u32 s84, s84, s0
    s_add_u32 m0, s77, 81920
    s_add_u32 s78, s84, 1024
    buffer_load_dwordx4 v6, s[52:55], s78 offen  lds
    buffer_load_dwordx4 v7, s[52:55], s78 offen offset:1024  lds
    s_waitcnt vmcnt(16)
    s_barrier
    s_add_u32 s84, s36, 2
    s_and_b32 s84, s84, 7
    s_mul_i32 s84, s84, 229376
    s_add_u32 s84, s84, s0
    s_add_u32 m0, s77, 90112
    s_add_u32 s78, s84, 1024
    buffer_load_dwordx4 v6, s[52:55], s78 offen  lds
    buffer_load_dwordx4 v7, s[52:55], s78 offen offset:1024  lds
    s_add_u32 s84, s36, 3
    s_and_b32 s84, s84, 7
    s_mul_i32 s84, s84, 229376
    s_add_u32 s84, s84, s0
    s_add_u32 m0, s77, 98304
    s_add_u32 s78, s84, 1024
    buffer_load_dwordx4 v6, s[52:55], s78 offen  lds
    buffer_load_dwordx4 v7, s[52:55], s78 offen offset:1024  lds
    s_add_u32 s84, s36, 4
    s_and_b32 s84, s84, 7
    s_mul_i32 s84, s84, 229376
    s_add_u32 s84, s84, s0
    s_add_u32 m0, s77, 106496
    s_add_u32 s78, s84, 1024
    buffer_load_dwordx4 v6, s[52:55], s78 offen  lds
    buffer_load_dwordx4 v7, s[52:55], s78 offen offset:1024  lds
    s_add_u32 s84, s36, 5
    s_and_b32 s84, s84, 7
    s_mul_i32 s84, s84, 229376
    s_add_u32 s84, s84, s0
    s_add_u32 m0, s77, 114688
    s_add_u32 s78, s84, 1024
    buffer_load_dwordx4 v6, s[52:55], s78 offen  lds
    buffer_load_dwordx4 v7, s[52:55], s78 offen offset:1024  lds
    s_add_u32 s84, s36, 6
    s_and_b32 s84, s84, 7
    s_mul_i32 s84, s84, 229376
    s_add_u32 s84, s84, s0
    s_add_u32 m0, s77, 122880
    s_add_u32 s78, s84, 1024
    buffer_load_dwordx4 v6, s[52:55], s78 offen  lds
    buffer_load_dwordx4 v7, s[52:55], s78 offen offset:1024  lds
    s_add_u32 s84, s36, 7
    s_and_b32 s84, s84, 7
    s_mul_i32 s84, s84, 229376
    s_add_u32 s84, s84, s0
    s_add_u32 m0, s77, 131072
    s_add_u32 s78, s84, 1024
    buffer_load_dwordx4 v6, s[52:55], s78 offen  lds
    buffer_load_dwordx4 v7, s[52:55], s78 offen offset:1024  lds
    v_cmp_eq_u32 vcc, 0, v13
    s_cbranch_vccz Lc_4001
Lp_4002:
    buffer_load_dword v13, off, s[72:75], 0 sc1
    s_sub_u32 s37, s37, 1
    s_cbranch_scc1 L_end
    s_waitcnt vmcnt(0)
    v_cmp_eq_u32 vcc, 0, v13
    s_cbranch_vccnz Lp_4002
Lc_4001:
    s_mul_i32 s76, s87, 14336
    s_mov_b64 exec, 0x3fff
    buffer_load_dword v150, v30, s[56:59], s76 offen offset:384
    s_mul_i32 s76, s87, 4096
    s_mov_b64 exec, 0xf
    buffer_load_dword v151, v30, s[60:63], s76 offen offset:384
    s_mov_b64 exec, -1
    s_waitcnt vmcnt(22)
    s_barrier
    s_add_u32 m0, s77, 139264
    s_add_u32 s78, s69, 0
    buffer_load_dwordx4 v16, s[56:59], s78 offen  lds
    buffer_load_dwordx4 v17, s[56:59], s78 offen offset:1024  lds
    s_add_u32 m0, s77, 147456
    s_add_u32 s78, s69, 131072
    buffer_load_dwordx4 v16, s[56:59], s78 offen  lds
    buffer_load_dwordx4 v17, s[56:59], s78 offen offset:1024  lds
    s_add_u32 m0, s77, 155648
    s_add_u32 s78, s69, 262144
    buffer_load_dwordx4 v16, s[56:59], s78 offen  lds
    buffer_load_dwordx4 v17, s[56:59], s78 offen offset:1024  lds
    s_waitcnt vmcnt(20)
    s_barrier
    s_add_u32 m0, s77, 0
    s_add_u32 s78, s69, 393216
    buffer_load_dwordx4 v16, s[56:59], s78 offen  lds
    buffer_load_dwordx4 v17, s[56:59], s78 offen offset:1024  lds
    s_add_u32 m0, s77, 8192
    s_add_u32 s78, s69, 1572864
    buffer_load_dwordx4 v16, s[56:59], s78 offen  lds
    buffer_load_dwordx4 v17, s[56:59], s78 offen offset:1024  lds
    s_add_u32 m0, s77, 16384
    s_add_u32 s78, s69, 1703936
    buffer_load_dwordx4 v16, s[56:59], s78 offen  lds
    buffer_load_dwordx4 v17, s[56:59], s78 offen offset:1024  lds
    s_add_u32 m0, s77, 24576
    s_add_u32 s78, s69, 1048576
    buffer_load_dwordx4 v16, s[56:59], s78 offen  lds
    buffer_load_dwordx4 v17, s[56:59], s78 offen offset:1024  lds
    s_add_u32 s76, s71, 0
    s_mov_b64 exec, 15
    buffer_load_dword v200, v18, s[64:67], s76 offen sc1
    s_mov_b64 exec, -1
    s_waitcnt vmcnt(21)
    s_barrier
    s_add_u32 m0, s77, 32768
    s_add_u32 s78, s69, 1179648
    buffer_load_dwordx4 v16, s[56:59], s78 offen  lds
    buffer_load_dwordx4 v17, s[56:59], s78 offen offset:1024  lds
    s_add_u32 m0, s77, 40960
    s_add_u32 s78, s69, 1310720
    buffer_load_dwordx4 v16, s[56:59], s78 offen  lds
    buffer_load_dwordx4 v17, s[56:59], s78 offen offset:1024  lds
    s_add_u32 m0, s77, 49152
    s_add_u32 s78, s69, 1441792
    buffer_load_dwordx4 v16, s[56:59], s78 offen  lds
    buffer_load_dwordx4 v17, s[56:59], s78 offen offset:1024  lds
    s_add_u32 m0, s77, 57344
    s_add_u32 s78, s69, 524288
    buffer_load_dwordx4 v16, s[56:59], s78 offen  lds
    buffer_load_dwordx4 v17, s[56:59], s78 offen offset:1024  lds
    s_add_u32 m0, s77, 65536
    s_add_u32 s78, s69, 655360
    buffer_load_dwordx4 v16, s[56:59], s78 offen  lds
    buffer_load_dwordx4 v17, s[56:59], s78 offen offset:1024  lds
    s_add_u32 s76, s71, 0
    s_mov_b64 exec, 15
    s_waitcnt vmcnt(10)
    v_cmp_ne_u32 vcc, v13, v200
    s_cbranch_vccz Lc_4004
Lp_4005:
    buffer_load_dword v200, v18, s[64:67], s76 offen sc1
    s_sub_u32 s37, s37, 1
    s_cbranch_scc1 L_end
    s_waitcnt vmcnt(0)
    v_cmp_ne_u32 vcc, v13, v200
    s_cbranch_vccnz Lp_4005
Lc_4004:
Lc_4003:
    s_mov_b64 exec, -1
    s_barrier
    s_add_u32 m0, s77, 73728
    s_add_u32 s78, s69, 786432
    buffer_load_dwordx4 v16, s[56:59], s78 offen  lds
    buffer_load_dwordx4 v17, s[56:59], s78 offen offset:1024  lds
    s_add_u32 m0, s77, 81920
    s_add_u32 s78, s69, 917504
    buffer_load_dwordx4 v16, s[56:59], s78 offen  lds
    buffer_load_dwordx4 v17, s[56:59], s78 offen offset:1024  lds
    s_add_u32 m0, s77, 90112
    s_add_u32 s78, s81, 0
    buffer_load_dwordx4 v16, s[60:63], s78 offen  lds
    buffer_load_dwordx4 v17, s[60:63], s78 offen offset:1024  lds
    s_add_u32 m0, s77, 98304
    s_add_u32 s78, s81, 65536
    buffer_load_dwordx4 v16, s[60:63], s78 offen  lds
    buffer_load_dwordx4 v17, s[60:63], s78 offen offset:1024  lds
    s_add_u32 s76, s71, 12288
    s_mov_b64 exec, 15
    buffer_load_dword v204, v15, s[64:67], s76 offen sc1
    s_mov_b64 exec, -1
    s_barrier
    s_add_u32 s76, s71, 12288
    s_mov_b64 exec, 15
    s_waitcnt vmcnt(0)
    v_cmp_ne_u32 vcc, v13, v204
    s_cbranch_vccz Lc_4007
Lp_4008:
    buffer_load_dword v204, v15, s[64:67], s76 offen sc1
    s_sub_u32 s37, s37, 1
    s_cbranch_scc1 L_end
    s_waitcnt vmcnt(0)
    v_cmp_ne_u32 vcc, v13, v204
    s_cbranch_vccnz Lp_4008
Lc_4007:
Lc_4006:
    s_mov_b64 exec, -1
    s_barrier
    s_add_u32 s76, s71, 8192
    s_mov_b64 exec, 15
    buffer_load_dword v208, v18, s[64:67], s76 offen sc1
    s_mov_b64 exec, -1
    s_add_u32 m0, s77, 106496
    s_add_u32 s78, s81, 131072
    buffer_load_dwordx4 v16, s[60:63], s78 offen  lds
    buffer_load_dwordx4 v17, s[60:63], s78 offen offset:1024  lds
    s_add_u32 m0, s77, 114688
    s_add_u32 s78, s81, 196608
    buffer_load_dwordx4 v16, s[60:63], s78 offen  lds
    buffer_load_dwordx4 v17, s[60:63], s78 offen offset:1024  lds
    s_add_u32 m0, s77, 122880
    s_add_u32 s78, s81, 262144
    buffer_load_dwordx4 v16, s[60:63], s78 offen  lds
    buffer_load_dwordx4 v17, s[60:63], s78 offen offset:1024  lds
    s_add_u32 m0, s77, 131072
    s_add_u32 s78, s81, 327680
    buffer_load_dwordx4 v16, s[60:63], s78 offen  lds
    buffer_load_dwordx4 v17, s[60:63], s78 offen offset:1024  lds
    s_add_u32 m0, s77, 139264
    s_add_u32 s78, s81, 393216
    buffer_load_dwordx4 v16, s[60:63], s78 offen  lds
    buffer_load_dwordx4 v17, s[60:63], s78 offen offset:1024  lds
    s_barrier
    s_add_u32 m0, s77, 147456
    s_add_u32 s78, s81, 458752
    buffer_load_dwordx4 v16, s[60:63], s78 offen  lds
    buffer_load_dwordx4 v17, s[60:63], s78 offen offset:1024  lds
    s_add_u32 s76, s71, 8192
    s_mov_b64 exec, 15
    s_waitcnt vmcnt(12)
    v_cmp_ne_u32 vcc, v13, v208
    s_cbranch_vccz Lc_4010
Lp_4011:
    buffer_load_dword v208, v18, s[64:67], s76 offen sc1
    s_sub_u32 s37, s37, 1
    s_cbranch_scc1 L_end
    s_waitcnt vmcnt(0)
    v_cmp_ne_u32 vcc, v13, v208
    s_cbranch_vccnz Lp_4011
Lc_4010:
Lc_4009:
    s_mov_b64 exec, -1
    s_barrier
    s_barrier
    s_add_u32 s76, s71, 4096
    s_mov_b64 exec, 15
    buffer_load_dword v212, v18, s[64:67], s76 offen sc1
    s_mov_b64 exec, -1
    s_add_u32 s76, s71, 4096
    s_mov_b64 exec, 15
    s_waitcnt vmcnt(0)
    v_cmp_ne_u32 vcc, v13, v212
    s_cbranch_vccz Lc_4013
Lp_4014:
    buffer_load_dword v212, v18, s[64:67], s76 offen sc1
    s_sub_u32 s37, s37, 1
    s_cbranch_scc1 L_end
    s_waitcnt vmcnt(0)
    v_cmp_ne_u32 vcc, v13, v212
    s_cbranch_vccnz Lp_4014
Lc_4013:
Lc_4012:
    s_mov_b64 exec, -1
    s_barrier
    s_add_u32 s76, s83, 14336
    s_mov_b64 exec, 15
    buffer_load_dword v216, v14, s[64:67], s76 offen sc1
    s_mov_b64 exec, -1
    s_add_u32 s76, s83, 14336
    s_mov_b64 exec, 15
    s_waitcnt vmcnt(0)
    v_cmp_ne_u32 vcc, v13, v216
    s_cbranch_vccz Lc_4016
Lp_4017:
    buffer_load_dword v216, v14, s[64:67], s76 offen sc1
    s_sub_u32 s37, s37, 1
    s_cbranch_scc1 L_end
    s_waitcnt vmcnt(0)
    v_cmp_ne_u32 vcc, v13, v216
    s_cbranch_vccnz Lp_4017
Lc_4016:
Lc_4015:
    s_mov_b64 exec, -1
    s_barrier
    s_endpgm
L_end:
    s_endpgm
    .p2align 12
L_compute:
    v_and_b32 v0, 63, v0
    s_setprio 1
    v_lshlrev_b32 v7, 4, v0
    v_and_b32 v12, 15, v0
    v_lshrrev_b32 v13, 4, v0
    v_lshrrev_b32 v14, 1, v12
    v_xor_b32 v14, v13, v14
    v_lshlrev_b32 v14, 4, v14
    v_lshl_add_u32 v14, v12, 7, v14
    s_lshl_b32 s81, s3, 11
    v_add_u32 v64, s81, v14
    v_xor_b32 v65, 64, v64
    v_mov_b32 v20, 0x3f803f80
    v_mov_b32 v21, 0x3f803f80
    v_mov_b32 v22, 0x3f803f80
    v_mov_b32 v23, 0x3f803f80
    v_and_b32 v14, 31, v0
    v_lshrrev_b32 v15, 5, v0
    v_lshlrev_b32 v15, 3, v15
    v_sub_u32 v15, v14, v15
    v_and_b32 v16, 1, v15
    v_lshlrev_b32 v16, 4, v16
    v_mov_b32 v17, 0x3f80
    v_lshlrev_b32 v16, v16, v17
    v_lshrrev_b32 v15, 1, v15
    v_cmp_eq_u32 vcc, 0, v15
    s_nop 1
    v_cndmask_b32 v56, 0, v16, vcc
    v_cmp_eq_u32 vcc, 1, v15
    s_nop 1
    v_cndmask_b32 v57, 0, v16, vcc
    v_cmp_eq_u32 vcc, 2, v15
    s_nop 1
    v_cndmask_b32 v58, 0, v16, vcc
    v_cmp_eq_u32 vcc, 3, v15
    s_nop 1
    v_cndmask_b32 v59, 0, v16, vcc
    v_cmp_eq_u32 vcc, 8, v15
    s_nop 1
    v_cndmask_b32 v60, 0, v16, vcc
    v_cmp_eq_u32 vcc, 9, v15
    s_nop 1
    v_cndmask_b32 v61, 0, v16, vcc
    v_cmp_eq_u32 vcc, 10, v15
    s_nop 1
    v_cndmask_b32 v62, 0, v16, vcc
    v_cmp_eq_u32 vcc, 11, v15
    s_nop 1
    v_cndmask_b32 v63, 0, v16, vcc
    s_waitcnt lgkmcnt(0)
    s_mov_b64 s[64:65], s[34:35]
    s_mov_b32 s66, 0x2000000
    s_mov_b32 s67, 0x20000
    s_mov_b64 s[68:69], s[30:31]
    s_mov_b32 s70, 0x200000
    s_mov_b32 s71, 0x20000
    s_mov_b64 s[72:73], s[32:33]
    s_mov_b32 s74, 0x100
    s_mov_b32 s75, 0x20000
    s_mov_b64 s[40:41], s[16:17]
    s_mov_b32 s42, 0x200000
    s_mov_b32 s43, 0x20000
    s_or_b32 s0, s2, s3
    s_cmp_lg_u32 s0, 0
    s_cbranch_scc1 L_tag0
    buffer_load_dword v10, off, s[64:67], 0 sc1
L_tag0:
    v_lshlrev_b32 v14, 2, v13
    v_sub_u32 v14, v12, v14
    v_cmp_eq_u32 s[88:89], 0, v14
    v_cmp_eq_u32 s[90:91], 1, v14
    v_cmp_eq_u32 s[92:93], 2, v14
    v_cmp_eq_u32 s[94:95], 3, v14
    s_mov_b32 s38, 0x40053526
    s_mov_b32 s76, 0x3f317218
    s_mov_b32 s39, 0xffff0000
    s_mov_b32 s77, 0x35c1a2a0
    s_mov_b32 s36, 0x3fb8aa3b
    v_lshrrev_b32 v15, 5, v0
    v_bfe_u32 v16, v0, 2, 2
    v_lshl_add_u32 v16, v15, 2, v16
    v_and_b32 v17, 1, v13
    v_lshl_add_u32 v16, v17, 3, v16
    v_and_b32 v18, 3, v0
    v_lshlrev_b32 v18, 3, v18
    v_lshl_add_u32 v19, v16, 6, v18
    v_lshl_add_u32 v5, v17, 5, v19
    v_xor_b32 v6, 32, v5
    v_lshl_add_u32 v19, v16, 7, v18
    v_bfe_u32 v18, v0, 3, 2
    v_lshl_add_u32 v1, v18, 5, v19
    v_xor_b32 v2, 32, v1
    v_xor_b32 v3, 64, v1
    v_xor_b32 v4, 96, v1
    v_lshlrev_b32 v18, 2, v0
    v_lshl_add_u32 v11, v15, 30, v18
    s_lshr_b32 s81, s3, 1
    s_lshl_b32 s78, s4, 1
    s_add_u32 s78, s78, s81
    s_mul_i32 s78, s78, 36
    s_add_u32 s78, s78, s5
    s_lshl_b32 s78, s78, 1
    s_and_b32 s81, s3, 1
    s_add_u32 s78, s78, s81
    s_lshl_b32 s79, s78, 8
    s_add_u32 s79, s79, 0x1000
    s_lshl_b32 s78, s78, 12
    s_add_u32 s78, s78, 0x200000
    s_xor_b32 s96, s5, 1
    s_sub_u32 s96, s96, s5
    s_lshl_b32 s97, s96, 13
    s_add_u32 s44, s78, s97
    s_lshl_b32 s97, s96, 9
    s_add_u32 s45, s79, s97
    s_xor_b32 s96, s5, 4
    s_sub_u32 s96, s96, s5
    s_lshl_b32 s97, s96, 13
    s_add_u32 s46, s78, s97
    s_lshl_b32 s97, s96, 9
    s_add_u32 s47, s79, s97
    s_mul_i32 s10, s6, 294912
    s_add_u32 s10, s10, 0x200000
    s_and_b32 s96, s6, 1
    s_lshl_b32 s96, s96, 13
    s_add_u32 s8, s10, s96
    s_xor_b32 s97, s6, 1
    s_mul_i32 s9, s97, 294912
    s_add_u32 s9, s9, 0x200000
    s_add_u32 s9, s9, s96
    s_lshl_b32 s11, s97, 3
    s_add_u32 s11, s11, s7
    s_lshl_b32 s11, s11, 2
    s_add_u32 s11, s11, s3
    s_lshl_b32 s11, s11, 12
    s_add_u32 s11, s11, 0xc00000
    s_lshl_b32 s12, s6, 3
    s_add_u32 s12, s12, s7
    s_lshl_b32 s12, s12, 2
    s_add_u32 s12, s12, s3
    s_lshl_b32 s12, s12, 12
    s_add_u32 s12, s12, 0xc00000
    s_lshl_b32 s99, s6, 2
    s_add_u32 s99, s99, s3
    s_lshl_b32 s99, s99, 14
    s_lshl_b32 s97, s7, 7
    s_add_u32 s99, s99, s97
    s_mov_b32 s82, 0xffff0000
    s_mov_b32 s83, 0
    s_mov_b32 s84, 0
    s_mov_b32 s85, 0xffff
    s_mov_b32 s86, 0
    s_mov_b32 s87, 0xffff0000
    s_lshl_b32 s80, s5, 2
    s_add_u32 s80, s80, s3
    s_lshl_b32 s80, s80, 6
    s_add_u32 s80, s80, s4
    s_mul_i32 s80, s80, 384
    s_add_u32 s80, s80, 0x100000
    s_mov_b32 s97, 98304
    s_mov_b32 s98, 106496
    s_cmp_lt_u32 s3, 2
    s_cselect_b32 s97, s97, s98
    s_and_b32 s98, s3, 1
    s_lshl_b32 s98, s98, 12
    s_add_u32 s97, s97, s98
    s_lshr_b32 s96, s5, 1
    s_sub_u32 s96, s96, s5
    s_add_u32 s96, s96, 24
    s_lshl_b32 s96, s96, 2
    s_and_b32 s98, s5, 1
    s_add_u32 s96, s96, s98
    s_lshl_b32 s100, s96, 11
    s_add_u32 s100, s100, s78
    s_lshl_b32 s101, s96, 7
    s_add_u32 s101, s101, s79
    s_cmp_ge_u32 s2, 128
    s_cbranch_scc1 L_tF
L_tA:
    s_cmp_lg_u32 s3, 0
    s_cbranch_scc1 L_tA1
    s_call_b64 s[30:31], L_pg652
    s_call_b64 s[30:31], L_pg2926
    s_branch L_tdone
L_tA1:
    s_cmp_lg_u32 s3, 1
    s_cbranch_scc1 L_tA2
    s_call_b64 s[30:31], L_pg1188
    s_call_b64 s[30:31], L_pg3483
    s_branch L_tdone
L_tA2:
    s_cmp_lg_u32 s3, 2
    s_cbranch_scc1 L_tA3
    s_call_b64 s[30:31], L_pg1761
    s_call_b64 s[30:31], L_pg3483
    s_branch L_tdone
L_tA3:
    s_call_b64 s[30:31], L_pg2335
    s_call_b64 s[30:31], L_pg3483
    s_branch L_tdone
L_tF:
    s_cmp_lg_u32 s3, 0
    s_cbranch_scc1 L_tF1
    s_call_b64 s[30:31], L_pg652
    s_call_b64 s[30:31], L_pg5173
    s_branch L_tdone
L_tF1:
    s_cmp_lg_u32 s3, 1
    s_cbranch_scc1 L_tF2
    s_call_b64 s[30:31], L_pg3813
    s_call_b64 s[30:31], L_pg5738
    s_branch L_tdone
L_tF2:
    s_cmp_lg_u32 s3, 2
    s_cbranch_scc1 L_tF3
    s_call_b64 s[30:31], L_pg4038
    s_call_b64 s[30:31], L_pg6307
    s_branch L_tdone
L_tF3:
    s_call_b64 s[30:31], L_pg4603
    s_call_b64 s[30:31], L_pg6307
L_tdone:
    s_barrier
    ds_read_b128 v[128:131], v64 offset:8192
    ds_read_b128 v[132:135], v65 offset:8192
    ds_read_b128 v[136:139], v64 offset:16384
    ds_read_b128 v[140:143], v65 offset:16384
    s_waitcnt lgkmcnt(3)
    v_mfma_f32_16x16x32_bf16 v[68:71], v[20:23], v[128:131], 0
    v_mfma_f32_16x16x32_bf16 v[72:75], v[128:131], v[128:131], 0
    s_waitcnt lgkmcnt(2)
    v_mfma_f32_16x16x32_bf16 v[68:71], v[20:23], v[132:135], v[68:71]
    v_mfma_f32_16x16x32_bf16 v[72:75], v[132:135], v[132:135], v[72:75]
    s_waitcnt lgkmcnt(1)
    v_mfma_f32_16x16x32_bf16 v[68:71], v[20:23], v[136:139], v[68:71]
    v_mfma_f32_16x16x32_bf16 v[72:75], v[136:139], v[136:139], v[72:75]
    s_waitcnt lgkmcnt(0)
    v_mfma_f32_16x16x32_bf16 v[68:71], v[20:23], v[140:143], v[68:71]
    v_mfma_f32_16x16x32_bf16 v[72:75], v[140:143], v[140:143], v[72:75]
    v_mfma_f32_32x32x16_bf16 v[208:223], v[56:59], v[128:131], 0
    v_mfma_f32_32x32x16_bf16 v[208:223], v[60:63], v[132:135], v[208:223]
    v_mfma_f32_32x32x16_bf16 v[224:239], v[56:59], v[136:139], 0
    v_mfma_f32_32x32x16_bf16 v[224:239], v[60:63], v[140:143], v[224:239]
    s_waitcnt vmcnt(0)
    s_cmp_lg_u32 s0, 0
    s_cbranch_scc1 L_tag1
    s_waitcnt vmcnt(0)
    v_add_u32 v10, 0x9e377902, v10
    v_or_b32 v10, 0x80000000, v10
    s_mov_b64 exec, 1
    buffer_store_dword v10, off, s[72:75], 0 sc1
    buffer_store_dword v10, off, s[64:67], 0 sc1
    s_mov_b64 exec, -1
L_tag1:
    s_barrier
    ds_read_b128 v[192:195], v64 offset:24576
    ds_read_b128 v[196:199], v65 offset:24576
    ds_read_b128 v[200:203], v64 offset:32768
    ds_read_b128 v[204:207], v65 offset:32768
    ds_read_b128 v[144:147], v64 offset:40960
    ds_read_b128 v[148:151], v65 offset:40960
    ds_read_b128 v[152:155], v64 offset:49152
    ds_read_b128 v[156:159], v65 offset:49152
    s_waitcnt lgkmcnt(7)
    v_mfma_f32_16x16x32_bf16 v[76:79], v[20:23], v[192:195], 0
    v_mfma_f32_16x16x32_bf16 v[80:83], v[192:195], v[192:195], 0
    s_waitcnt lgkmcnt(6)
    v_mfma_f32_16x16x32_bf16 v[76:79], v[20:23], v[196:199], v[76:79]
    v_mfma_f32_16x16x32_bf16 v[80:83], v[196:199], v[196:199], v[80:83]
    s_waitcnt lgkmcnt(5)
    v_mfma_f32_16x16x32_bf16 v[76:79], v[20:23], v[200:203], v[76:79]
    v_mfma_f32_16x16x32_bf16 v[80:83], v[200:203], v[200:203], v[80:83]
    s_waitcnt lgkmcnt(4)
    v_mfma_f32_16x16x32_bf16 v[76:79], v[20:23], v[204:207], v[76:79]
    v_mfma_f32_16x16x32_bf16 v[80:83], v[204:207], v[204:207], v[80:83]
    s_waitcnt lgkmcnt(3)
    v_mfma_f32_16x16x32_bf16 v[68:71], v[20:23], v[144:147], v[68:71]
    v_mfma_f32_16x16x32_bf16 v[72:75], v[144:147], v[144:147], v[72:75]
    s_waitcnt lgkmcnt(2)
    v_mfma_f32_16x16x32_bf16 v[68:71], v[20:23], v[148:151], v[68:71]
    v_mfma_f32_16x16x32_bf16 v[72:75], v[148:151], v[148:151], v[72:75]
    s_waitcnt lgkmcnt(1)
    v_mfma_f32_16x16x32_bf16 v[68:71], v[20:23], v[152:155], v[68:71]
    v_mfma_f32_16x16x32_bf16 v[72:75], v[152:155], v[152:155], v[72:75]
    s_waitcnt lgkmcnt(0)
    v_mfma_f32_16x16x32_bf16 v[68:71], v[20:23], v[156:159], v[68:71]
    v_mfma_f32_16x16x32_bf16 v[72:75], v[156:159], v[156:159], v[72:75]
    v_mfma_f32_32x32x16_bf16 v[240:255], v[56:59], v[144:147], 0
    v_mfma_f32_32x32x16_bf16 v[240:255], v[60:63], v[148:151], v[240:255]
    v_mfma_f32_32x32x16_bf16 v[24:39], v[56:59], v[152:155], 0
    v_mfma_f32_32x32x16_bf16 v[24:39], v[60:63], v[156:159], v[24:39]
    s_barrier
    ds_read_b128 v[160:163], v64 offset:57344
    ds_read_b128 v[164:167], v65 offset:57344
    v_add_u32 v64, 0x10000, v64
    ds_read_b128 v[168:171], v64 offset:0
    v_add_u32 v65, 0x10000, v65
    ds_read_b128 v[172:175], v65 offset:0
    s_waitcnt lgkmcnt(3)
    v_mfma_f32_16x16x32_bf16 v[68:71], v[20:23], v[160:163], v[68:71]
    v_mfma_f32_16x16x32_bf16 v[72:75], v[160:163], v[160:163], v[72:75]
    s_waitcnt lgkmcnt(2)
    v_mfma_f32_16x16x32_bf16 v[68:71], v[20:23], v[164:167], v[68:71]
    v_mfma_f32_16x16x32_bf16 v[72:75], v[164:167], v[164:167], v[72:75]
    s_waitcnt lgkmcnt(1)
    v_mfma_f32_16x16x32_bf16 v[68:71], v[20:23], v[168:171], v[68:71]
    v_mfma_f32_16x16x32_bf16 v[72:75], v[168:171], v[168:171], v[72:75]
    s_waitcnt lgkmcnt(0)
    v_mfma_f32_16x16x32_bf16 v[68:71], v[20:23], v[172:175], v[68:71]
    v_mfma_f32_16x16x32_bf16 v[72:75], v[172:175], v[172:175], v[72:75]
    v_mfma_f32_32x32x16_bf16 v[40:55], v[56:59], v[160:163], 0
    v_mfma_f32_32x32x16_bf16 v[40:55], v[60:63], v[164:167], v[40:55]
    s_barrier
    ds_read_b128 v[176:179], v64 offset:8192
    ds_read_b128 v[180:183], v65 offset:8192
    ds_read_b128 v[184:187], v64 offset:16384
    ds_read_b128 v[188:191], v65 offset:16384
    s_waitcnt lgkmcnt(3)
    v_mfma_f32_16x16x32_bf16 v[68:71], v[20:23], v[176:179], v[68:71]
    v_mfma_f32_16x16x32_bf16 v[72:75], v[176:179], v[176:179], v[72:75]
    s_waitcnt lgkmcnt(2)
    v_mfma_f32_16x16x32_bf16 v[68:71], v[20:23], v[180:183], v[68:71]
    v_mfma_f32_16x16x32_bf16 v[72:75], v[180:183], v[180:183], v[72:75]
    s_waitcnt lgkmcnt(1)
    v_mfma_f32_16x16x32_bf16 v[68:71], v[20:23], v[184:187], v[68:71]
    v_mfma_f32_16x16x32_bf16 v[72:75], v[184:187], v[184:187], v[72:75]
    s_waitcnt lgkmcnt(0)
    v_mfma_f32_16x16x32_bf16 v[68:71], v[20:23], v[188:191], v[68:71]
    v_mfma_f32_16x16x32_bf16 v[72:75], v[188:191], v[188:191], v[72:75]
    v_mfma_f32_32x32x16_bf16 v[112:127], v[56:59], v[168:171], 0
    s_nop 6
    v_cndmask_b32 v14, 0, v72, s[88:89]
    v_cndmask_b32 v14, v14, v73, s[90:91]
    v_cndmask_b32 v14, v14, v74, s[92:93]
    v_cndmask_b32 v14, v14, v75, s[94:95]
    v_mov_b32 v15, v14
    v_mul_f32 v12, 0x3b000000, v68
    v_mul_f32 v13, v12, v12
    v_mfma_f32_32x32x16_bf16 v[112:127], v[60:63], v[172:175], v[112:127]
    v_permlane32_swap_b32 v14, v15
    v_add_f32 v14, v14, v15
    v_mov_b32 v15, v14
    s_nop 1
    v_permlane16_swap_b32 v14, v15
    v_add_f32 v14, v14, v15
    v_mul_f32 v14, 0x3b000000, v14
    v_sub_f32 v14, v14, v13
    v_mfma_f32_32x32x16_bf16 v[96:111], v[56:59], v[176:179], 0
    v_max_f32 v14, 0, v14
    v_cvt_pk_bf16_f32 v13, v12, v14
    v_and_b32 v14, s39, v13
    v_lshlrev_b32 v12, 16, v13
    v_add_f32 v14, 0x3727c5ac, v14
    v_cvt_pk_bf16_f32 v14, v14, v14
    v_lshlrev_b32 v14, 16, v14
    v_mfma_f32_32x32x16_bf16 v[96:111], v[60:63], v[180:183], v[96:111]
    v_sqrt_f32 v14, v14
    s_nop 0
    v_cvt_pk_bf16_f32 v14, v14, v14
    v_lshlrev_b32 v14, 16, v14
    v_rcp_f32 v16, v14
    s_nop 0
    v_mul_f32 v16, s36, v16
    v_mul_f32_e64 v17, -v12, v16
    s_nop 0
    v_pk_fma_f32 v[208:209], v[208:209], v[16:17], v[16:17] op_sel:[0,0,1] op_sel_hi:[1,0,1]
    v_pk_fma_f32 v[210:211], v[210:211], v[16:17], v[16:17] op_sel:[0,0,1] op_sel_hi:[1,0,1]
    v_pk_fma_f32 v[212:213], v[212:213], v[16:17], v[16:17] op_sel:[0,0,1] op_sel_hi:[1,0,1]
    v_pk_fma_f32 v[214:215], v[214:215], v[16:17], v[16:17] op_sel:[0,0,1] op_sel_hi:[1,0,1]
    v_pk_fma_f32 v[216:217], v[216:217], v[16:17], v[16:17] op_sel:[0,0,1] op_sel_hi:[1,0,1]
    v_pk_fma_f32 v[218:219], v[218:219], v[16:17], v[16:17] op_sel:[0,0,1] op_sel_hi:[1,0,1]
    v_pk_fma_f32 v[220:221], v[220:221], v[16:17], v[16:17] op_sel:[0,0,1] op_sel_hi:[1,0,1]
    v_pk_fma_f32 v[222:223], v[222:223], v[16:17], v[16:17] op_sel:[0,0,1] op_sel_hi:[1,0,1]
    v_cvt_pk_bf16_f32 v128, v208, v209
    v_cvt_pk_bf16_f32 v129, v210, v211
    v_cvt_pk_bf16_f32 v130, v212, v213
    v_cvt_pk_bf16_f32 v131, v214, v215
    v_cvt_pk_bf16_f32 v132, v216, v217
    v_cvt_pk_bf16_f32 v133, v218, v219
    v_cvt_pk_bf16_f32 v134, v220, v221
    v_cvt_pk_bf16_f32 v135, v222, v223
    v_pk_fma_f32 v[224:225], v[224:225], v[16:17], v[16:17] op_sel:[0,0,1] op_sel_hi:[1,0,1]
    v_pk_fma_f32 v[226:227], v[226:227], v[16:17], v[16:17] op_sel:[0,0,1] op_sel_hi:[1,0,1]
    v_pk_fma_f32 v[228:229], v[228:229], v[16:17], v[16:17] op_sel:[0,0,1] op_sel_hi:[1,0,1]
    v_pk_fma_f32 v[230:231], v[230:231], v[16:17], v[16:17] op_sel:[0,0,1] op_sel_hi:[1,0,1]
    v_pk_fma_f32 v[232:233], v[232:233], v[16:17], v[16:17] op_sel:[0,0,1] op_sel_hi:[1,0,1]
    v_pk_fma_f32 v[234:235], v[234:235], v[16:17], v[16:17] op_sel:[0,0,1] op_sel_hi:[1,0,1]
    v_pk_fma_f32 v[236:237], v[236:237], v[16:17], v[16:17] op_sel:[0,0,1] op_sel_hi:[1,0,1]
    v_pk_fma_f32 v[238:239], v[238:239], v[16:17], v[16:17] op_sel:[0,0,1] op_sel_hi:[1,0,1]
    v_cvt_pk_bf16_f32 v136, v224, v225
    v_cvt_pk_bf16_f32 v137, v226, v227
    v_cvt_pk_bf16_f32 v138, v228, v229
    v_cvt_pk_bf16_f32 v139, v230, v231
    v_cvt_pk_bf16_f32 v140, v232, v233
    v_cvt_pk_bf16_f32 v141, v234, v235
    v_cvt_pk_bf16_f32 v142, v236, v237
    v_cvt_pk_bf16_f32 v143, v238, v239
    v_pk_fma_f32 v[240:241], v[240:241], v[16:17], v[16:17] op_sel:[0,0,1] op_sel_hi:[1,0,1]
    v_pk_fma_f32 v[242:243], v[242:243], v[16:17], v[16:17] op_sel:[0,0,1] op_sel_hi:[1,0,1]
    v_pk_fma_f32 v[244:245], v[244:245], v[16:17], v[16:17] op_sel:[0,0,1] op_sel_hi:[1,0,1]
    v_pk_fma_f32 v[246:247], v[246:247], v[16:17], v[16:17] op_sel:[0,0,1] op_sel_hi:[1,0,1]
    v_pk_fma_f32 v[248:249], v[248:249], v[16:17], v[16:17] op_sel:[0,0,1] op_sel_hi:[1,0,1]
    v_pk_fma_f32 v[250:251], v[250:251], v[16:17], v[16:17] op_sel:[0,0,1] op_sel_hi:[1,0,1]
    v_pk_fma_f32 v[252:253], v[252:253], v[16:17], v[16:17] op_sel:[0,0,1] op_sel_hi:[1,0,1]
    v_pk_fma_f32 v[254:255], v[254:255], v[16:17], v[16:17] op_sel:[0,0,1] op_sel_hi:[1,0,1]
    v_cvt_pk_bf16_f32 v144, v240, v241
    v_cvt_pk_bf16_f32 v145, v242, v243
    v_cvt_pk_bf16_f32 v146, v244, v245
    v_cvt_pk_bf16_f32 v147, v246, v247
    v_cvt_pk_bf16_f32 v148, v248, v249
    v_cvt_pk_bf16_f32 v149, v250, v251
    v_cvt_pk_bf16_f32 v150, v252, v253
    v_cvt_pk_bf16_f32 v151, v254, v255
    v_pk_fma_f32 v[24:25], v[24:25], v[16:17], v[16:17] op_sel:[0,0,1] op_sel_hi:[1,0,1]
    v_pk_fma_f32 v[26:27], v[26:27], v[16:17], v[16:17] op_sel:[0,0,1] op_sel_hi:[1,0,1]
    v_pk_fma_f32 v[28:29], v[28:29], v[16:17], v[16:17] op_sel:[0,0,1] op_sel_hi:[1,0,1]
    v_pk_fma_f32 v[30:31], v[30:31], v[16:17], v[16:17] op_sel:[0,0,1] op_sel_hi:[1,0,1]
    v_pk_fma_f32 v[32:33], v[32:33], v[16:17], v[16:17] op_sel:[0,0,1] op_sel_hi:[1,0,1]
    v_pk_fma_f32 v[34:35], v[34:35], v[16:17], v[16:17] op_sel:[0,0,1] op_sel_hi:[1,0,1]
    v_pk_fma_f32 v[36:37], v[36:37], v[16:17], v[16:17] op_sel:[0,0,1] op_sel_hi:[1,0,1]
    v_pk_fma_f32 v[38:39], v[38:39], v[16:17], v[16:17] op_sel:[0,0,1] op_sel_hi:[1,0,1]
    v_pk_fma_f32 v[40:41], v[40:41], v[16:17], v[16:17] op_sel:[0,0,1] op_sel_hi:[1,0,1]
    v_pk_fma_f32 v[42:43], v[42:43], v[16:17], v[16:17] op_sel:[0,0,1] op_sel_hi:[1,0,1]
    v_pk_fma_f32 v[44:45], v[44:45], v[16:17], v[16:17] op_sel:[0,0,1] op_sel_hi:[1,0,1]
    v_pk_fma_f32 v[46:47], v[46:47], v[16:17], v[16:17] op_sel:[0,0,1] op_sel_hi:[1,0,1]
    v_pk_fma_f32 v[48:49], v[48:49], v[16:17], v[16:17] op_sel:[0,0,1] op_sel_hi:[1,0,1]
    v_pk_fma_f32 v[50:51], v[50:51], v[16:17], v[16:17] op_sel:[0,0,1] op_sel_hi:[1,0,1]
    v_pk_fma_f32 v[52:53], v[52:53], v[16:17], v[16:17] op_sel:[0,0,1] op_sel_hi:[1,0,1]
    v_pk_fma_f32 v[54:55], v[54:55], v[16:17], v[16:17] op_sel:[0,0,1] op_sel_hi:[1,0,1]
    v_pk_fma_f32 v[112:113], v[112:113], v[16:17], v[16:17] op_sel:[0,0,1] op_sel_hi:[1,0,1]
    v_pk_fma_f32 v[114:115], v[114:115], v[16:17], v[16:17] op_sel:[0,0,1] op_sel_hi:[1,0,1]
    v_pk_fma_f32 v[116:117], v[116:117], v[16:17], v[16:17] op_sel:[0,0,1] op_sel_hi:[1,0,1]
    v_pk_fma_f32 v[118:119], v[118:119], v[16:17], v[16:17] op_sel:[0,0,1] op_sel_hi:[1,0,1]
    v_pk_fma_f32 v[120:121], v[120:121], v[16:17], v[16:17] op_sel:[0,0,1] op_sel_hi:[1,0,1]
    v_pk_fma_f32 v[122:123], v[122:123], v[16:17], v[16:17] op_sel:[0,0,1] op_sel_hi:[1,0,1]
    v_pk_fma_f32 v[124:125], v[124:125], v[16:17], v[16:17] op_sel:[0,0,1] op_sel_hi:[1,0,1]
    v_pk_fma_f32 v[126:127], v[126:127], v[16:17], v[16:17] op_sel:[0,0,1] op_sel_hi:[1,0,1]
    v_pk_fma_f32 v[96:97], v[96:97], v[16:17], v[16:17] op_sel:[0,0,1] op_sel_hi:[1,0,1]
    v_pk_fma_f32 v[98:99], v[98:99], v[16:17], v[16:17] op_sel:[0,0,1] op_sel_hi:[1,0,1]
    v_pk_fma_f32 v[100:101], v[100:101], v[16:17], v[16:17] op_sel:[0,0,1] op_sel_hi:[1,0,1]
    v_pk_fma_f32 v[102:103], v[102:103], v[16:17], v[16:17] op_sel:[0,0,1] op_sel_hi:[1,0,1]
    v_pk_fma_f32 v[104:105], v[104:105], v[16:17], v[16:17] op_sel:[0,0,1] op_sel_hi:[1,0,1]
    v_pk_fma_f32 v[106:107], v[106:107], v[16:17], v[16:17] op_sel:[0,0,1] op_sel_hi:[1,0,1]
    v_pk_fma_f32 v[108:109], v[108:109], v[16:17], v[16:17] op_sel:[0,0,1] op_sel_hi:[1,0,1]
    v_pk_fma_f32 v[110:111], v[110:111], v[16:17], v[16:17] op_sel:[0,0,1] op_sel_hi:[1,0,1]
    s_barrier
    ds_read_b128 v[208:211], v64 offset:24576
    ds_read_b128 v[212:215], v65 offset:24576
    ds_read_b128 v[216:219], v64 offset:32768
    ds_read_b128 v[220:223], v65 offset:32768
    ds_read_b128 v[224:227], v64 offset:40960
    ds_read_b128 v[228:231], v65 offset:40960
    s_nop 0
    v_cvt_pk_bf16_f32 v168, v112, v113
    v_cvt_pk_bf16_f32 v169, v114, v115
    v_cvt_pk_bf16_f32 v170, v116, v117
    v_cvt_pk_bf16_f32 v171, v118, v119
    v_cvt_pk_bf16_f32 v172, v120, v121
    v_cvt_pk_bf16_f32 v173, v122, v123
    v_cvt_pk_bf16_f32 v174, v124, v125
    v_cvt_pk_bf16_f32 v175, v126, v127
    v_mfma_f32_32x32x16_bf16 v[112:127], v[56:59], v[184:187], 0
    v_cvt_pk_bf16_f32 v152, v24, v25
    v_cvt_pk_bf16_f32 v153, v26, v27
    v_cvt_pk_bf16_f32 v154, v28, v29
    v_cvt_pk_bf16_f32 v155, v30, v31
    v_cvt_pk_bf16_f32 v156, v32, v33
    v_cvt_pk_bf16_f32 v157, v34, v35
    v_mfma_f32_32x32x16_bf16 v[112:127], v[60:63], v[188:191], v[112:127]
    v_cvt_pk_bf16_f32 v158, v36, v37
    v_cvt_pk_bf16_f32 v159, v38, v39
    v_cvt_pk_bf16_f32 v160, v40, v41
    v_cvt_pk_bf16_f32 v161, v42, v43
    v_cvt_pk_bf16_f32 v162, v44, v45
    v_cvt_pk_bf16_f32 v163, v46, v47
    v_mfma_f32_32x32x16_bf16 v[24:39], v[56:59], v[192:195], 0
    v_cvt_pk_bf16_f32 v164, v48, v49
    v_cvt_pk_bf16_f32 v165, v50, v51
    v_cvt_pk_bf16_f32 v166, v52, v53
    v_cvt_pk_bf16_f32 v167, v54, v55
    v_cvt_pk_bf16_f32 v176, v96, v97
    v_cvt_pk_bf16_f32 v177, v98, v99
    v_mfma_f32_32x32x16_bf16 v[24:39], v[60:63], v[196:199], v[24:39]
    v_cvt_pk_bf16_f32 v178, v100, v101
    v_cvt_pk_bf16_f32 v179, v102, v103
    v_cvt_pk_bf16_f32 v180, v104, v105
    v_cvt_pk_bf16_f32 v181, v106, v107
    v_cvt_pk_bf16_f32 v182, v108, v109
    v_cvt_pk_bf16_f32 v183, v110, v111
    v_mfma_f32_32x32x16_bf16 v[40:55], v[56:59], v[200:203], 0
    v_fma_f32 v112, v112, v16, v17
    v_fma_f32 v113, v113, v16, v17
    v_fma_f32 v114, v114, v16, v17
    v_fma_f32 v115, v115, v16, v17
    v_cvt_pk_bf16_f32 v184, v112, v113
    v_cvt_pk_bf16_f32 v185, v114, v115
    v_mfma_f32_32x32x16_bf16 v[40:55], v[60:63], v[204:207], v[40:55]
    v_fma_f32 v116, v116, v16, v17
    v_fma_f32 v117, v117, v16, v17
    v_fma_f32 v118, v118, v16, v17
    v_fma_f32 v119, v119, v16, v17
    v_cvt_pk_bf16_f32 v186, v116, v117
    v_cvt_pk_bf16_f32 v187, v118, v119
    s_waitcnt lgkmcnt(0)
    s_nop 0
    v_mfma_f32_16x16x32_bf16 v[76:79], v[20:23], v[208:211], v[76:79]
    v_fma_f32 v120, v120, v16, v17
    v_fma_f32 v121, v121, v16, v17
    v_mfma_f32_16x16x32_bf16 v[80:83], v[208:211], v[208:211], v[80:83]
    v_fma_f32 v122, v122, v16, v17
    v_fma_f32 v123, v123, v16, v17
    v_mfma_f32_16x16x32_bf16 v[76:79], v[20:23], v[212:215], v[76:79]
    v_cvt_pk_bf16_f32 v188, v120, v121
    v_cvt_pk_bf16_f32 v189, v122, v123
    v_mfma_f32_16x16x32_bf16 v[80:83], v[212:215], v[212:215], v[80:83]
    v_fma_f32 v124, v124, v16, v17
    v_fma_f32 v125, v125, v16, v17
    v_mfma_f32_16x16x32_bf16 v[76:79], v[20:23], v[216:219], v[76:79]
    v_fma_f32 v126, v126, v16, v17
    v_fma_f32 v127, v127, v16, v17
    v_mfma_f32_16x16x32_bf16 v[80:83], v[216:219], v[216:219], v[80:83]
    v_cvt_pk_bf16_f32 v190, v124, v125
    v_cvt_pk_bf16_f32 v191, v126, v127
    v_mfma_f32_16x16x32_bf16 v[76:79], v[20:23], v[220:223], v[76:79]
    v_mfma_f32_16x16x32_bf16 v[80:83], v[220:223], v[220:223], v[80:83]
    v_mfma_f32_16x16x32_bf16 v[76:79], v[20:23], v[224:227], v[76:79]
    v_mfma_f32_16x16x32_bf16 v[80:83], v[224:227], v[224:227], v[80:83]
    v_mfma_f32_16x16x32_bf16 v[76:79], v[20:23], v[228:231], v[76:79]
    v_mfma_f32_16x16x32_bf16 v[80:83], v[228:231], v[228:231], v[80:83]
    s_barrier
    ds_read_b128 v[232:235], v64 offset:49152
    ds_read_b128 v[236:239], v65 offset:49152
    ds_read_b128 v[240:243], v64 offset:57344
    ds_read_b128 v[244:247], v65 offset:57344
    v_add_u32 v64, 0x10000, v64
    ds_read_b128 v[248:251], v64 offset:0
    v_add_u32 v65, 0x10000, v65
    ds_read_b128 v[252:255], v65 offset:0
    v_mfma_f32_32x32x16_bf16 v[96:111], v[56:59], v[208:211], 0
    v_mfma_f32_32x32x16_bf16 v[96:111], v[60:63], v[212:215], v[96:111]
    s_waitcnt lgkmcnt(5)
    v_mfma_f32_16x16x32_bf16 v[76:79], v[20:23], v[232:235], v[76:79]
    v_mfma_f32_16x16x32_bf16 v[80:83], v[232:235], v[232:235], v[80:83]
    s_waitcnt lgkmcnt(4)
    v_mfma_f32_16x16x32_bf16 v[76:79], v[20:23], v[236:239], v[76:79]
    v_mfma_f32_16x16x32_bf16 v[80:83], v[236:239], v[236:239], v[80:83]
    s_waitcnt lgkmcnt(3)
    v_mfma_f32_16x16x32_bf16 v[76:79], v[20:23], v[240:243], v[76:79]
    v_mfma_f32_16x16x32_bf16 v[80:83], v[240:243], v[240:243], v[80:83]
    s_waitcnt lgkmcnt(2)
    v_mfma_f32_16x16x32_bf16 v[76:79], v[20:23], v[244:247], v[76:79]
    v_mfma_f32_16x16x32_bf16 v[80:83], v[244:247], v[244:247], v[80:83]
    s_waitcnt lgkmcnt(1)
    v_mfma_f32_16x16x32_bf16 v[76:79], v[20:23], v[248:251], v[76:79]
    v_mfma_f32_16x16x32_bf16 v[80:83], v[248:251], v[248:251], v[80:83]
    s_waitcnt lgkmcnt(0)
    v_mfma_f32_16x16x32_bf16 v[76:79], v[20:23], v[252:255], v[76:79]
    v_mfma_f32_16x16x32_bf16 v[80:83], v[252:255], v[252:255], v[80:83]
    v_mfma_f32_32x32x16_bf16 v[112:127], v[56:59], v[216:219], 0
    s_nop 6
    v_cndmask_b32 v14, 0, v80, s[88:89]
    v_cndmask_b32 v14, v14, v81, s[90:91]
    v_cndmask_b32 v14, v14, v82, s[92:93]
    v_cndmask_b32 v14, v14, v83, s[94:95]
    v_mov_b32 v15, v14
    v_mul_f32 v12, 0x3b000000, v76
    v_mul_f32 v13, v12, v12
    v_mfma_f32_32x32x16_bf16 v[112:127], v[60:63], v[220:223], v[112:127]
    v_permlane32_swap_b32 v14, v15
    v_add_f32 v14, v14, v15
    v_mov_b32 v15, v14
    s_nop 1
    v_permlane16_swap_b32 v14, v15
    v_add_f32 v14, v14, v15
    v_mul_f32 v14, 0x3b000000, v14
    v_sub_f32 v14, v14, v13
    v_max_f32 v14, 0, v14
    v_cvt_pk_bf16_f32 v13, v12, v14
    v_and_b32 v14, s39, v13
    v_lshlrev_b32 v12, 16, v13
    v_add_f32 v14, 0x3727c5ac, v14
    v_cvt_pk_bf16_f32 v14, v14, v14
    v_lshlrev_b32 v14, 16, v14
    v_sqrt_f32 v14, v14
    s_nop 0
    v_cvt_pk_bf16_f32 v14, v14, v14
    v_lshlrev_b32 v14, 16, v14
    v_rcp_f32 v8, v14
    s_nop 0
    v_mul_f32 v8, s36, v8
    v_mul_f32_e64 v9, -v12, v8
    s_nop 0
    v_pk_fma_f32 v[24:25], v[24:25], v[8:9], v[8:9] op_sel:[0,0,1] op_sel_hi:[1,0,1]
    v_pk_fma_f32 v[26:27], v[26:27], v[8:9], v[8:9] op_sel:[0,0,1] op_sel_hi:[1,0,1]
    v_pk_fma_f32 v[28:29], v[28:29], v[8:9], v[8:9] op_sel:[0,0,1] op_sel_hi:[1,0,1]
    v_pk_fma_f32 v[30:31], v[30:31], v[8:9], v[8:9] op_sel:[0,0,1] op_sel_hi:[1,0,1]
    v_pk_fma_f32 v[32:33], v[32:33], v[8:9], v[8:9] op_sel:[0,0,1] op_sel_hi:[1,0,1]
    v_pk_fma_f32 v[34:35], v[34:35], v[8:9], v[8:9] op_sel:[0,0,1] op_sel_hi:[1,0,1]
    v_pk_fma_f32 v[36:37], v[36:37], v[8:9], v[8:9] op_sel:[0,0,1] op_sel_hi:[1,0,1]
    v_pk_fma_f32 v[38:39], v[38:39], v[8:9], v[8:9] op_sel:[0,0,1] op_sel_hi:[1,0,1]
    v_pk_fma_f32 v[40:41], v[40:41], v[8:9], v[8:9] op_sel:[0,0,1] op_sel_hi:[1,0,1]
    v_pk_fma_f32 v[42:43], v[42:43], v[8:9], v[8:9] op_sel:[0,0,1] op_sel_hi:[1,0,1]
    v_pk_fma_f32 v[44:45], v[44:45], v[8:9], v[8:9] op_sel:[0,0,1] op_sel_hi:[1,0,1]
    v_pk_fma_f32 v[46:47], v[46:47], v[8:9], v[8:9] op_sel:[0,0,1] op_sel_hi:[1,0,1]
    v_pk_fma_f32 v[48:49], v[48:49], v[8:9], v[8:9] op_sel:[0,0,1] op_sel_hi:[1,0,1]
    v_pk_fma_f32 v[50:51], v[50:51], v[8:9], v[8:9] op_sel:[0,0,1] op_sel_hi:[1,0,1]
    v_pk_fma_f32 v[52:53], v[52:53], v[8:9], v[8:9] op_sel:[0,0,1] op_sel_hi:[1,0,1]
    v_pk_fma_f32 v[54:55], v[54:55], v[8:9], v[8:9] op_sel:[0,0,1] op_sel_hi:[1,0,1]
    v_pk_fma_f32 v[96:97], v[96:97], v[8:9], v[8:9] op_sel:[0,0,1] op_sel_hi:[1,0,1]
    v_pk_fma_f32 v[98:99], v[98:99], v[8:9], v[8:9] op_sel:[0,0,1] op_sel_hi:[1,0,1]
    v_pk_fma_f32 v[100:101], v[100:101], v[8:9], v[8:9] op_sel:[0,0,1] op_sel_hi:[1,0,1]
    v_pk_fma_f32 v[102:103], v[102:103], v[8:9], v[8:9] op_sel:[0,0,1] op_sel_hi:[1,0,1]
    v_pk_fma_f32 v[104:105], v[104:105], v[8:9], v[8:9] op_sel:[0,0,1] op_sel_hi:[1,0,1]
    v_pk_fma_f32 v[106:107], v[106:107], v[8:9], v[8:9] op_sel:[0,0,1] op_sel_hi:[1,0,1]
    v_pk_fma_f32 v[108:109], v[108:109], v[8:9], v[8:9] op_sel:[0,0,1] op_sel_hi:[1,0,1]
    v_pk_fma_f32 v[110:111], v[110:111], v[8:9], v[8:9] op_sel:[0,0,1] op_sel_hi:[1,0,1]
    v_pk_fma_f32 v[112:113], v[112:113], v[8:9], v[8:9] op_sel:[0,0,1] op_sel_hi:[1,0,1]
    v_pk_fma_f32 v[114:115], v[114:115], v[8:9], v[8:9] op_sel:[0,0,1] op_sel_hi:[1,0,1]
    v_pk_fma_f32 v[116:117], v[116:117], v[8:9], v[8:9] op_sel:[0,0,1] op_sel_hi:[1,0,1]
    v_pk_fma_f32 v[118:119], v[118:119], v[8:9], v[8:9] op_sel:[0,0,1] op_sel_hi:[1,0,1]
    v_pk_fma_f32 v[120:121], v[120:121], v[8:9], v[8:9] op_sel:[0,0,1] op_sel_hi:[1,0,1]
    v_pk_fma_f32 v[122:123], v[122:123], v[8:9], v[8:9] op_sel:[0,0,1] op_sel_hi:[1,0,1]
    v_pk_fma_f32 v[124:125], v[124:125], v[8:9], v[8:9] op_sel:[0,0,1] op_sel_hi:[1,0,1]
    v_pk_fma_f32 v[126:127], v[126:127], v[8:9], v[8:9] op_sel:[0,0,1] op_sel_hi:[1,0,1]
    v_cvt_pk_bf16_f32 v208, v96, v97
    v_cvt_pk_bf16_f32 v209, v98, v99
    v_cvt_pk_bf16_f32 v210, v100, v101
    v_cvt_pk_bf16_f32 v211, v102, v103
    v_cvt_pk_bf16_f32 v212, v104, v105
    v_cvt_pk_bf16_f32 v213, v106, v107
    v_cvt_pk_bf16_f32 v214, v108, v109
    v_cvt_pk_bf16_f32 v215, v110, v111
    v_mfma_f32_32x32x16_bf16 v[96:111], v[56:59], v[224:227], 0
    v_cvt_pk_bf16_f32 v192, v24, v25
    v_cvt_pk_bf16_f32 v193, v26, v27
    v_cvt_pk_bf16_f32 v194, v28, v29
    v_cvt_pk_bf16_f32 v195, v30, v31
    v_cvt_pk_bf16_f32 v196, v32, v33
    v_cvt_pk_bf16_f32 v197, v34, v35
    v_cvt_pk_bf16_f32 v198, v36, v37
    v_cvt_pk_bf16_f32 v199, v38, v39
    v_mfma_f32_32x32x16_bf16 v[96:111], v[60:63], v[228:231], v[96:111]
    v_cvt_pk_bf16_f32 v200, v40, v41
    v_cvt_pk_bf16_f32 v201, v42, v43
    v_cvt_pk_bf16_f32 v202, v44, v45
    v_cvt_pk_bf16_f32 v203, v46, v47
    v_cvt_pk_bf16_f32 v204, v48, v49
    v_cvt_pk_bf16_f32 v205, v50, v51
    v_cvt_pk_bf16_f32 v206, v52, v53
    v_cvt_pk_bf16_f32 v207, v54, v55
    s_barrier
    v_add_u32 v1, 0x22000, v1
    s_branch L_pg652x
L_pg652:
    s_setpc_b64 s[30:31]
L_pg652x:
    ds_read_b64_tr_b16 v[24:25], v1 offset:0
    ds_read_b64_tr_b16 v[26:27], v1 offset:2048
    ds_read_b64_tr_b16 v[28:29], v1 offset:4096
    ds_read_b64_tr_b16 v[30:31], v1 offset:6144
    v_add_u32 v2, 0x22000, v2
    ds_read_b64_tr_b16 v[32:33], v2 offset:0
    ds_read_b64_tr_b16 v[34:35], v2 offset:2048
    ds_read_b64_tr_b16 v[36:37], v2 offset:4096
    ds_read_b64_tr_b16 v[38:39], v2 offset:6144
    v_add_u32 v3, 0x22000, v3
    ds_read_b64_tr_b16 v[40:41], v3 offset:0
    ds_read_b64_tr_b16 v[42:43], v3 offset:2048
    ds_read_b64_tr_b16 v[44:45], v3 offset:4096
    ds_read_b64_tr_b16 v[46:47], v3 offset:6144
    v_cvt_pk_bf16_f32 v216, v112, v113
    v_cvt_pk_bf16_f32 v217, v114, v115
    v_cvt_pk_bf16_f32 v218, v116, v117
    v_cvt_pk_bf16_f32 v219, v118, v119
    v_cvt_pk_bf16_f32 v220, v120, v121
    v_cvt_pk_bf16_f32 v221, v122, v123
    v_cvt_pk_bf16_f32 v222, v124, v125
    v_cvt_pk_bf16_f32 v223, v126, v127
    s_cmp_ge_u32 s2, 128
    s_cbranch_scc1 L_compF
L_compA:
    s_waitcnt lgkmcnt(4)
    v_mfma_f32_16x16x32_bf16 v[64:67], v[128:131], v[24:27], 0
    v_add_u32 v4, 0x22000, v4
    ds_read_b64_tr_b16 v[48:49], v4 offset:0
    v_mfma_f32_32x32x16_bf16 v[112:127], v[56:59], v[232:235], 0
    v_fma_f32 v96, v96, v8, v9
    v_fma_f32 v97, v97, v8, v9
    v_fma_f32 v98, v98, v8, v9
    v_fma_f32 v99, v99, v8, v9
    v_mfma_f32_16x16x32_bf16 v[64:67], v[132:135], v[28:31], v[64:67]
    ds_read_b64_tr_b16 v[50:51], v4 offset:2048
    v_mfma_f32_16x16x32_bf16 v[68:71], v[196:199], v[28:31], 0
    ds_read_b64_tr_b16 v[52:53], v4 offset:4096
    v_mfma_f32_16x16x32_bf16 v[68:71], v[192:195], v[24:27], v[68:71]
    ds_read_b64_tr_b16 v[54:55], v4 offset:6144
    v_mfma_f32_16x16x32_bf16 v[72:75], v[128:131], v[32:35], 0
    ds_read_b64_tr_b16 v[24:25], v1 offset:8192
    v_mfma_f32_16x16x32_bf16 v[72:75], v[132:135], v[36:39], v[72:75]
    ds_read_b64_tr_b16 v[26:27], v1 offset:10240
    v_mfma_f32_16x16x32_bf16 v[76:79], v[196:199], v[36:39], 0
    ds_read_b64_tr_b16 v[28:29], v1 offset:12288
    v_cvt_pk_bf16_f32 v224, v96, v97
    v_mfma_f32_16x16x32_bf16 v[76:79], v[192:195], v[32:35], v[76:79]
    ds_read_b64_tr_b16 v[30:31], v1 offset:14336
    v_cvt_pk_bf16_f32 v225, v98, v99
    s_waitcnt lgkmcnt(4)
    v_mfma_f32_16x16x32_bf16 v[80:83], v[128:131], v[40:43], 0
    ds_read_b64_tr_b16 v[32:33], v2 offset:8192
    v_fma_f32 v100, v100, v8, v9
    v_mfma_f32_16x16x32_bf16 v[80:83], v[132:135], v[44:47], v[80:83]
    ds_read_b64_tr_b16 v[34:35], v2 offset:10240
    v_fma_f32 v101, v101, v8, v9
    v_mfma_f32_16x16x32_bf16 v[84:87], v[196:199], v[44:47], 0
    ds_read_b64_tr_b16 v[36:37], v2 offset:12288
    v_mfma_f32_32x32x16_bf16 v[112:127], v[60:63], v[236:239], v[112:127]
    v_fma_f32 v102, v102, v8, v9
    v_fma_f32 v103, v103, v8, v9
    v_cvt_pk_bf16_f32 v226, v100, v101
    v_cvt_pk_bf16_f32 v227, v102, v103
    v_mfma_f32_16x16x32_bf16 v[84:87], v[192:195], v[40:43], v[84:87]
    ds_read_b64_tr_b16 v[38:39], v2 offset:14336
    v_mfma_f32_16x16x32_bf16 v[88:91], v[128:131], v[48:51], 0
    ds_read_b64_tr_b16 v[40:41], v3 offset:8192
    v_mfma_f32_16x16x32_bf16 v[88:91], v[132:135], v[52:55], v[88:91]
    ds_read_b64_tr_b16 v[42:43], v3 offset:10240
    v_mfma_f32_16x16x32_bf16 v[92:95], v[196:199], v[52:55], 0
    ds_read_b64_tr_b16 v[44:45], v3 offset:12288
    v_mfma_f32_16x16x32_bf16 v[92:95], v[192:195], v[48:51], v[92:95]
    ds_read_b64_tr_b16 v[46:47], v3 offset:14336
    s_waitcnt lgkmcnt(4)
    v_mfma_f32_16x16x32_bf16 v[64:67], v[136:139], v[24:27], v[64:67]
    ds_read_b64_tr_b16 v[48:49], v4 offset:8192
    v_mfma_f32_16x16x32_bf16 v[64:67], v[140:143], v[28:31], v[64:67]
    ds_read_b64_tr_b16 v[50:51], v4 offset:10240
    v_fma_f32 v104, v104, v8, v9
    v_mfma_f32_16x16x32_bf16 v[68:71], v[204:207], v[28:31], v[68:71]
    ds_read_b64_tr_b16 v[52:53], v4 offset:12288
    v_fma_f32 v105, v105, v8, v9
    v_mfma_f32_16x16x32_bf16 v[68:71], v[200:203], v[24:27], v[68:71]
    ds_read_b64_tr_b16 v[54:55], v4 offset:14336
    v_fma_f32 v106, v106, v8, v9
    v_mfma_f32_16x16x32_bf16 v[72:75], v[136:139], v[32:35], v[72:75]
    s_barrier
    ds_read_b64_tr_b16 v[24:25], v1 offset:16384
    v_fma_f32 v107, v107, v8, v9
    v_mfma_f32_16x16x32_bf16 v[72:75], v[140:143], v[36:39], v[72:75]
    ds_read_b64_tr_b16 v[26:27], v1 offset:18432
    v_cvt_pk_bf16_f32 v228, v104, v105
    v_mfma_f32_16x16x32_bf16 v[76:79], v[204:207], v[36:39], v[76:79]
    ds_read_b64_tr_b16 v[28:29], v1 offset:20480
    v_cvt_pk_bf16_f32 v229, v106, v107
    v_mfma_f32_16x16x32_bf16 v[76:79], v[200:203], v[32:35], v[76:79]
    ds_read_b64_tr_b16 v[30:31], v1 offset:22528
    v_fma_f32 v108, v108, v8, v9
    s_waitcnt lgkmcnt(4)
    v_mfma_f32_16x16x32_bf16 v[80:83], v[136:139], v[40:43], v[80:83]
    ds_read_b64_tr_b16 v[32:33], v2 offset:16384
    v_fma_f32 v109, v109, v8, v9
    v_mfma_f32_16x16x32_bf16 v[80:83], v[140:143], v[44:47], v[80:83]
    ds_read_b64_tr_b16 v[34:35], v2 offset:18432
    v_fma_f32 v110, v110, v8, v9
    v_mfma_f32_16x16x32_bf16 v[84:87], v[204:207], v[44:47], v[84:87]
    ds_read_b64_tr_b16 v[36:37], v2 offset:20480
    v_fma_f32 v111, v111, v8, v9
    v_mfma_f32_16x16x32_bf16 v[84:87], v[200:203], v[40:43], v[84:87]
    ds_read_b64_tr_b16 v[38:39], v2 offset:22528
    v_cvt_pk_bf16_f32 v230, v108, v109
    v_mfma_f32_16x16x32_bf16 v[88:91], v[136:139], v[48:51], v[88:91]
    ds_read_b64_tr_b16 v[40:41], v3 offset:16384
    v_cvt_pk_bf16_f32 v231, v110, v111
    v_mfma_f32_16x16x32_bf16 v[88:91], v[140:143], v[52:55], v[88:91]
    ds_read_b64_tr_b16 v[42:43], v3 offset:18432
    v_mfma_f32_32x32x16_bf16 v[96:111], v[56:59], v[240:243], 0
    v_mfma_f32_16x16x32_bf16 v[92:95], v[204:207], v[52:55], v[92:95]
    ds_read_b64_tr_b16 v[44:45], v3 offset:20480
    v_mfma_f32_16x16x32_bf16 v[92:95], v[200:203], v[48:51], v[92:95]
    ds_read_b64_tr_b16 v[46:47], v3 offset:22528
    v_fma_f32 v112, v112, v8, v9
    s_waitcnt lgkmcnt(4)
    v_mfma_f32_16x16x32_bf16 v[64:67], v[144:147], v[24:27], v[64:67]
    ds_read_b64_tr_b16 v[48:49], v4 offset:16384
    v_fma_f32 v113, v113, v8, v9
    v_mfma_f32_16x16x32_bf16 v[64:67], v[148:151], v[28:31], v[64:67]
    ds_read_b64_tr_b16 v[50:51], v4 offset:18432
    v_fma_f32 v114, v114, v8, v9
    v_mfma_f32_16x16x32_bf16 v[68:71], v[212:215], v[28:31], v[68:71]
    ds_read_b64_tr_b16 v[52:53], v4 offset:20480
    v_fma_f32 v115, v115, v8, v9
    v_mfma_f32_16x16x32_bf16 v[68:71], v[208:211], v[24:27], v[68:71]
    ds_read_b64_tr_b16 v[54:55], v4 offset:22528
    v_cvt_pk_bf16_f32 v232, v112, v113
    v_mfma_f32_16x16x32_bf16 v[72:75], v[144:147], v[32:35], v[72:75]
    v_add_u32 v1, 0xfffe0000, v1
    ds_read_b64_tr_b16 v[24:25], v1 offset:0
    v_cvt_pk_bf16_f32 v233, v114, v115
    v_mfma_f32_16x16x32_bf16 v[72:75], v[148:151], v[36:39], v[72:75]
    ds_read_b64_tr_b16 v[26:27], v1 offset:2048
    v_fma_f32 v116, v116, v8, v9
    v_mfma_f32_16x16x32_bf16 v[76:79], v[212:215], v[36:39], v[76:79]
    ds_read_b64_tr_b16 v[28:29], v1 offset:4096
    v_fma_f32 v117, v117, v8, v9
    v_mfma_f32_16x16x32_bf16 v[76:79], v[208:211], v[32:35], v[76:79]
    ds_read_b64_tr_b16 v[30:31], v1 offset:6144
    v_mfma_f32_32x32x16_bf16 v[96:111], v[60:63], v[244:247], v[96:111]
    v_fma_f32 v118, v118, v8, v9
    v_fma_f32 v119, v119, v8, v9
    v_cvt_pk_bf16_f32 v234, v116, v117
    v_cvt_pk_bf16_f32 v235, v118, v119
    s_waitcnt lgkmcnt(4)
    v_mfma_f32_16x16x32_bf16 v[80:83], v[144:147], v[40:43], v[80:83]
    v_add_u32 v2, 0xfffe0000, v2
    ds_read_b64_tr_b16 v[32:33], v2 offset:0
    v_mfma_f32_16x16x32_bf16 v[80:83], v[148:151], v[44:47], v[80:83]
    ds_read_b64_tr_b16 v[34:35], v2 offset:2048
    v_mfma_f32_16x16x32_bf16 v[84:87], v[212:215], v[44:47], v[84:87]
    ds_read_b64_tr_b16 v[36:37], v2 offset:4096
    v_mfma_f32_16x16x32_bf16 v[84:87], v[208:211], v[40:43], v[84:87]
    ds_read_b64_tr_b16 v[38:39], v2 offset:6144
    v_mfma_f32_16x16x32_bf16 v[88:91], v[144:147], v[48:51], v[88:91]
    v_add_u32 v3, 0xfffe0000, v3
    ds_read_b64_tr_b16 v[40:41], v3 offset:0
    v_mfma_f32_16x16x32_bf16 v[88:91], v[148:151], v[52:55], v[88:91]
    ds_read_b64_tr_b16 v[42:43], v3 offset:2048
    v_fma_f32 v120, v120, v8, v9
    v_mfma_f32_16x16x32_bf16 v[92:95], v[212:215], v[52:55], v[92:95]
    ds_read_b64_tr_b16 v[44:45], v3 offset:4096
    v_mfma_f32_16x16x32_bf16 v[92:95], v[208:211], v[48:51], v[92:95]
    ds_read_b64_tr_b16 v[46:47], v3 offset:6144
    v_fma_f32 v121, v121, v8, v9
    s_waitcnt lgkmcnt(4)
    v_mfma_f32_16x16x32_bf16 v[64:67], v[152:155], v[24:27], v[64:67]
    v_add_u32 v4, 0xfffe0000, v4
    ds_read_b64_tr_b16 v[48:49], v4 offset:0
    v_fma_f32 v122, v122, v8, v9
    v_mfma_f32_16x16x32_bf16 v[64:67], v[156:159], v[28:31], v[64:67]
    ds_read_b64_tr_b16 v[50:51], v4 offset:2048
    v_fma_f32 v123, v123, v8, v9
    v_mfma_f32_16x16x32_bf16 v[68:71], v[220:223], v[28:31], v[68:71]
    ds_read_b64_tr_b16 v[52:53], v4 offset:4096
    v_cvt_pk_bf16_f32 v236, v120, v121
    v_mfma_f32_16x16x32_bf16 v[68:71], v[216:219], v[24:27], v[68:71]
    ds_read_b64_tr_b16 v[54:55], v4 offset:6144
    v_cvt_pk_bf16_f32 v237, v122, v123
    v_mfma_f32_16x16x32_bf16 v[72:75], v[152:155], v[32:35], v[72:75]
    ds_read_b64_tr_b16 v[24:25], v1 offset:8192
    v_fma_f32 v124, v124, v8, v9
    v_mfma_f32_16x16x32_bf16 v[72:75], v[156:159], v[36:39], v[72:75]
    ds_read_b64_tr_b16 v[26:27], v1 offset:10240
    v_fma_f32 v125, v125, v8, v9
    v_mfma_f32_16x16x32_bf16 v[76:79], v[220:223], v[36:39], v[76:79]
    ds_read_b64_tr_b16 v[28:29], v1 offset:12288
    v_fma_f32 v126, v126, v8, v9
    v_mfma_f32_16x16x32_bf16 v[76:79], v[216:219], v[32:35], v[76:79]
    ds_read_b64_tr_b16 v[30:31], v1 offset:14336
    v_fma_f32 v127, v127, v8, v9
    s_waitcnt lgkmcnt(4)
    v_mfma_f32_16x16x32_bf16 v[80:83], v[152:155], v[40:43], v[80:83]
    ds_read_b64_tr_b16 v[32:33], v2 offset:8192
    v_cvt_pk_bf16_f32 v238, v124, v125
    v_mfma_f32_16x16x32_bf16 v[80:83], v[156:159], v[44:47], v[80:83]
    ds_read_b64_tr_b16 v[34:35], v2 offset:10240
    v_cvt_pk_bf16_f32 v239, v126, v127
    v_mfma_f32_16x16x32_bf16 v[84:87], v[220:223], v[44:47], v[84:87]
    ds_read_b64_tr_b16 v[36:37], v2 offset:12288
    v_mfma_f32_32x32x16_bf16 v[112:127], v[56:59], v[248:251], 0
    v_mfma_f32_16x16x32_bf16 v[84:87], v[216:219], v[40:43], v[84:87]
    ds_read_b64_tr_b16 v[38:39], v2 offset:14336
    v_mfma_f32_16x16x32_bf16 v[88:91], v[152:155], v[48:51], v[88:91]
    ds_read_b64_tr_b16 v[40:41], v3 offset:8192
    v_fma_f32 v96, v96, v8, v9
    v_mfma_f32_16x16x32_bf16 v[88:91], v[156:159], v[52:55], v[88:91]
    ds_read_b64_tr_b16 v[42:43], v3 offset:10240
    v_fma_f32 v97, v97, v8, v9
    v_mfma_f32_16x16x32_bf16 v[92:95], v[220:223], v[52:55], v[92:95]
    ds_read_b64_tr_b16 v[44:45], v3 offset:12288
    v_fma_f32 v98, v98, v8, v9
    v_mfma_f32_16x16x32_bf16 v[92:95], v[216:219], v[48:51], v[92:95]
    ds_read_b64_tr_b16 v[46:47], v3 offset:14336
    v_fma_f32 v99, v99, v8, v9
    s_waitcnt lgkmcnt(4)
    v_mfma_f32_16x16x32_bf16 v[64:67], v[160:163], v[24:27], v[64:67]
    ds_read_b64_tr_b16 v[48:49], v4 offset:8192
    v_cvt_pk_bf16_f32 v240, v96, v97
    v_mfma_f32_16x16x32_bf16 v[64:67], v[164:167], v[28:31], v[64:67]
    ds_read_b64_tr_b16 v[50:51], v4 offset:10240
    v_cvt_pk_bf16_f32 v241, v98, v99
    v_mfma_f32_16x16x32_bf16 v[68:71], v[228:231], v[28:31], v[68:71]
    ds_read_b64_tr_b16 v[52:53], v4 offset:12288
    v_fma_f32 v100, v100, v8, v9
    v_mfma_f32_16x16x32_bf16 v[68:71], v[224:227], v[24:27], v[68:71]
    ds_read_b64_tr_b16 v[54:55], v4 offset:14336
    v_fma_f32 v101, v101, v8, v9
    v_mfma_f32_16x16x32_bf16 v[72:75], v[160:163], v[32:35], v[72:75]
    s_barrier
    ds_read_b64_tr_b16 v[24:25], v1 offset:16384
    v_mfma_f32_32x32x16_bf16 v[112:127], v[60:63], v[252:255], v[112:127]
    v_fma_f32 v102, v102, v8, v9
    v_fma_f32 v103, v103, v8, v9
    v_cvt_pk_bf16_f32 v242, v100, v101
    v_cvt_pk_bf16_f32 v243, v102, v103
    v_mfma_f32_16x16x32_bf16 v[72:75], v[164:167], v[36:39], v[72:75]
    ds_read_b64_tr_b16 v[26:27], v1 offset:18432
    v_mfma_f32_16x16x32_bf16 v[76:79], v[228:231], v[36:39], v[76:79]
    ds_read_b64_tr_b16 v[28:29], v1 offset:20480
    v_mfma_f32_16x16x32_bf16 v[76:79], v[224:227], v[32:35], v[76:79]
    ds_read_b64_tr_b16 v[30:31], v1 offset:22528
    s_waitcnt lgkmcnt(4)
    v_mfma_f32_16x16x32_bf16 v[80:83], v[160:163], v[40:43], v[80:83]
    ds_read_b64_tr_b16 v[32:33], v2 offset:16384
    v_mfma_f32_16x16x32_bf16 v[80:83], v[164:167], v[44:47], v[80:83]
    ds_read_b64_tr_b16 v[34:35], v2 offset:18432
    v_mfma_f32_16x16x32_bf16 v[84:87], v[228:231], v[44:47], v[84:87]
    ds_read_b64_tr_b16 v[36:37], v2 offset:20480
    v_fma_f32 v104, v104, v8, v9
    v_mfma_f32_16x16x32_bf16 v[84:87], v[224:227], v[40:43], v[84:87]
    ds_read_b64_tr_b16 v[38:39], v2 offset:22528
    v_fma_f32 v105, v105, v8, v9
    v_mfma_f32_16x16x32_bf16 v[88:91], v[160:163], v[48:51], v[88:91]
    ds_read_b64_tr_b16 v[40:41], v3 offset:16384
    v_fma_f32 v106, v106, v8, v9
    v_mfma_f32_16x16x32_bf16 v[88:91], v[164:167], v[52:55], v[88:91]
    ds_read_b64_tr_b16 v[42:43], v3 offset:18432
    v_fma_f32 v107, v107, v8, v9
    v_mfma_f32_16x16x32_bf16 v[92:95], v[228:231], v[52:55], v[92:95]
    ds_read_b64_tr_b16 v[44:45], v3 offset:20480
    v_cvt_pk_bf16_f32 v244, v104, v105
    v_mfma_f32_16x16x32_bf16 v[92:95], v[224:227], v[48:51], v[92:95]
    ds_read_b64_tr_b16 v[46:47], v3 offset:22528
    v_cvt_pk_bf16_f32 v245, v106, v107
    s_waitcnt lgkmcnt(4)
    v_mfma_f32_16x16x32_bf16 v[64:67], v[168:171], v[24:27], v[64:67]
    ds_read_b64_tr_b16 v[48:49], v4 offset:16384
    v_fma_f32 v108, v108, v8, v9
    v_mfma_f32_16x16x32_bf16 v[64:67], v[172:175], v[28:31], v[64:67]
    ds_read_b64_tr_b16 v[50:51], v4 offset:18432
    v_fma_f32 v109, v109, v8, v9
    v_mfma_f32_16x16x32_bf16 v[68:71], v[236:239], v[28:31], v[68:71]
    ds_read_b64_tr_b16 v[52:53], v4 offset:20480
    v_fma_f32 v110, v110, v8, v9
    v_mfma_f32_16x16x32_bf16 v[68:71], v[232:235], v[24:27], v[68:71]
    ds_read_b64_tr_b16 v[54:55], v4 offset:22528
    v_fma_f32 v111, v111, v8, v9
    v_mfma_f32_16x16x32_bf16 v[72:75], v[168:171], v[32:35], v[72:75]
    ds_read_b64_tr_b16 v[24:25], v1 offset:24576
    v_cvt_pk_bf16_f32 v246, v108, v109
    v_mfma_f32_16x16x32_bf16 v[72:75], v[172:175], v[36:39], v[72:75]
    ds_read_b64_tr_b16 v[26:27], v1 offset:26624
    v_cvt_pk_bf16_f32 v247, v110, v111
    v_mfma_f32_16x16x32_bf16 v[76:79], v[236:239], v[36:39], v[76:79]
    ds_read_b64_tr_b16 v[28:29], v1 offset:28672
    v_fma_f32 v112, v112, v8, v9
    v_mfma_f32_16x16x32_bf16 v[76:79], v[232:235], v[32:35], v[76:79]
    ds_read_b64_tr_b16 v[30:31], v1 offset:30720
    v_fma_f32 v113, v113, v8, v9
    s_waitcnt lgkmcnt(4)
    v_mfma_f32_16x16x32_bf16 v[80:83], v[168:171], v[40:43], v[80:83]
    ds_read_b64_tr_b16 v[32:33], v2 offset:24576
    v_fma_f32 v114, v114, v8, v9
    v_mfma_f32_16x16x32_bf16 v[80:83], v[172:175], v[44:47], v[80:83]
    ds_read_b64_tr_b16 v[34:35], v2 offset:26624
    v_fma_f32 v115, v115, v8, v9
    v_mfma_f32_16x16x32_bf16 v[84:87], v[236:239], v[44:47], v[84:87]
    ds_read_b64_tr_b16 v[36:37], v2 offset:28672
    v_cvt_pk_bf16_f32 v248, v112, v113
    v_mfma_f32_16x16x32_bf16 v[84:87], v[232:235], v[40:43], v[84:87]
    ds_read_b64_tr_b16 v[38:39], v2 offset:30720
    v_mfma_f32_16x16x32_bf16 v[88:91], v[168:171], v[48:51], v[88:91]
    ds_read_b64_tr_b16 v[40:41], v3 offset:24576
    v_cvt_pk_bf16_f32 v249, v114, v115
    v_fma_f32 v116, v116, v8, v9
    v_mfma_f32_16x16x32_bf16 v[88:91], v[172:175], v[52:55], v[88:91]
    ds_read_b64_tr_b16 v[42:43], v3 offset:26624
    v_mfma_f32_16x16x32_bf16 v[92:95], v[236:239], v[52:55], v[92:95]
    ds_read_b64_tr_b16 v[44:45], v3 offset:28672
    v_fma_f32 v117, v117, v8, v9
    v_fma_f32 v118, v118, v8, v9
    v_mfma_f32_16x16x32_bf16 v[92:95], v[232:235], v[48:51], v[92:95]
    ds_read_b64_tr_b16 v[46:47], v3 offset:30720
    s_waitcnt lgkmcnt(4)
    v_mfma_f32_16x16x32_bf16 v[64:67], v[176:179], v[24:27], v[64:67]
    ds_read_b64_tr_b16 v[48:49], v4 offset:24576
    v_fma_f32 v119, v119, v8, v9
    v_cvt_pk_bf16_f32 v250, v116, v117
    v_mfma_f32_16x16x32_bf16 v[64:67], v[180:183], v[28:31], v[64:67]
    ds_read_b64_tr_b16 v[50:51], v4 offset:26624
    v_mfma_f32_16x16x32_bf16 v[68:71], v[244:247], v[28:31], v[68:71]
    ds_read_b64_tr_b16 v[52:53], v4 offset:28672
    v_cvt_pk_bf16_f32 v251, v118, v119
    v_fma_f32 v120, v120, v8, v9
    v_mfma_f32_16x16x32_bf16 v[68:71], v[240:243], v[24:27], v[68:71]
    ds_read_b64_tr_b16 v[54:55], v4 offset:30720
    v_mfma_f32_16x16x32_bf16 v[72:75], v[176:179], v[32:35], v[72:75]
    ds_read_b64_tr_b16 v[24:25], v1 offset:32768
    v_fma_f32 v121, v121, v8, v9
    v_fma_f32 v122, v122, v8, v9
    v_mfma_f32_16x16x32_bf16 v[72:75], v[180:183], v[36:39], v[72:75]
    ds_read_b64_tr_b16 v[26:27], v1 offset:34816
    v_mfma_f32_16x16x32_bf16 v[76:79], v[244:247], v[36:39], v[76:79]
    ds_read_b64_tr_b16 v[28:29], v1 offset:36864
    v_fma_f32 v123, v123, v8, v9
    v_cvt_pk_bf16_f32 v252, v120, v121
    v_mfma_f32_16x16x32_bf16 v[76:79], v[240:243], v[32:35], v[76:79]
    ds_read_b64_tr_b16 v[30:31], v1 offset:38912
    s_waitcnt lgkmcnt(4)
    v_mfma_f32_16x16x32_bf16 v[80:83], v[176:179], v[40:43], v[80:83]
    ds_read_b64_tr_b16 v[32:33], v2 offset:32768
    v_cvt_pk_bf16_f32 v253, v122, v123
    v_fma_f32 v124, v124, v8, v9
    v_mfma_f32_16x16x32_bf16 v[80:83], v[180:183], v[44:47], v[80:83]
    ds_read_b64_tr_b16 v[34:35], v2 offset:34816
    v_mfma_f32_16x16x32_bf16 v[84:87], v[244:247], v[44:47], v[84:87]
    ds_read_b64_tr_b16 v[36:37], v2 offset:36864
    v_fma_f32 v125, v125, v8, v9
    v_fma_f32 v126, v126, v8, v9
    v_mfma_f32_16x16x32_bf16 v[84:87], v[240:243], v[40:43], v[84:87]
    ds_read_b64_tr_b16 v[38:39], v2 offset:38912
    v_mfma_f32_16x16x32_bf16 v[88:91], v[176:179], v[48:51], v[88:91]
    ds_read_b64_tr_b16 v[40:41], v3 offset:32768
    v_fma_f32 v127, v127, v8, v9
    v_cvt_pk_bf16_f32 v254, v124, v125
    v_mfma_f32_16x16x32_bf16 v[88:91], v[180:183], v[52:55], v[88:91]
    ds_read_b64_tr_b16 v[42:43], v3 offset:34816
    v_mfma_f32_16x16x32_bf16 v[92:95], v[244:247], v[52:55], v[92:95]
    ds_read_b64_tr_b16 v[44:45], v3 offset:36864
    v_cvt_pk_bf16_f32 v255, v126, v127
    v_mfma_f32_16x16x32_bf16 v[92:95], v[240:243], v[48:51], v[92:95]
    ds_read_b64_tr_b16 v[46:47], v3 offset:38912
    s_waitcnt lgkmcnt(4)
    v_mfma_f32_16x16x32_bf16 v[64:67], v[184:187], v[24:27], v[64:67]
    ds_read_b64_tr_b16 v[48:49], v4 offset:32768
    v_mfma_f32_16x16x32_bf16 v[64:67], v[188:191], v[28:31], v[64:67]
    ds_read_b64_tr_b16 v[50:51], v4 offset:34816
    v_mfma_f32_16x16x32_bf16 v[68:71], v[252:255], v[28:31], v[68:71]
    ds_read_b64_tr_b16 v[52:53], v4 offset:36864
    v_mfma_f32_16x16x32_bf16 v[68:71], v[248:251], v[24:27], v[68:71]
    ds_read_b64_tr_b16 v[54:55], v4 offset:38912
    v_mfma_f32_16x16x32_bf16 v[72:75], v[184:187], v[32:35], v[72:75]
    ds_read_b64_tr_b16 v[24:25], v1 offset:40960
    v_mfma_f32_16x16x32_bf16 v[72:75], v[188:191], v[36:39], v[72:75]
    ds_read_b64_tr_b16 v[26:27], v1 offset:43008
    v_mfma_f32_16x16x32_bf16 v[76:79], v[252:255], v[36:39], v[76:79]
    ds_read_b64_tr_b16 v[28:29], v1 offset:45056
    v_mfma_f32_16x16x32_bf16 v[76:79], v[248:251], v[32:35], v[76:79]
    ds_read_b64_tr_b16 v[30:31], v1 offset:47104
    s_waitcnt lgkmcnt(4)
    v_mfma_f32_16x16x32_bf16 v[80:83], v[184:187], v[40:43], v[80:83]
    ds_read_b64_tr_b16 v[32:33], v1 offset:49152
    v_mfma_f32_16x16x32_bf16 v[80:83], v[188:191], v[44:47], v[80:83]
    ds_read_b64_tr_b16 v[34:35], v1 offset:51200
    v_mfma_f32_16x16x32_bf16 v[84:87], v[252:255], v[44:47], v[84:87]
    ds_read_b64_tr_b16 v[36:37], v1 offset:53248
    v_mfma_f32_16x16x32_bf16 v[84:87], v[248:251], v[40:43], v[84:87]
    ds_read_b64_tr_b16 v[38:39], v1 offset:55296
    v_mfma_f32_16x16x32_bf16 v[88:91], v[184:187], v[48:51], v[88:91]
    s_barrier
    ds_read_b64_tr_b16 v[40:41], v1 offset:57344
    v_mfma_f32_16x16x32_bf16 v[88:91], v[188:191], v[52:55], v[88:91]
    ds_read_b64_tr_b16 v[42:43], v1 offset:59392
    v_mfma_f32_16x16x32_bf16 v[92:95], v[252:255], v[52:55], v[92:95]
    ds_read_b64_tr_b16 v[44:45], v1 offset:61440
    v_mfma_f32_16x16x32_bf16 v[92:95], v[248:251], v[48:51], v[92:95]
    ds_read_b64_tr_b16 v[46:47], v1 offset:63488
    s_waitcnt lgkmcnt(4)
    v_mfma_f32_16x16x32_bf16 v[96:99], v[128:131], v[24:27], 0
    v_add_u32 v1, 0x10000, v1
    ds_read_b64_tr_b16 v[48:49], v1 offset:0
    v_mfma_f32_16x16x32_bf16 v[96:99], v[132:135], v[28:31], v[96:99]
    ds_read_b64_tr_b16 v[50:51], v1 offset:2048
    v_mfma_f32_16x16x32_bf16 v[100:103], v[196:199], v[28:31], 0
    ds_read_b64_tr_b16 v[52:53], v1 offset:4096
    buffer_load_dword v10, off, s[72:75], 0 sc1
    v_exp_f32_e64 v12, v68 clamp
    v_mfma_f32_16x16x32_bf16 v[100:103], v[192:195], v[24:27], v[100:103]
    ds_read_b64_tr_b16 v[54:55], v1 offset:6144
    v_exp_f32_e64 v13, v69 clamp
    v_mfma_f32_16x16x32_bf16 v[100:103], v[200:203], v[32:35], v[100:103]
    ds_read_b64_tr_b16 v[24:25], v2 offset:40960
    v_exp_f32_e64 v14, v70 clamp
    v_mfma_f32_16x16x32_bf16 v[100:103], v[204:207], v[36:39], v[100:103]
    ds_read_b64_tr_b16 v[26:27], v2 offset:43008
    v_mfma_f32_16x16x32_bf16 v[96:99], v[140:143], v[36:39], v[96:99]
    ds_read_b64_tr_b16 v[28:29], v2 offset:45056
    v_exp_f32_e64 v15, v71 clamp
    v_mfma_f32_16x16x32_bf16 v[96:99], v[136:139], v[32:35], v[96:99]
    ds_read_b64_tr_b16 v[30:31], v2 offset:47104
    v_max_f32 v68, s77, v68
    s_waitcnt lgkmcnt(4)
    v_mfma_f32_16x16x32_bf16 v[96:99], v[144:147], v[40:43], v[96:99]
    ds_read_b64_tr_b16 v[32:33], v2 offset:49152
    v_max_f32 v69, s77, v69
    v_mfma_f32_16x16x32_bf16 v[96:99], v[148:151], v[44:47], v[96:99]
    ds_read_b64_tr_b16 v[34:35], v2 offset:51200
    v_max_f32 v70, s77, v70
    v_max_f32 v71, s77, v71
    v_mfma_f32_16x16x32_bf16 v[100:103], v[212:215], v[44:47], v[100:103]
    ds_read_b64_tr_b16 v[36:37], v2 offset:53248
    v_fmac_f32 v12, s76, v68
    v_mfma_f32_16x16x32_bf16 v[100:103], v[208:211], v[40:43], v[100:103]
    ds_read_b64_tr_b16 v[38:39], v2 offset:55296
    v_fmac_f32 v13, s76, v69
    v_fmac_f32 v14, s76, v70
    v_mfma_f32_16x16x32_bf16 v[100:103], v[216:219], v[48:51], v[100:103]
    ds_read_b64_tr_b16 v[40:41], v2 offset:57344
    v_fmac_f32 v15, s76, v71
    v_mfma_f32_16x16x32_bf16 v[100:103], v[220:223], v[52:55], v[100:103]
    ds_read_b64_tr_b16 v[42:43], v2 offset:59392
    v_cvt_pk_bf16_f32 v70, v12, v13
    v_mfma_f32_16x16x32_bf16 v[96:99], v[156:159], v[52:55], v[96:99]
    ds_read_b64_tr_b16 v[44:45], v2 offset:61440
    v_cvt_pk_bf16_f32 v71, v14, v15
    v_exp_f32_e64 v16, v64 clamp
    v_mfma_f32_16x16x32_bf16 v[96:99], v[152:155], v[48:51], v[96:99]
    ds_read_b64_tr_b16 v[46:47], v2 offset:63488
    s_waitcnt lgkmcnt(4)
    v_mfma_f32_16x16x32_bf16 v[104:107], v[128:131], v[24:27], 0
    v_add_u32 v2, 0x10000, v2
    ds_read_b64_tr_b16 v[48:49], v2 offset:0
    v_exp_f32_e64 v17, v65 clamp
    v_mfma_f32_16x16x32_bf16 v[104:107], v[132:135], v[28:31], v[104:107]
    ds_read_b64_tr_b16 v[50:51], v2 offset:2048
    v_exp_f32_e64 v18, v66 clamp
    v_mfma_f32_16x16x32_bf16 v[108:111], v[196:199], v[28:31], 0
    ds_read_b64_tr_b16 v[52:53], v2 offset:4096
    v_mfma_f32_16x16x32_bf16 v[108:111], v[192:195], v[24:27], v[108:111]
    ds_read_b64_tr_b16 v[54:55], v2 offset:6144
    v_exp_f32_e64 v19, v67 clamp
    v_mfma_f32_16x16x32_bf16 v[108:111], v[200:203], v[32:35], v[108:111]
    ds_read_b64_tr_b16 v[24:25], v3 offset:40960
    v_max_f32 v64, s77, v64
    v_mfma_f32_16x16x32_bf16 v[108:111], v[204:207], v[36:39], v[108:111]
    ds_read_b64_tr_b16 v[26:27], v3 offset:43008
    v_max_f32 v65, s77, v65
    v_max_f32 v66, s77, v66
    v_mfma_f32_16x16x32_bf16 v[104:107], v[140:143], v[36:39], v[104:107]
    ds_read_b64_tr_b16 v[28:29], v3 offset:45056
    v_max_f32 v67, s77, v67
    v_mfma_f32_16x16x32_bf16 v[104:107], v[136:139], v[32:35], v[104:107]
    ds_read_b64_tr_b16 v[30:31], v3 offset:47104
    v_fmac_f32 v16, s76, v64
    v_fmac_f32 v17, s76, v65
    s_waitcnt lgkmcnt(4)
    v_mfma_f32_16x16x32_bf16 v[104:107], v[144:147], v[40:43], v[104:107]
    ds_read_b64_tr_b16 v[32:33], v3 offset:49152
    v_fmac_f32 v18, s76, v66
    v_mfma_f32_16x16x32_bf16 v[104:107], v[148:151], v[44:47], v[104:107]
    ds_read_b64_tr_b16 v[34:35], v3 offset:51200
    v_fmac_f32 v19, s76, v67
    v_mfma_f32_16x16x32_bf16 v[108:111], v[212:215], v[44:47], v[108:111]
    ds_read_b64_tr_b16 v[36:37], v3 offset:53248
    v_cvt_pk_bf16_f32 v68, v16, v17
    v_cvt_pk_bf16_f32 v69, v18, v19
    v_mfma_f32_16x16x32_bf16 v[108:111], v[208:211], v[40:43], v[108:111]
    ds_read_b64_tr_b16 v[38:39], v3 offset:55296
    v_exp_f32_e64 v12, v76 clamp
    v_mfma_f32_16x16x32_bf16 v[108:111], v[216:219], v[48:51], v[108:111]
    ds_read_b64_tr_b16 v[40:41], v3 offset:57344
    v_exp_f32_e64 v13, v77 clamp
    v_mfma_f32_16x16x32_bf16 v[108:111], v[220:223], v[52:55], v[108:111]
    ds_read_b64_tr_b16 v[42:43], v3 offset:59392
    v_mfma_f32_16x16x32_bf16 v[104:107], v[156:159], v[52:55], v[104:107]
    ds_read_b64_tr_b16 v[44:45], v3 offset:61440
    v_exp_f32_e64 v14, v78 clamp
    v_mfma_f32_16x16x32_bf16 v[104:107], v[152:155], v[48:51], v[104:107]
    ds_read_b64_tr_b16 v[46:47], v3 offset:63488
    v_exp_f32_e64 v15, v79 clamp
    s_waitcnt lgkmcnt(4)
    v_mfma_f32_16x16x32_bf16 v[112:115], v[128:131], v[24:27], 0
    v_add_u32 v3, 0x10000, v3
    ds_read_b64_tr_b16 v[48:49], v3 offset:0
    v_mfma_f32_16x16x32_bf16 v[112:115], v[132:135], v[28:31], v[112:115]
    ds_read_b64_tr_b16 v[50:51], v3 offset:2048
    v_max_f32 v76, s77, v76
    v_max_f32 v77, s77, v77
    v_mfma_f32_16x16x32_bf16 v[116:119], v[196:199], v[28:31], 0
    ds_read_b64_tr_b16 v[52:53], v3 offset:4096
    v_max_f32 v78, s77, v78
    v_mfma_f32_16x16x32_bf16 v[116:119], v[192:195], v[24:27], v[116:119]
    ds_read_b64_tr_b16 v[54:55], v3 offset:6144
    v_max_f32 v79, s77, v79
    v_mfma_f32_16x16x32_bf16 v[116:119], v[200:203], v[32:35], v[116:119]
    ds_read_b64_tr_b16 v[24:25], v4 offset:40960
    v_fmac_f32 v12, s76, v76
    v_fmac_f32 v13, s76, v77
    v_mfma_f32_16x16x32_bf16 v[116:119], v[204:207], v[36:39], v[116:119]
    ds_read_b64_tr_b16 v[26:27], v4 offset:43008
    v_fmac_f32 v14, s76, v78
    v_mfma_f32_16x16x32_bf16 v[112:115], v[140:143], v[36:39], v[112:115]
    s_branch L_pg1188x
L_pg1188:
    s_setpc_b64 s[30:31]
L_pg1188x:
    ds_read_b64_tr_b16 v[28:29], v4 offset:45056
    v_fmac_f32 v15, s76, v79
    v_cvt_pk_bf16_f32 v78, v12, v13
    v_mfma_f32_16x16x32_bf16 v[112:115], v[136:139], v[32:35], v[112:115]
    ds_read_b64_tr_b16 v[30:31], v4 offset:47104
    v_cvt_pk_bf16_f32 v79, v14, v15
    s_waitcnt lgkmcnt(4)
    v_mfma_f32_16x16x32_bf16 v[112:115], v[144:147], v[40:43], v[112:115]
    ds_read_b64_tr_b16 v[32:33], v4 offset:49152
    v_exp_f32_e64 v16, v72 clamp
    v_mfma_f32_16x16x32_bf16 v[112:115], v[148:151], v[44:47], v[112:115]
    ds_read_b64_tr_b16 v[34:35], v4 offset:51200
    v_exp_f32_e64 v17, v73 clamp
    v_mfma_f32_16x16x32_bf16 v[116:119], v[212:215], v[44:47], v[116:119]
    ds_read_b64_tr_b16 v[36:37], v4 offset:53248
    v_mfma_f32_16x16x32_bf16 v[116:119], v[208:211], v[40:43], v[116:119]
    ds_read_b64_tr_b16 v[38:39], v4 offset:55296
    v_exp_f32_e64 v18, v74 clamp
    v_mfma_f32_16x16x32_bf16 v[116:119], v[216:219], v[48:51], v[116:119]
    ds_read_b64_tr_b16 v[40:41], v4 offset:57344
    v_exp_f32_e64 v19, v75 clamp
    v_mfma_f32_16x16x32_bf16 v[116:119], v[220:223], v[52:55], v[116:119]
    ds_read_b64_tr_b16 v[42:43], v4 offset:59392
    v_max_f32 v72, s77, v72
    v_mfma_f32_16x16x32_bf16 v[112:115], v[156:159], v[52:55], v[112:115]
    ds_read_b64_tr_b16 v[44:45], v4 offset:61440
    v_max_f32 v73, s77, v73
    v_mfma_f32_16x16x32_bf16 v[112:115], v[152:155], v[48:51], v[112:115]
    ds_read_b64_tr_b16 v[46:47], v4 offset:63488
    v_max_f32 v74, s77, v74
    s_waitcnt lgkmcnt(4)
    v_mfma_f32_16x16x32_bf16 v[120:123], v[128:131], v[24:27], 0
    v_add_u32 v4, 0x10000, v4
    ds_read_b64_tr_b16 v[48:49], v4 offset:0
    v_max_f32 v75, s77, v75
    v_fmac_f32 v16, s76, v72
    v_mfma_f32_16x16x32_bf16 v[120:123], v[132:135], v[28:31], v[120:123]
    ds_read_b64_tr_b16 v[50:51], v4 offset:2048
    v_fmac_f32 v17, s76, v73
    v_mfma_f32_16x16x32_bf16 v[124:127], v[196:199], v[28:31], 0
    ds_read_b64_tr_b16 v[52:53], v4 offset:4096
    v_fmac_f32 v18, s76, v74
    v_fmac_f32 v19, s76, v75
    v_mfma_f32_16x16x32_bf16 v[124:127], v[192:195], v[24:27], v[124:127]
    ds_read_b64_tr_b16 v[54:55], v4 offset:6144
    v_cvt_pk_bf16_f32 v76, v16, v17
    v_mfma_f32_16x16x32_bf16 v[124:127], v[200:203], v[32:35], v[124:127]
    ds_read_b64_tr_b16 v[24:25], v1 offset:8192
    v_cvt_pk_bf16_f32 v77, v18, v19
    v_mfma_f32_16x16x32_bf16 v[124:127], v[204:207], v[36:39], v[124:127]
    ds_read_b64_tr_b16 v[26:27], v1 offset:10240
    v_mfma_f32_16x16x32_bf16 v[64:67], v[20:23], v[68:71], 0
    v_mfma_f32_16x16x32_bf16 v[120:123], v[140:143], v[36:39], v[120:123]
    ds_read_b64_tr_b16 v[28:29], v1 offset:12288
    v_exp_f32_e64 v12, v84 clamp
    v_mfma_f32_16x16x32_bf16 v[120:123], v[136:139], v[32:35], v[120:123]
    ds_read_b64_tr_b16 v[30:31], v1 offset:14336
    v_exp_f32_e64 v13, v85 clamp
    s_waitcnt lgkmcnt(4)
    v_mfma_f32_16x16x32_bf16 v[120:123], v[144:147], v[40:43], v[120:123]
    ds_read_b64_tr_b16 v[32:33], v1 offset:16384
    v_mfma_f32_16x16x32_bf16 v[120:123], v[148:151], v[44:47], v[120:123]
    ds_read_b64_tr_b16 v[34:35], v1 offset:18432
    v_exp_f32_e64 v14, v86 clamp
    v_mfma_f32_16x16x32_bf16 v[124:127], v[212:215], v[44:47], v[124:127]
    ds_read_b64_tr_b16 v[36:37], v1 offset:20480
    v_exp_f32_e64 v15, v87 clamp
    v_mfma_f32_16x16x32_bf16 v[124:127], v[208:211], v[40:43], v[124:127]
    ds_read_b64_tr_b16 v[38:39], v1 offset:22528
    v_mfma_f32_16x16x32_bf16 v[124:127], v[216:219], v[48:51], v[124:127]
    s_barrier
    ds_read_b64_tr_b16 v[40:41], v1 offset:24576
    v_max_f32 v84, s77, v84
    v_max_f32 v85, s77, v85
    v_mfma_f32_16x16x32_bf16 v[124:127], v[220:223], v[52:55], v[124:127]
    ds_read_b64_tr_b16 v[42:43], v1 offset:26624
    v_max_f32 v86, s77, v86
    v_mfma_f32_16x16x32_bf16 v[120:123], v[156:159], v[52:55], v[120:123]
    ds_read_b64_tr_b16 v[44:45], v1 offset:28672
    v_max_f32 v87, s77, v87
    v_mfma_f32_16x16x32_bf16 v[120:123], v[152:155], v[48:51], v[120:123]
    ds_read_b64_tr_b16 v[46:47], v1 offset:30720
    v_fmac_f32 v12, s76, v84
    v_fmac_f32 v13, s76, v85
    s_waitcnt lgkmcnt(4)
    v_mfma_f32_16x16x32_bf16 v[96:99], v[160:163], v[24:27], v[96:99]
    ds_read_b64_tr_b16 v[48:49], v1 offset:32768
    v_fmac_f32 v14, s76, v86
    v_mfma_f32_16x16x32_bf16 v[96:99], v[164:167], v[28:31], v[96:99]
    ds_read_b64_tr_b16 v[50:51], v1 offset:34816
    v_fmac_f32 v15, s76, v87
    v_cvt_pk_bf16_f32 v86, v12, v13
    v_mfma_f32_16x16x32_bf16 v[100:103], v[228:231], v[28:31], v[100:103]
    ds_read_b64_tr_b16 v[52:53], v1 offset:36864
    v_cvt_pk_bf16_f32 v87, v14, v15
    v_mfma_f32_16x16x32_bf16 v[100:103], v[224:227], v[24:27], v[100:103]
    ds_read_b64_tr_b16 v[54:55], v1 offset:38912
    v_exp_f32_e64 v16, v80 clamp
    v_mfma_f32_16x16x32_bf16 v[100:103], v[232:235], v[32:35], v[100:103]
    ds_read_b64_tr_b16 v[24:25], v2 offset:8192
    v_exp_f32_e64 v17, v81 clamp
    v_mfma_f32_16x16x32_bf16 v[100:103], v[236:239], v[36:39], v[100:103]
    ds_read_b64_tr_b16 v[26:27], v2 offset:10240
    v_mfma_f32_16x16x32_bf16 v[96:99], v[172:175], v[36:39], v[96:99]
    ds_read_b64_tr_b16 v[28:29], v2 offset:12288
    v_exp_f32_e64 v18, v82 clamp
    v_mfma_f32_16x16x32_bf16 v[96:99], v[168:171], v[32:35], v[96:99]
    ds_read_b64_tr_b16 v[30:31], v2 offset:14336
    v_exp_f32_e64 v19, v83 clamp
    s_waitcnt lgkmcnt(4)
    v_mfma_f32_16x16x32_bf16 v[96:99], v[176:179], v[40:43], v[96:99]
    ds_read_b64_tr_b16 v[32:33], v2 offset:16384
    v_max_f32 v80, s77, v80
    v_mfma_f32_16x16x32_bf16 v[96:99], v[180:183], v[44:47], v[96:99]
    ds_read_b64_tr_b16 v[34:35], v2 offset:18432
    v_max_f32 v81, s77, v81
    v_mfma_f32_16x16x32_bf16 v[100:103], v[244:247], v[44:47], v[100:103]
    ds_read_b64_tr_b16 v[36:37], v2 offset:20480
    v_max_f32 v82, s77, v82
    v_mfma_f32_16x16x32_bf16 v[100:103], v[240:243], v[40:43], v[100:103]
    ds_read_b64_tr_b16 v[38:39], v2 offset:22528
    v_max_f32 v83, s77, v83
    v_fmac_f32 v16, s76, v80
    v_mfma_f32_16x16x32_bf16 v[100:103], v[248:251], v[48:51], v[100:103]
    ds_read_b64_tr_b16 v[40:41], v2 offset:24576
    v_fmac_f32 v17, s76, v81
    v_mfma_f32_16x16x32_bf16 v[100:103], v[252:255], v[52:55], v[100:103]
    ds_read_b64_tr_b16 v[42:43], v2 offset:26624
    v_fmac_f32 v18, s76, v82
    v_fmac_f32 v19, s76, v83
    v_mfma_f32_16x16x32_bf16 v[96:99], v[188:191], v[52:55], v[96:99]
    ds_read_b64_tr_b16 v[44:45], v2 offset:28672
    v_cvt_pk_bf16_f32 v84, v16, v17
    v_mfma_f32_16x16x32_bf16 v[96:99], v[184:187], v[48:51], v[96:99]
    ds_read_b64_tr_b16 v[46:47], v2 offset:30720
    v_cvt_pk_bf16_f32 v85, v18, v19
    s_waitcnt lgkmcnt(4)
    v_mfma_f32_16x16x32_bf16 v[104:107], v[160:163], v[24:27], v[104:107]
    ds_read_b64_tr_b16 v[48:49], v2 offset:32768
    v_mfma_f32_16x16x32_bf16 v[72:75], v[20:23], v[76:79], 0
    v_mfma_f32_16x16x32_bf16 v[104:107], v[164:167], v[28:31], v[104:107]
    ds_read_b64_tr_b16 v[50:51], v2 offset:34816
    v_exp_f32_e64 v12, v92 clamp
    v_mfma_f32_16x16x32_bf16 v[108:111], v[228:231], v[28:31], v[108:111]
    ds_read_b64_tr_b16 v[52:53], v2 offset:36864
    v_exp_f32_e64 v13, v93 clamp
    v_mfma_f32_16x16x32_bf16 v[108:111], v[224:227], v[24:27], v[108:111]
    ds_read_b64_tr_b16 v[54:55], v2 offset:38912
    v_mfma_f32_16x16x32_bf16 v[108:111], v[232:235], v[32:35], v[108:111]
    ds_read_b64_tr_b16 v[24:25], v3 offset:8192
    v_exp_f32_e64 v14, v94 clamp
    v_mfma_f32_16x16x32_bf16 v[108:111], v[236:239], v[36:39], v[108:111]
    ds_read_b64_tr_b16 v[26:27], v3 offset:10240
    v_exp_f32_e64 v15, v95 clamp
    v_mfma_f32_16x16x32_bf16 v[104:107], v[172:175], v[36:39], v[104:107]
    ds_read_b64_tr_b16 v[28:29], v3 offset:12288
    v_mfma_f32_16x16x32_bf16 v[104:107], v[168:171], v[32:35], v[104:107]
    ds_read_b64_tr_b16 v[30:31], v3 offset:14336
    v_max_f32 v92, s77, v92
    v_max_f32 v93, s77, v93
    s_waitcnt lgkmcnt(4)
    v_mfma_f32_16x16x32_bf16 v[104:107], v[176:179], v[40:43], v[104:107]
    ds_read_b64_tr_b16 v[32:33], v3 offset:16384
    v_max_f32 v94, s77, v94
    v_mfma_f32_16x16x32_bf16 v[104:107], v[180:183], v[44:47], v[104:107]
    ds_read_b64_tr_b16 v[34:35], v3 offset:18432
    v_max_f32 v95, s77, v95
    v_fmac_f32 v12, s76, v92
    v_mfma_f32_16x16x32_bf16 v[108:111], v[244:247], v[44:47], v[108:111]
    ds_read_b64_tr_b16 v[36:37], v3 offset:20480
    v_fmac_f32 v13, s76, v93
    v_mfma_f32_16x16x32_bf16 v[108:111], v[240:243], v[40:43], v[108:111]
    ds_read_b64_tr_b16 v[38:39], v3 offset:22528
    v_fmac_f32 v14, s76, v94
    v_mfma_f32_16x16x32_bf16 v[108:111], v[248:251], v[48:51], v[108:111]
    ds_read_b64_tr_b16 v[40:41], v3 offset:24576
    v_fmac_f32 v15, s76, v95
    v_cvt_pk_bf16_f32 v94, v12, v13
    v_mfma_f32_16x16x32_bf16 v[108:111], v[252:255], v[52:55], v[108:111]
    ds_read_b64_tr_b16 v[42:43], v3 offset:26624
    v_cvt_pk_bf16_f32 v95, v14, v15
    v_mfma_f32_16x16x32_bf16 v[104:107], v[188:191], v[52:55], v[104:107]
    ds_read_b64_tr_b16 v[44:45], v3 offset:28672
    v_exp_f32_e64 v16, v88 clamp
    v_mfma_f32_16x16x32_bf16 v[104:107], v[184:187], v[48:51], v[104:107]
    ds_read_b64_tr_b16 v[46:47], v3 offset:30720
    v_exp_f32_e64 v17, v89 clamp
    s_waitcnt lgkmcnt(4)
    v_mfma_f32_16x16x32_bf16 v[112:115], v[160:163], v[24:27], v[112:115]
    ds_read_b64_tr_b16 v[48:49], v3 offset:32768
    v_mfma_f32_16x16x32_bf16 v[112:115], v[164:167], v[28:31], v[112:115]
    ds_read_b64_tr_b16 v[50:51], v3 offset:34816
    v_exp_f32_e64 v18, v90 clamp
    v_mfma_f32_16x16x32_bf16 v[116:119], v[228:231], v[28:31], v[116:119]
    ds_read_b64_tr_b16 v[52:53], v3 offset:36864
    v_exp_f32_e64 v19, v91 clamp
    v_mfma_f32_16x16x32_bf16 v[116:119], v[224:227], v[24:27], v[116:119]
    ds_read_b64_tr_b16 v[54:55], v3 offset:38912
    v_max_f32 v88, s77, v88
    v_mfma_f32_16x16x32_bf16 v[116:119], v[232:235], v[32:35], v[116:119]
    ds_read_b64_tr_b16 v[24:25], v4 offset:8192
    v_max_f32 v89, s77, v89
    v_mfma_f32_16x16x32_bf16 v[116:119], v[236:239], v[36:39], v[116:119]
    ds_read_b64_tr_b16 v[26:27], v4 offset:10240
    v_max_f32 v90, s77, v90
    v_mfma_f32_16x16x32_bf16 v[112:115], v[172:175], v[36:39], v[112:115]
    ds_read_b64_tr_b16 v[28:29], v4 offset:12288
    v_max_f32 v91, s77, v91
    v_fmac_f32 v16, s76, v88
    v_mfma_f32_16x16x32_bf16 v[112:115], v[168:171], v[32:35], v[112:115]
    ds_read_b64_tr_b16 v[30:31], v4 offset:14336
    v_fmac_f32 v17, s76, v89
    s_waitcnt lgkmcnt(4)
    v_mfma_f32_16x16x32_bf16 v[112:115], v[176:179], v[40:43], v[112:115]
    ds_read_b64_tr_b16 v[32:33], v4 offset:16384
    v_fmac_f32 v18, s76, v90
    v_fmac_f32 v19, s76, v91
    v_mfma_f32_16x16x32_bf16 v[112:115], v[180:183], v[44:47], v[112:115]
    ds_read_b64_tr_b16 v[34:35], v4 offset:18432
    v_cvt_pk_bf16_f32 v92, v16, v17
    v_mfma_f32_16x16x32_bf16 v[116:119], v[244:247], v[44:47], v[116:119]
    ds_read_b64_tr_b16 v[36:37], v4 offset:20480
    v_cvt_pk_bf16_f32 v93, v18, v19
    v_mfma_f32_16x16x32_bf16 v[80:83], v[20:23], v[84:87], 0
    v_mfma_f32_16x16x32_bf16 v[116:119], v[240:243], v[40:43], v[116:119]
    ds_read_b64_tr_b16 v[38:39], v4 offset:22528
    v_mfma_f32_16x16x32_bf16 v[116:119], v[248:251], v[48:51], v[116:119]
    ds_read_b64_tr_b16 v[40:41], v4 offset:24576
    v_add_u32 v5, s97, v7
    v_mfma_f32_16x16x32_bf16 v[116:119], v[252:255], v[52:55], v[116:119]
    ds_read_b64_tr_b16 v[42:43], v4 offset:26624
    s_lshl_b32 s81, s3, 8
    v_lshrrev_b32 v13, 2, v7
    v_mfma_f32_16x16x32_bf16 v[112:115], v[188:191], v[52:55], v[112:115]
    ds_read_b64_tr_b16 v[44:45], v4 offset:28672
    v_mfma_f32_16x16x32_bf16 v[88:91], v[20:23], v[92:95], 0
    v_mfma_f32_16x16x32_bf16 v[112:115], v[184:187], v[48:51], v[112:115]
    ds_read_b64_tr_b16 v[46:47], v4 offset:30720
    v_and_b32 v14, 12, v13
    s_waitcnt lgkmcnt(4)
    v_mfma_f32_16x16x32_bf16 v[120:123], v[160:163], v[24:27], v[120:123]
    ds_read_b64_tr_b16 v[48:49], v4 offset:32768
    v_and_b32 v18, 48, v0
    v_mfma_f32_16x16x32_bf16 v[120:123], v[164:167], v[28:31], v[120:123]
    ds_read_b64_tr_b16 v[50:51], v4 offset:34816
    v_add_u32 v14, v14, v18
    v_mfma_f32_16x16x32_bf16 v[124:127], v[228:231], v[28:31], v[124:127]
    ds_read_b64_tr_b16 v[52:53], v4 offset:36864
    v_mul_u32_u24 v19, 376, v18
    v_lshl_add_u32 v19, v0, 3, v19
    v_mfma_f32_16x16x32_bf16 v[124:127], v[224:227], v[24:27], v[124:127]
    ds_read_b64_tr_b16 v[54:55], v4 offset:38912
    v_mul_u32_u24 v18, 368, v18
    v_mfma_f32_16x16x32_bf16 v[124:127], v[232:235], v[32:35], v[124:127]
    ds_read_b64_tr_b16 v[24:25], v1 offset:40960
    v_add_u32 v18, v18, v7
    v_add_u32 v13, s81, v13
    v_mfma_f32_16x16x32_bf16 v[124:127], v[236:239], v[36:39], v[124:127]
    ds_read_b64_tr_b16 v[26:27], v1 offset:43008
    s_lshl_b32 s81, s3, 6
    v_mfma_f32_16x16x32_bf16 v[120:123], v[172:175], v[36:39], v[120:123]
    ds_read_b64_tr_b16 v[28:29], v1 offset:45056
    v_add_u32 v14, s81, v14
    v_mfma_f32_16x16x32_bf16 v[120:123], v[168:171], v[32:35], v[120:123]
    ds_read_b64_tr_b16 v[30:31], v1 offset:47104
    s_lshl_b32 s81, s3, 10
    v_add_u32 v15, s81, v7
    s_waitcnt lgkmcnt(4)
    v_mfma_f32_16x16x32_bf16 v[120:123], v[176:179], v[40:43], v[120:123]
    ds_read_b64_tr_b16 v[32:33], v1 offset:49152
    v_add_u32 v16, 106496, v15
    v_mfma_f32_16x16x32_bf16 v[120:123], v[180:183], v[44:47], v[120:123]
    ds_read_b64_tr_b16 v[34:35], v1 offset:51200
    v_add_u32 v15, 98304, v15
    v_cndmask_b32 v12, v64, v72, s[82:83]
    v_mfma_f32_16x16x32_bf16 v[124:127], v[244:247], v[44:47], v[124:127]
    ds_read_b64_tr_b16 v[36:37], v1 offset:53248
    v_cndmask_b32 v12, v12, v80, s[84:85]
    v_mfma_f32_16x16x32_bf16 v[124:127], v[240:243], v[40:43], v[124:127]
    ds_read_b64_tr_b16 v[38:39], v1 offset:55296
    v_cndmask_b32 v12, v12, v88, s[86:87]
    s_waitcnt vmcnt(0)
    v_cmp_eq_u32 vcc, 0, v10
    s_cbranch_vccnz Ln_1001
Lc_1002:
    v_mfma_f32_16x16x32_bf16 v[124:127], v[248:251], v[48:51], v[124:127]
    s_barrier
    ds_read_b64_tr_b16 v[40:41], v1 offset:57344
    v_cvt_pk_bf16_f32 v96, v96, v97
    v_mfma_f32_16x16x32_bf16 v[124:127], v[252:255], v[52:55], v[124:127]
    ds_read_b64_tr_b16 v[42:43], v1 offset:59392
    v_cvt_pk_bf16_f32 v97, v98, v99
    v_mfma_f32_16x16x32_bf16 v[120:123], v[188:191], v[52:55], v[120:123]
    ds_read_b64_tr_b16 v[44:45], v1 offset:61440
    v_cvt_pk_bf16_f32 v98, v100, v101
    v_cvt_pk_bf16_f32 v99, v102, v103
    v_mfma_f32_16x16x32_bf16 v[120:123], v[184:187], v[48:51], v[120:123]
    ds_read_b64_tr_b16 v[46:47], v1 offset:63488
    v_cvt_pk_bf16_f32 v104, v104, v105
    s_waitcnt lgkmcnt(4)
    v_mfma_f32_16x16x32_bf16 v[64:67], v[24:27], v[128:131], 0
    v_add_u32 v1, 0x10000, v1
    ds_read_b64_tr_b16 v[48:49], v1 offset:0
    v_cvt_pk_bf16_f32 v105, v106, v107
    v_cvt_pk_bf16_f32 v106, v108, v109
    v_mfma_f32_16x16x32_bf16 v[64:67], v[28:31], v[132:135], v[64:67]
    ds_read_b64_tr_b16 v[50:51], v1 offset:2048
    v_cvt_pk_bf16_f32 v107, v110, v111
    v_mfma_f32_16x16x32_bf16 v[80:83], v[28:31], v[196:199], 0
    ds_read_b64_tr_b16 v[52:53], v1 offset:4096
    v_mfma_f32_16x16x32_bf16 v[100:103], v[68:71], v[96:99], 0
    v_mfma_f32_16x16x32_bf16 v[80:83], v[24:27], v[192:195], v[80:83]
    ds_read_b64_tr_b16 v[54:55], v1 offset:6144
    v_cvt_pk_bf16_f32 v112, v112, v113
    v_mfma_f32_16x16x32_bf16 v[80:83], v[32:35], v[200:203], v[80:83]
    ds_read_b64_tr_b16 v[24:25], v2 offset:40960
    v_cvt_pk_bf16_f32 v113, v114, v115
    v_mfma_f32_16x16x32_bf16 v[80:83], v[36:39], v[204:207], v[80:83]
    ds_read_b64_tr_b16 v[26:27], v2 offset:43008
    v_cvt_pk_bf16_f32 v114, v116, v117
    v_cvt_pk_bf16_f32 v115, v118, v119
    v_mfma_f32_16x16x32_bf16 v[64:67], v[36:39], v[140:143], v[64:67]
    ds_read_b64_tr_b16 v[28:29], v2 offset:45056
    v_mfma_f32_16x16x32_bf16 v[108:111], v[76:79], v[104:107], 0
    v_mfma_f32_16x16x32_bf16 v[64:67], v[32:35], v[136:139], v[64:67]
    ds_read_b64_tr_b16 v[30:31], v2 offset:47104
    s_waitcnt lgkmcnt(4)
    v_mfma_f32_16x16x32_bf16 v[64:67], v[40:43], v[144:147], v[64:67]
    ds_read_b64_tr_b16 v[32:33], v2 offset:49152
    v_cvt_pk_bf16_f32 v120, v120, v121
    v_cvt_pk_bf16_f32 v121, v122, v123
    v_mfma_f32_16x16x32_bf16 v[64:67], v[44:47], v[148:151], v[64:67]
    ds_read_b64_tr_b16 v[34:35], v2 offset:51200
    v_cvt_pk_bf16_f32 v122, v124, v125
    v_mfma_f32_16x16x32_bf16 v[80:83], v[44:47], v[212:215], v[80:83]
    ds_read_b64_tr_b16 v[36:37], v2 offset:53248
    v_cvt_pk_bf16_f32 v123, v126, v127
    v_mfma_f32_16x16x32_bf16 v[116:119], v[84:87], v[112:115], 0
    v_mfma_f32_16x16x32_bf16 v[80:83], v[40:43], v[208:211], v[80:83]
    ds_read_b64_tr_b16 v[38:39], v2 offset:55296
    v_mfma_f32_16x16x32_bf16 v[80:83], v[48:51], v[216:219], v[80:83]
    ds_read_b64_tr_b16 v[40:41], v2 offset:57344
    v_mov_b32 v17, 0xff
    v_mfma_f32_16x16x32_bf16 v[80:83], v[52:55], v[220:223], v[80:83]
    ds_read_b64_tr_b16 v[42:43], v2 offset:59392
    v_mfma_f32_16x16x32_bf16 v[124:127], v[92:95], v[120:123], 0
    v_mfma_f32_16x16x32_bf16 v[64:67], v[52:55], v[156:159], v[64:67]
    ds_read_b64_tr_b16 v[44:45], v2 offset:61440
    ds_write_b32 v13, v12 offset:0
    v_mfma_f32_16x16x32_bf16 v[64:67], v[48:51], v[152:155], v[64:67]
    ds_read_b64_tr_b16 v[46:47], v2 offset:63488
    ds_write_b128 v5, v[100:103] offset:0
    ds_write_b128 v5, v[108:111] offset:1024
    s_waitcnt lgkmcnt(7)
    v_mfma_f32_16x16x32_bf16 v[68:71], v[24:27], v[128:131], 0
    v_add_u32 v2, 0x10000, v2
    ds_read_b64_tr_b16 v[48:49], v2 offset:0
    ds_write_b128 v5, v[116:119] offset:2048
    v_mfma_f32_16x16x32_bf16 v[68:71], v[28:31], v[132:135], v[68:71]
    ds_read_b64_tr_b16 v[50:51], v2 offset:2048
    ds_write_b128 v5, v[124:127] offset:3072
    v_mfma_f32_16x16x32_bf16 v[84:87], v[28:31], v[196:199], 0
    ds_read_b64_tr_b16 v[52:53], v2 offset:4096
    v_mfma_f32_16x16x32_bf16 v[84:87], v[24:27], v[192:195], v[84:87]
    ds_read_b64_tr_b16 v[54:55], v2 offset:6144
    v_mfma_f32_16x16x32_bf16 v[84:87], v[32:35], v[200:203], v[84:87]
    ds_read_b64_tr_b16 v[24:25], v3 offset:40960
    v_mfma_f32_16x16x32_bf16 v[84:87], v[36:39], v[204:207], v[84:87]
    ds_read_b64_tr_b16 v[26:27], v3 offset:43008
    v_mfma_f32_16x16x32_bf16 v[68:71], v[36:39], v[140:143], v[68:71]
    s_waitcnt lgkmcnt(12)
    ds_read_b64_tr_b16 v[28:29], v3 offset:45056
    v_mfma_f32_16x16x32_bf16 v[68:71], v[32:35], v[136:139], v[68:71]
    ds_read_b64_tr_b16 v[30:31], v3 offset:47104
    s_waitcnt lgkmcnt(4)
    v_mfma_f32_16x16x32_bf16 v[68:71], v[40:43], v[144:147], v[68:71]
    ds_read_b64_tr_b16 v[32:33], v3 offset:49152
    v_mfma_f32_16x16x32_bf16 v[68:71], v[44:47], v[148:151], v[68:71]
    ds_read_b64_tr_b16 v[34:35], v3 offset:51200
    v_mfma_f32_16x16x32_bf16 v[84:87], v[44:47], v[212:215], v[84:87]
    ds_read_b64_tr_b16 v[36:37], v3 offset:53248
    v_mfma_f32_16x16x32_bf16 v[84:87], v[40:43], v[208:211], v[84:87]
    ds_read_b64_tr_b16 v[38:39], v3 offset:55296
    s_barrier
    ds_read_b128 v[96:99], v15 offset:0
    ds_read_b128 v[100:103], v15 offset:4096
    v_mfma_f32_16x16x32_bf16 v[84:87], v[48:51], v[216:219], v[84:87]
    ds_read_b64_tr_b16 v[40:41], v3 offset:57344
    ds_read_b128 v[104:107], v16 offset:0
    v_mfma_f32_16x16x32_bf16 v[84:87], v[52:55], v[220:223], v[84:87]
    ds_read_b64_tr_b16 v[42:43], v3 offset:59392
    ds_read_b128 v[108:111], v16 offset:4096
    v_mfma_f32_16x16x32_bf16 v[68:71], v[52:55], v[156:159], v[68:71]
    ds_read_b64_tr_b16 v[44:45], v3 offset:61440
    s_waitcnt lgkmcnt(12)
    ds_read_b32 v112, v14 offset:0
    v_mfma_f32_16x16x32_bf16 v[68:71], v[48:51], v[152:155], v[68:71]
    ds_read_b64_tr_b16 v[46:47], v3 offset:63488
    ds_read_b32 v113, v14 offset:256
    s_waitcnt lgkmcnt(10)
    v_mfma_f32_16x16x32_bf16 v[72:75], v[24:27], v[128:131], 0
    v_add_u32 v3, 0x10000, v3
    ds_read_b64_tr_b16 v[48:49], v3 offset:0
    ds_read_b32 v114, v14 offset:512
    ds_read_b32 v115, v14 offset:768
    v_mfma_f32_16x16x32_bf16 v[72:75], v[28:31], v[132:135], v[72:75]
    ds_read_b64_tr_b16 v[50:51], v3 offset:2048
    v_mfma_f32_16x16x32_bf16 v[88:91], v[28:31], v[196:199], 0
    ds_read_b64_tr_b16 v[52:53], v3 offset:4096
    v_mfma_f32_16x16x32_bf16 v[88:91], v[24:27], v[192:195], v[88:91]
    s_waitcnt lgkmcnt(12)
    ds_read_b64_tr_b16 v[54:55], v3 offset:6144
    v_mfma_f32_16x16x32_bf16 v[88:91], v[32:35], v[200:203], v[88:91]
    ds_read_b64_tr_b16 v[24:25], v4 offset:40960
    v_mfma_f32_16x16x32_bf16 v[88:91], v[36:39], v[204:207], v[88:91]
    ds_read_b64_tr_b16 v[26:27], v4 offset:43008
    v_mfma_f32_16x16x32_bf16 v[72:75], v[36:39], v[140:143], v[72:75]
    s_waitcnt lgkmcnt(12)
    ds_read_b64_tr_b16 v[28:29], v4 offset:45056
    v_mfma_f32_16x16x32_bf16 v[72:75], v[32:35], v[136:139], v[72:75]
    ds_read_b64_tr_b16 v[30:31], v4 offset:47104
    v_add_f32 v96, v96, v100
    v_add_f32 v97, v97, v101
    v_add_f32 v98, v98, v102
    s_waitcnt lgkmcnt(4)
    v_mfma_f32_16x16x32_bf16 v[72:75], v[40:43], v[144:147], v[72:75]
    ds_read_b64_tr_b16 v[32:33], v4 offset:49152
    v_add_f32 v99, v99, v103
    v_mfma_f32_16x16x32_bf16 v[72:75], v[44:47], v[148:151], v[72:75]
    ds_read_b64_tr_b16 v[34:35], v4 offset:51200
    v_add_f32 v112, v112, v113
    v_mfma_f32_16x16x32_bf16 v[88:91], v[44:47], v[212:215], v[88:91]
    ds_read_b64_tr_b16 v[36:37], v4 offset:53248
    v_add_f32 v96, v96, v104
    v_mfma_f32_16x16x32_bf16 v[88:91], v[40:43], v[208:211], v[88:91]
    ds_read_b64_tr_b16 v[38:39], v4 offset:55296
    v_add_f32 v97, v97, v105
    v_mfma_f32_16x16x32_bf16 v[88:91], v[48:51], v[216:219], v[88:91]
    ds_read_b64_tr_b16 v[40:41], v4 offset:57344
    v_add_f32 v98, v98, v106
    v_mfma_f32_16x16x32_bf16 v[88:91], v[52:55], v[220:223], v[88:91]
    ds_read_b64_tr_b16 v[42:43], v4 offset:59392
    v_add_f32 v99, v99, v107
    v_add_f32 v112, v112, v114
    v_mfma_f32_16x16x32_bf16 v[72:75], v[52:55], v[156:159], v[72:75]
    ds_read_b64_tr_b16 v[44:45], v4 offset:61440
    v_add_f32 v96, v96, v108
    v_mfma_f32_16x16x32_bf16 v[72:75], v[48:51], v[152:155], v[72:75]
    ds_read_b64_tr_b16 v[46:47], v4 offset:63488
    v_add_f32 v97, v97, v109
    s_waitcnt lgkmcnt(4)
    v_mfma_f32_16x16x32_bf16 v[76:79], v[24:27], v[128:131], 0
    v_add_u32 v4, 0x10000, v4
    ds_read_b64_tr_b16 v[48:49], v4 offset:0
    v_add_f32 v98, v98, v110
    v_mfma_f32_16x16x32_bf16 v[76:79], v[28:31], v[132:135], v[76:79]
    ds_read_b64_tr_b16 v[50:51], v4 offset:2048
    v_add_f32 v99, v99, v111
    v_mfma_f32_16x16x32_bf16 v[92:95], v[28:31], v[196:199], 0
    ds_read_b64_tr_b16 v[52:53], v4 offset:4096
    v_add_f32 v112, v112, v115
    v_mfma_f32_16x16x32_bf16 v[92:95], v[24:27], v[192:195], v[92:95]
    ds_read_b64_tr_b16 v[54:55], v4 offset:6144
    v_bfi_b32 v96, v17, v10, v96
    v_mfma_f32_16x16x32_bf16 v[92:95], v[32:35], v[200:203], v[92:95]
    ds_read_b64_tr_b16 v[24:25], v1 offset:8192
    v_bfi_b32 v112, v17, v10, v112
    v_mov_b32 v113, v112
    v_mfma_f32_16x16x32_bf16 v[92:95], v[36:39], v[204:207], v[92:95]
    ds_read_b64_tr_b16 v[26:27], v1 offset:10240
    buffer_store_dwordx4 v[96:99], v18, s[64:67], s80 offen sc1
    v_mfma_f32_16x16x32_bf16 v[76:79], v[36:39], v[140:143], v[76:79]
    ds_read_b64_tr_b16 v[28:29], v1 offset:12288
    buffer_store_dwordx2 v[112:113], v19, s[64:67], s80 offen offset:256 sc1
    v_mfma_f32_16x16x32_bf16 v[76:79], v[32:35], v[136:139], v[76:79]
    ds_read_b64_tr_b16 v[30:31], v1 offset:14336
    v_bfe_u32 v9, v0, 4, 1
    s_waitcnt lgkmcnt(4)
    v_mfma_f32_16x16x32_bf16 v[76:79], v[40:43], v[144:147], v[76:79]
    ds_read_b64_tr_b16 v[32:33], v1 offset:16384
    v_lshrrev_b32 v8, 5, v0
    v_mfma_f32_16x16x32_bf16 v[76:79], v[44:47], v[148:151], v[76:79]
    ds_read_b64_tr_b16 v[34:35], v1 offset:18432
    v_lshl_add_u32 v8, v9, 1, v8
    v_mfma_f32_16x16x32_bf16 v[92:95], v[44:47], v[212:215], v[92:95]
    ds_read_b64_tr_b16 v[36:37], v1 offset:20480
    v_lshlrev_b32 v8, 4, v8
    v_mfma_f32_16x16x32_bf16 v[92:95], v[40:43], v[208:211], v[92:95]
    ds_read_b64_tr_b16 v[38:39], v1 offset:22528
    v_and_b32 v9, 15, v0
    v_lshl_add_u32 v8, v9, 10, v8
    v_mfma_f32_16x16x32_bf16 v[92:95], v[48:51], v[216:219], v[92:95]
    s_barrier
    v_add_u32 v1, 0xfffe0000, v1
    ds_read_b64_tr_b16 v[40:41], v1 offset:0
    v_lshrrev_b32 v9, 5, v0
    v_mfma_f32_16x16x32_bf16 v[92:95], v[52:55], v[220:223], v[92:95]
    ds_read_b64_tr_b16 v[42:43], v1 offset:2048
    v_bfe_u32 v20, v0, 4, 1
    v_mfma_f32_16x16x32_bf16 v[76:79], v[52:55], v[156:159], v[76:79]
    ds_read_b64_tr_b16 v[44:45], v1 offset:4096
    v_sub_u32 v9, v9, v20
    v_mfma_f32_16x16x32_bf16 v[76:79], v[48:51], v[152:155], v[76:79]
    ds_read_b64_tr_b16 v[46:47], v1 offset:6144
    v_lshlrev_b32 v9, 9, v9
    s_waitcnt lgkmcnt(4)
    v_mfma_f32_16x16x32_bf16 v[64:67], v[24:27], v[160:163], v[64:67]
    ds_read_b64_tr_b16 v[48:49], v1 offset:8192
    s_and_b32 s96, s3, 2
    v_mfma_f32_16x16x32_bf16 v[64:67], v[28:31], v[164:167], v[64:67]
    ds_read_b64_tr_b16 v[50:51], v1 offset:10240
    s_add_u32 s96, s96, s3
    v_mfma_f32_16x16x32_bf16 v[80:83], v[28:31], v[228:231], v[80:83]
    ds_read_b64_tr_b16 v[52:53], v1 offset:12288
    v_lshl_add_u32 v21, s96, 10, v7
    buffer_load_dwordx4 v[56:59], v8, s[40:43], s99 offen offset:0
    v_mfma_f32_16x16x32_bf16 v[80:83], v[24:27], v[224:227], v[80:83]
    ds_read_b64_tr_b16 v[54:55], v1 offset:14336
    buffer_load_dwordx4 v[60:63], v8, s[40:43], s99 offen offset:64
    v_mfma_f32_16x16x32_bf16 v[80:83], v[32:35], v[232:235], v[80:83]
    ds_read_b64_tr_b16 v[24:25], v2 offset:8192
    v_lshrrev_b32 v5, 1, v7
    v_mfma_f32_16x16x32_bf16 v[80:83], v[36:39], v[236:239], v[80:83]
    ds_read_b64_tr_b16 v[26:27], v2 offset:10240
    v_lshrrev_b32 v6, 4, v0
    v_mfma_f32_16x16x32_bf16 v[64:67], v[36:39], v[172:175], v[64:67]
    ds_read_b64_tr_b16 v[28:29], v2 offset:12288
    v_lshlrev_b32 v6, 3, v6
    v_mfma_f32_16x16x32_bf16 v[64:67], v[32:35], v[168:171], v[64:67]
    ds_read_b64_tr_b16 v[30:31], v2 offset:14336
    s_add_u32 s88, s44, 131072
    s_waitcnt lgkmcnt(4)
    v_mfma_f32_16x16x32_bf16 v[64:67], v[40:43], v[176:179], v[64:67]
    ds_read_b64_tr_b16 v[32:33], v2 offset:16384
    s_add_u32 s89, s46, 229376
    v_mfma_f32_16x16x32_bf16 v[64:67], v[44:47], v[180:183], v[64:67]
    ds_read_b64_tr_b16 v[34:35], v2 offset:18432
    v_mfma_f32_16x16x32_bf16 v[80:83], v[44:47], v[244:247], v[80:83]
    ds_read_b64_tr_b16 v[36:37], v2 offset:20480
    v_mfma_f32_16x16x32_bf16 v[80:83], v[40:43], v[240:243], v[80:83]
    ds_read_b64_tr_b16 v[38:39], v2 offset:22528
    v_mfma_f32_16x16x32_bf16 v[80:83], v[48:51], v[248:251], v[80:83]
    v_add_u32 v2, 0xfffe0000, v2
    ds_read_b64_tr_b16 v[40:41], v2 offset:0
    v_mfma_f32_16x16x32_bf16 v[80:83], v[52:55], v[252:255], v[80:83]
    ds_read_b64_tr_b16 v[42:43], v2 offset:2048
    v_mfma_f32_16x16x32_bf16 v[64:67], v[52:55], v[188:191], v[64:67]
    ds_read_b64_tr_b16 v[44:45], v2 offset:4096
    v_mfma_f32_16x16x32_bf16 v[64:67], v[48:51], v[184:187], v[64:67]
    ds_read_b64_tr_b16 v[46:47], v2 offset:6144
    s_waitcnt lgkmcnt(4)
    v_mfma_f32_16x16x32_bf16 v[68:71], v[24:27], v[160:163], v[68:71]
    ds_read_b64_tr_b16 v[48:49], v2 offset:8192
    v_mfma_f32_16x16x32_bf16 v[68:71], v[28:31], v[164:167], v[68:71]
    ds_read_b64_tr_b16 v[50:51], v2 offset:10240
    v_mfma_f32_16x16x32_bf16 v[84:87], v[28:31], v[228:231], v[84:87]
    ds_read_b64_tr_b16 v[52:53], v2 offset:12288
    v_mfma_f32_16x16x32_bf16 v[84:87], v[24:27], v[224:227], v[84:87]
    ds_read_b64_tr_b16 v[54:55], v2 offset:14336
    v_mfma_f32_16x16x32_bf16 v[84:87], v[32:35], v[232:235], v[84:87]
    ds_read_b64_tr_b16 v[24:25], v3 offset:8192
    v_exp_f32_e64 v12, -v64
    v_exp_f32_e64 v13, -v65
    v_mfma_f32_16x16x32_bf16 v[84:87], v[36:39], v[236:239], v[84:87]
    ds_read_b64_tr_b16 v[26:27], v3 offset:10240
    v_mfma_f32_16x16x32_bf16 v[68:71], v[36:39], v[172:175], v[68:71]
    ds_read_b64_tr_b16 v[28:29], v3 offset:12288
    v_exp_f32_e64 v14, -v66
    v_mfma_f32_16x16x32_bf16 v[68:71], v[32:35], v[168:171], v[68:71]
    s_branch L_pg1761x
L_pg1761:
    s_setpc_b64 s[30:31]
L_pg1761x:
    ds_read_b64_tr_b16 v[30:31], v3 offset:14336
    s_waitcnt lgkmcnt(4)
    v_mfma_f32_16x16x32_bf16 v[68:71], v[40:43], v[176:179], v[68:71]
    ds_read_b64_tr_b16 v[32:33], v3 offset:16384
    v_exp_f32_e64 v15, -v67
    v_mfma_f32_16x16x32_bf16 v[68:71], v[44:47], v[180:183], v[68:71]
    ds_read_b64_tr_b16 v[34:35], v3 offset:18432
    v_fma_f32 v12, v12, s38, s38
    v_mfma_f32_16x16x32_bf16 v[84:87], v[44:47], v[244:247], v[84:87]
    ds_read_b64_tr_b16 v[36:37], v3 offset:20480
    v_fma_f32 v13, v13, s38, s38
    v_mfma_f32_16x16x32_bf16 v[84:87], v[40:43], v[240:243], v[84:87]
    ds_read_b64_tr_b16 v[38:39], v3 offset:22528
    v_fma_f32 v14, v14, s38, s38
    v_mfma_f32_16x16x32_bf16 v[84:87], v[48:51], v[248:251], v[84:87]
    v_add_u32 v3, 0xfffe0000, v3
    ds_read_b64_tr_b16 v[40:41], v3 offset:0
    v_fma_f32 v15, v15, s38, s38
    v_mfma_f32_16x16x32_bf16 v[84:87], v[52:55], v[252:255], v[84:87]
    ds_read_b64_tr_b16 v[42:43], v3 offset:2048
    v_rcp_f32 v12, v12
    v_mfma_f32_16x16x32_bf16 v[68:71], v[52:55], v[188:191], v[68:71]
    ds_read_b64_tr_b16 v[44:45], v3 offset:4096
    v_rcp_f32 v13, v13
    v_mfma_f32_16x16x32_bf16 v[68:71], v[48:51], v[184:187], v[68:71]
    ds_read_b64_tr_b16 v[46:47], v3 offset:6144
    s_waitcnt lgkmcnt(4)
    v_mfma_f32_16x16x32_bf16 v[72:75], v[24:27], v[160:163], v[72:75]
    ds_read_b64_tr_b16 v[48:49], v3 offset:8192
    v_rcp_f32 v14, v14
    v_mfma_f32_16x16x32_bf16 v[72:75], v[28:31], v[164:167], v[72:75]
    ds_read_b64_tr_b16 v[50:51], v3 offset:10240
    v_mfma_f32_16x16x32_bf16 v[88:91], v[28:31], v[228:231], v[88:91]
    ds_read_b64_tr_b16 v[52:53], v3 offset:12288
    v_rcp_f32 v15, v15
    v_mfma_f32_16x16x32_bf16 v[88:91], v[24:27], v[224:227], v[88:91]
    ds_read_b64_tr_b16 v[54:55], v3 offset:14336
    v_mul_f32 v64, v64, v12
    v_mfma_f32_16x16x32_bf16 v[88:91], v[32:35], v[232:235], v[88:91]
    ds_read_b64_tr_b16 v[24:25], v4 offset:8192
    v_mul_f32 v65, v65, v13
    v_mfma_f32_16x16x32_bf16 v[88:91], v[36:39], v[236:239], v[88:91]
    ds_read_b64_tr_b16 v[26:27], v4 offset:10240
    v_mul_f32 v66, v66, v14
    v_mfma_f32_16x16x32_bf16 v[72:75], v[36:39], v[172:175], v[72:75]
    ds_read_b64_tr_b16 v[28:29], v4 offset:12288
    v_mul_f32 v67, v67, v15
    v_mfma_f32_16x16x32_bf16 v[72:75], v[32:35], v[168:171], v[72:75]
    ds_read_b64_tr_b16 v[30:31], v4 offset:14336
    v_exp_f32_e64 v16, -v80
    s_waitcnt lgkmcnt(4)
    v_mfma_f32_16x16x32_bf16 v[72:75], v[40:43], v[176:179], v[72:75]
    ds_read_b64_tr_b16 v[32:33], v4 offset:16384
    v_exp_f32_e64 v17, -v81
    v_mfma_f32_16x16x32_bf16 v[72:75], v[44:47], v[180:183], v[72:75]
    ds_read_b64_tr_b16 v[34:35], v4 offset:18432
    v_mfma_f32_16x16x32_bf16 v[88:91], v[44:47], v[244:247], v[88:91]
    ds_read_b64_tr_b16 v[36:37], v4 offset:20480
    v_exp_f32_e64 v18, -v82
    v_mfma_f32_16x16x32_bf16 v[88:91], v[40:43], v[240:243], v[88:91]
    ds_read_b64_tr_b16 v[38:39], v4 offset:22528
    v_exp_f32_e64 v19, -v83
    v_mfma_f32_16x16x32_bf16 v[88:91], v[48:51], v[248:251], v[88:91]
    v_add_u32 v4, 0xfffe0000, v4
    ds_read_b64_tr_b16 v[40:41], v4 offset:0
    v_mfma_f32_16x16x32_bf16 v[88:91], v[52:55], v[252:255], v[88:91]
    ds_read_b64_tr_b16 v[42:43], v4 offset:2048
    v_fma_f32 v16, v16, s38, s38
    v_mfma_f32_16x16x32_bf16 v[72:75], v[52:55], v[188:191], v[72:75]
    ds_read_b64_tr_b16 v[44:45], v4 offset:4096
    v_fma_f32 v17, v17, s38, s38
    v_mfma_f32_16x16x32_bf16 v[72:75], v[48:51], v[184:187], v[72:75]
    ds_read_b64_tr_b16 v[46:47], v4 offset:6144
    v_fma_f32 v18, v18, s38, s38
    s_waitcnt lgkmcnt(4)
    v_mfma_f32_16x16x32_bf16 v[76:79], v[24:27], v[160:163], v[76:79]
    ds_read_b64_tr_b16 v[48:49], v4 offset:8192
    v_fma_f32 v19, v19, s38, s38
    v_rcp_f32 v16, v16
    v_mfma_f32_16x16x32_bf16 v[76:79], v[28:31], v[164:167], v[76:79]
    ds_read_b64_tr_b16 v[50:51], v4 offset:10240
    v_mfma_f32_16x16x32_bf16 v[92:95], v[28:31], v[228:231], v[92:95]
    ds_read_b64_tr_b16 v[52:53], v4 offset:12288
    v_rcp_f32 v17, v17
    v_mfma_f32_16x16x32_bf16 v[92:95], v[24:27], v[224:227], v[92:95]
    ds_read_b64_tr_b16 v[54:55], v4 offset:14336
    v_mfma_f32_16x16x32_bf16 v[92:95], v[32:35], v[232:235], v[92:95]
    ds_read_b64_tr_b16 v[24:25], v1 offset:16384
    v_rcp_f32 v18, v18
    v_mfma_f32_16x16x32_bf16 v[92:95], v[36:39], v[236:239], v[92:95]
    ds_read_b64_tr_b16 v[26:27], v1 offset:18432
    v_rcp_f32 v19, v19
    v_mfma_f32_16x16x32_bf16 v[76:79], v[36:39], v[172:175], v[76:79]
    ds_read_b64_tr_b16 v[28:29], v1 offset:20480
    v_mfma_f32_16x16x32_bf16 v[76:79], v[32:35], v[168:171], v[76:79]
    ds_read_b64_tr_b16 v[30:31], v1 offset:22528
    v_mul_f32 v80, v80, v16
    s_waitcnt lgkmcnt(4)
    v_mfma_f32_16x16x32_bf16 v[76:79], v[40:43], v[176:179], v[76:79]
    ds_read_b64_tr_b16 v[32:33], v1 offset:24576
    v_mul_f32 v81, v81, v17
    v_mfma_f32_16x16x32_bf16 v[76:79], v[44:47], v[180:183], v[76:79]
    ds_read_b64_tr_b16 v[34:35], v1 offset:26624
    v_mul_f32 v82, v82, v18
    v_mfma_f32_16x16x32_bf16 v[92:95], v[44:47], v[244:247], v[92:95]
    ds_read_b64_tr_b16 v[36:37], v1 offset:28672
    v_mul_f32 v83, v83, v19
    v_exp_f32_e64 v12, -v68
    v_mfma_f32_16x16x32_bf16 v[92:95], v[40:43], v[240:243], v[92:95]
    ds_read_b64_tr_b16 v[38:39], v1 offset:30720
    v_mfma_f32_16x16x32_bf16 v[92:95], v[48:51], v[248:251], v[92:95]
    s_barrier
    ds_read_b64_tr_b16 v[40:41], v1 offset:32768
    v_exp_f32_e64 v13, -v69
    v_mfma_f32_16x16x32_bf16 v[92:95], v[52:55], v[252:255], v[92:95]
    ds_read_b64_tr_b16 v[42:43], v1 offset:34816
    v_mfma_f32_16x16x32_bf16 v[76:79], v[52:55], v[188:191], v[76:79]
    ds_read_b64_tr_b16 v[44:45], v1 offset:36864
    v_exp_f32_e64 v14, -v70
    v_mfma_f32_16x16x32_bf16 v[76:79], v[48:51], v[184:187], v[76:79]
    ds_read_b64_tr_b16 v[46:47], v1 offset:38912
    v_exp_f32_e64 v15, -v71
    s_waitcnt lgkmcnt(4)
    v_mfma_f32_16x16x32_bf16 v[96:99], v[24:27], v[128:131], 0
    ds_read_b64_tr_b16 v[48:49], v1 offset:40960
    v_mfma_f32_16x16x32_bf16 v[96:99], v[28:31], v[132:135], v[96:99]
    ds_read_b64_tr_b16 v[50:51], v1 offset:43008
    v_fma_f32 v12, v12, s38, s38
    v_mfma_f32_16x16x32_bf16 v[112:115], v[28:31], v[196:199], 0
    ds_read_b64_tr_b16 v[52:53], v1 offset:45056
    v_fma_f32 v13, v13, s38, s38
    v_mfma_f32_16x16x32_bf16 v[112:115], v[24:27], v[192:195], v[112:115]
    ds_read_b64_tr_b16 v[54:55], v1 offset:47104
    v_fma_f32 v14, v14, s38, s38
    v_fma_f32 v15, v15, s38, s38
    v_mfma_f32_16x16x32_bf16 v[112:115], v[32:35], v[200:203], v[112:115]
    ds_read_b64_tr_b16 v[24:25], v2 offset:16384
    v_rcp_f32 v12, v12
    v_mfma_f32_16x16x32_bf16 v[112:115], v[36:39], v[204:207], v[112:115]
    ds_read_b64_tr_b16 v[26:27], v2 offset:18432
    v_mfma_f32_16x16x32_bf16 v[96:99], v[36:39], v[140:143], v[96:99]
    ds_read_b64_tr_b16 v[28:29], v2 offset:20480
    v_rcp_f32 v13, v13
    v_mfma_f32_16x16x32_bf16 v[96:99], v[32:35], v[136:139], v[96:99]
    ds_read_b64_tr_b16 v[30:31], v2 offset:22528
    s_waitcnt lgkmcnt(4)
    v_mfma_f32_16x16x32_bf16 v[96:99], v[40:43], v[144:147], v[96:99]
    ds_read_b64_tr_b16 v[32:33], v2 offset:24576
    v_rcp_f32 v14, v14
    v_mfma_f32_16x16x32_bf16 v[96:99], v[44:47], v[148:151], v[96:99]
    ds_read_b64_tr_b16 v[34:35], v2 offset:26624
    v_rcp_f32 v15, v15
    v_mfma_f32_16x16x32_bf16 v[112:115], v[44:47], v[212:215], v[112:115]
    ds_read_b64_tr_b16 v[36:37], v2 offset:28672
    v_mfma_f32_16x16x32_bf16 v[112:115], v[40:43], v[208:211], v[112:115]
    ds_read_b64_tr_b16 v[38:39], v2 offset:30720
    v_mul_f32 v68, v68, v12
    v_mfma_f32_16x16x32_bf16 v[112:115], v[48:51], v[216:219], v[112:115]
    ds_read_b64_tr_b16 v[40:41], v2 offset:32768
    v_mul_f32 v69, v69, v13
    v_mfma_f32_16x16x32_bf16 v[112:115], v[52:55], v[220:223], v[112:115]
    ds_read_b64_tr_b16 v[42:43], v2 offset:34816
    v_mul_f32 v70, v70, v14
    v_mul_f32 v71, v71, v15
    v_mfma_f32_16x16x32_bf16 v[96:99], v[52:55], v[156:159], v[96:99]
    ds_read_b64_tr_b16 v[44:45], v2 offset:36864
    v_exp_f32_e64 v16, -v84
    v_mfma_f32_16x16x32_bf16 v[96:99], v[48:51], v[152:155], v[96:99]
    ds_read_b64_tr_b16 v[46:47], v2 offset:38912
    s_waitcnt lgkmcnt(4)
    v_mfma_f32_16x16x32_bf16 v[100:103], v[24:27], v[128:131], 0
    ds_read_b64_tr_b16 v[48:49], v2 offset:40960
    v_exp_f32_e64 v17, -v85
    v_mfma_f32_16x16x32_bf16 v[100:103], v[28:31], v[132:135], v[100:103]
    ds_read_b64_tr_b16 v[50:51], v2 offset:43008
    v_mfma_f32_16x16x32_bf16 v[116:119], v[28:31], v[196:199], 0
    ds_read_b64_tr_b16 v[52:53], v2 offset:45056
    v_exp_f32_e64 v18, -v86
    v_mfma_f32_16x16x32_bf16 v[116:119], v[24:27], v[192:195], v[116:119]
    ds_read_b64_tr_b16 v[54:55], v2 offset:47104
    v_exp_f32_e64 v19, -v87
    v_mfma_f32_16x16x32_bf16 v[116:119], v[32:35], v[200:203], v[116:119]
    ds_read_b64_tr_b16 v[24:25], v3 offset:16384
    v_mfma_f32_16x16x32_bf16 v[116:119], v[36:39], v[204:207], v[116:119]
    ds_read_b64_tr_b16 v[26:27], v3 offset:18432
    v_fma_f32 v16, v16, s38, s38
    v_mfma_f32_16x16x32_bf16 v[100:103], v[36:39], v[140:143], v[100:103]
    ds_read_b64_tr_b16 v[28:29], v3 offset:20480
    v_fma_f32 v17, v17, s38, s38
    v_fma_f32 v18, v18, s38, s38
    v_mfma_f32_16x16x32_bf16 v[100:103], v[32:35], v[136:139], v[100:103]
    ds_read_b64_tr_b16 v[30:31], v3 offset:22528
    v_fma_f32 v19, v19, s38, s38
    s_waitcnt lgkmcnt(4)
    v_mfma_f32_16x16x32_bf16 v[100:103], v[40:43], v[144:147], v[100:103]
    ds_read_b64_tr_b16 v[32:33], v3 offset:24576
    v_rcp_f32 v16, v16
    v_mfma_f32_16x16x32_bf16 v[100:103], v[44:47], v[148:151], v[100:103]
    ds_read_b64_tr_b16 v[34:35], v3 offset:26624
    v_mfma_f32_16x16x32_bf16 v[116:119], v[44:47], v[212:215], v[116:119]
    ds_read_b64_tr_b16 v[36:37], v3 offset:28672
    v_rcp_f32 v17, v17
    v_mfma_f32_16x16x32_bf16 v[116:119], v[40:43], v[208:211], v[116:119]
    ds_read_b64_tr_b16 v[38:39], v3 offset:30720
    v_rcp_f32 v18, v18
    v_mfma_f32_16x16x32_bf16 v[116:119], v[48:51], v[216:219], v[116:119]
    ds_read_b64_tr_b16 v[40:41], v3 offset:32768
    v_mfma_f32_16x16x32_bf16 v[116:119], v[52:55], v[220:223], v[116:119]
    ds_read_b64_tr_b16 v[42:43], v3 offset:34816
    v_rcp_f32 v19, v19
    v_mfma_f32_16x16x32_bf16 v[100:103], v[52:55], v[156:159], v[100:103]
    ds_read_b64_tr_b16 v[44:45], v3 offset:36864
    v_mfma_f32_16x16x32_bf16 v[100:103], v[48:51], v[152:155], v[100:103]
    ds_read_b64_tr_b16 v[46:47], v3 offset:38912
    v_mul_f32 v84, v84, v16
    s_waitcnt lgkmcnt(4)
    v_mfma_f32_16x16x32_bf16 v[104:107], v[24:27], v[128:131], 0
    ds_read_b64_tr_b16 v[48:49], v3 offset:40960
    v_mul_f32 v85, v85, v17
    v_mul_f32 v86, v86, v18
    v_mfma_f32_16x16x32_bf16 v[104:107], v[28:31], v[132:135], v[104:107]
    ds_read_b64_tr_b16 v[50:51], v3 offset:43008
    v_mul_f32 v87, v87, v19
    v_mfma_f32_16x16x32_bf16 v[120:123], v[28:31], v[196:199], 0
    ds_read_b64_tr_b16 v[52:53], v3 offset:45056
    v_exp_f32_e64 v12, -v72
    v_mfma_f32_16x16x32_bf16 v[120:123], v[24:27], v[192:195], v[120:123]
    ds_read_b64_tr_b16 v[54:55], v3 offset:47104
    v_mfma_f32_16x16x32_bf16 v[120:123], v[32:35], v[200:203], v[120:123]
    ds_read_b64_tr_b16 v[24:25], v4 offset:16384
    v_exp_f32_e64 v13, -v73
    v_mfma_f32_16x16x32_bf16 v[120:123], v[36:39], v[204:207], v[120:123]
    ds_read_b64_tr_b16 v[26:27], v4 offset:18432
    v_exp_f32_e64 v14, -v74
    v_mfma_f32_16x16x32_bf16 v[104:107], v[36:39], v[140:143], v[104:107]
    ds_read_b64_tr_b16 v[28:29], v4 offset:20480
    v_mfma_f32_16x16x32_bf16 v[104:107], v[32:35], v[136:139], v[104:107]
    ds_read_b64_tr_b16 v[30:31], v4 offset:22528
    v_exp_f32_e64 v15, -v75
    s_waitcnt lgkmcnt(4)
    v_mfma_f32_16x16x32_bf16 v[104:107], v[40:43], v[144:147], v[104:107]
    ds_read_b64_tr_b16 v[32:33], v4 offset:24576
    v_mfma_f32_16x16x32_bf16 v[104:107], v[44:47], v[148:151], v[104:107]
    ds_read_b64_tr_b16 v[34:35], v4 offset:26624
    v_fma_f32 v12, v12, s38, s38
    v_mfma_f32_16x16x32_bf16 v[120:123], v[44:47], v[212:215], v[120:123]
    ds_read_b64_tr_b16 v[36:37], v4 offset:28672
    v_fma_f32 v13, v13, s38, s38
    v_fma_f32 v14, v14, s38, s38
    v_mfma_f32_16x16x32_bf16 v[120:123], v[40:43], v[208:211], v[120:123]
    ds_read_b64_tr_b16 v[38:39], v4 offset:30720
    v_fma_f32 v15, v15, s38, s38
    v_mfma_f32_16x16x32_bf16 v[120:123], v[48:51], v[216:219], v[120:123]
    ds_read_b64_tr_b16 v[40:41], v4 offset:32768
    v_rcp_f32 v12, v12
    v_mfma_f32_16x16x32_bf16 v[120:123], v[52:55], v[220:223], v[120:123]
    ds_read_b64_tr_b16 v[42:43], v4 offset:34816
    v_mfma_f32_16x16x32_bf16 v[104:107], v[52:55], v[156:159], v[104:107]
    ds_read_b64_tr_b16 v[44:45], v4 offset:36864
    v_rcp_f32 v13, v13
    v_mfma_f32_16x16x32_bf16 v[104:107], v[48:51], v[152:155], v[104:107]
    ds_read_b64_tr_b16 v[46:47], v4 offset:38912
    v_rcp_f32 v14, v14
    s_waitcnt lgkmcnt(4)
    v_mfma_f32_16x16x32_bf16 v[108:111], v[24:27], v[128:131], 0
    ds_read_b64_tr_b16 v[48:49], v4 offset:40960
    v_mfma_f32_16x16x32_bf16 v[108:111], v[28:31], v[132:135], v[108:111]
    ds_read_b64_tr_b16 v[50:51], v4 offset:43008
    v_rcp_f32 v15, v15
    v_mfma_f32_16x16x32_bf16 v[124:127], v[28:31], v[196:199], 0
    ds_read_b64_tr_b16 v[52:53], v4 offset:45056
    v_mfma_f32_16x16x32_bf16 v[124:127], v[24:27], v[192:195], v[124:127]
    ds_read_b64_tr_b16 v[54:55], v4 offset:47104
    v_mul_f32 v72, v72, v12
    v_mul_f32 v73, v73, v13
    v_mfma_f32_16x16x32_bf16 v[124:127], v[32:35], v[200:203], v[124:127]
    ds_read_b64_tr_b16 v[24:25], v1 offset:49152
    v_mul_f32 v74, v74, v14
    v_mfma_f32_16x16x32_bf16 v[124:127], v[36:39], v[204:207], v[124:127]
    ds_read_b64_tr_b16 v[26:27], v1 offset:51200
    v_mul_f32 v75, v75, v15
    v_mfma_f32_16x16x32_bf16 v[108:111], v[36:39], v[140:143], v[108:111]
    ds_read_b64_tr_b16 v[28:29], v1 offset:53248
    v_exp_f32_e64 v16, -v88
    v_mfma_f32_16x16x32_bf16 v[108:111], v[32:35], v[136:139], v[108:111]
    ds_read_b64_tr_b16 v[30:31], v1 offset:55296
    s_waitcnt lgkmcnt(4)
    v_mfma_f32_16x16x32_bf16 v[108:111], v[40:43], v[144:147], v[108:111]
    ds_read_b64_tr_b16 v[32:33], v1 offset:57344
    v_exp_f32_e64 v17, -v89
    v_mfma_f32_16x16x32_bf16 v[108:111], v[44:47], v[148:151], v[108:111]
    ds_read_b64_tr_b16 v[34:35], v1 offset:59392
    v_exp_f32_e64 v18, -v90
    v_mfma_f32_16x16x32_bf16 v[124:127], v[44:47], v[212:215], v[124:127]
    ds_read_b64_tr_b16 v[36:37], v1 offset:61440
    v_mfma_f32_16x16x32_bf16 v[124:127], v[40:43], v[208:211], v[124:127]
    ds_read_b64_tr_b16 v[38:39], v1 offset:63488
    v_exp_f32_e64 v19, -v91
    v_mfma_f32_16x16x32_bf16 v[124:127], v[48:51], v[216:219], v[124:127]
    s_barrier
    v_add_u32 v1, 0x10000, v1
    ds_read_b64_tr_b16 v[40:41], v1 offset:0
    v_mfma_f32_16x16x32_bf16 v[124:127], v[52:55], v[220:223], v[124:127]
    ds_read_b64_tr_b16 v[42:43], v1 offset:2048
    v_fma_f32 v16, v16, s38, s38
    v_fma_f32 v17, v17, s38, s38
    v_mfma_f32_16x16x32_bf16 v[108:111], v[52:55], v[156:159], v[108:111]
    ds_read_b64_tr_b16 v[44:45], v1 offset:4096
    v_fma_f32 v18, v18, s38, s38
    v_mfma_f32_16x16x32_bf16 v[108:111], v[48:51], v[152:155], v[108:111]
    ds_read_b64_tr_b16 v[46:47], v1 offset:6144
    v_fma_f32 v19, v19, s38, s38
    s_waitcnt lgkmcnt(4)
    v_mfma_f32_16x16x32_bf16 v[96:99], v[24:27], v[160:163], v[96:99]
    ds_read_b64_tr_b16 v[48:49], v1 offset:8192
    v_rcp_f32 v16, v16
    v_mfma_f32_16x16x32_bf16 v[96:99], v[28:31], v[164:167], v[96:99]
    ds_read_b64_tr_b16 v[50:51], v1 offset:10240
    v_rcp_f32 v17, v17
    v_mfma_f32_16x16x32_bf16 v[112:115], v[28:31], v[228:231], v[112:115]
    ds_read_b64_tr_b16 v[52:53], v1 offset:12288
    v_mfma_f32_16x16x32_bf16 v[112:115], v[24:27], v[224:227], v[112:115]
    ds_read_b64_tr_b16 v[54:55], v1 offset:14336
    v_rcp_f32 v18, v18
    v_mfma_f32_16x16x32_bf16 v[112:115], v[32:35], v[232:235], v[112:115]
    ds_read_b64_tr_b16 v[24:25], v2 offset:49152
    v_mfma_f32_16x16x32_bf16 v[112:115], v[36:39], v[236:239], v[112:115]
    ds_read_b64_tr_b16 v[26:27], v2 offset:51200
    v_rcp_f32 v19, v19
    v_mfma_f32_16x16x32_bf16 v[96:99], v[36:39], v[172:175], v[96:99]
    ds_read_b64_tr_b16 v[28:29], v2 offset:53248
    v_mul_f32 v88, v88, v16
    v_mfma_f32_16x16x32_bf16 v[96:99], v[32:35], v[168:171], v[96:99]
    ds_read_b64_tr_b16 v[30:31], v2 offset:55296
    v_mul_f32 v89, v89, v17
    s_waitcnt lgkmcnt(4)
    v_mfma_f32_16x16x32_bf16 v[96:99], v[40:43], v[176:179], v[96:99]
    ds_read_b64_tr_b16 v[32:33], v2 offset:57344
    v_mul_f32 v90, v90, v18
    v_mfma_f32_16x16x32_bf16 v[96:99], v[44:47], v[180:183], v[96:99]
    ds_read_b64_tr_b16 v[34:35], v2 offset:59392
    v_mul_f32 v91, v91, v19
    v_mfma_f32_16x16x32_bf16 v[112:115], v[44:47], v[244:247], v[112:115]
    ds_read_b64_tr_b16 v[36:37], v2 offset:61440
    v_exp_f32_e64 v12, -v76
    v_mfma_f32_16x16x32_bf16 v[112:115], v[40:43], v[240:243], v[112:115]
    ds_read_b64_tr_b16 v[38:39], v2 offset:63488
    v_exp_f32_e64 v13, -v77
    v_mfma_f32_16x16x32_bf16 v[112:115], v[48:51], v[248:251], v[112:115]
    v_add_u32 v2, 0x10000, v2
    ds_read_b64_tr_b16 v[40:41], v2 offset:0
    v_mfma_f32_16x16x32_bf16 v[112:115], v[52:55], v[252:255], v[112:115]
    ds_read_b64_tr_b16 v[42:43], v2 offset:2048
    v_exp_f32_e64 v14, -v78
    v_mfma_f32_16x16x32_bf16 v[96:99], v[52:55], v[188:191], v[96:99]
    ds_read_b64_tr_b16 v[44:45], v2 offset:4096
    v_mfma_f32_16x16x32_bf16 v[96:99], v[48:51], v[184:187], v[96:99]
    ds_read_b64_tr_b16 v[46:47], v2 offset:6144
    v_exp_f32_e64 v15, -v79
    s_waitcnt lgkmcnt(4)
    v_mfma_f32_16x16x32_bf16 v[100:103], v[24:27], v[160:163], v[100:103]
    ds_read_b64_tr_b16 v[48:49], v2 offset:8192
    v_fma_f32 v12, v12, s38, s38
    v_mfma_f32_16x16x32_bf16 v[100:103], v[28:31], v[164:167], v[100:103]
    ds_read_b64_tr_b16 v[50:51], v2 offset:10240
    v_fma_f32 v13, v13, s38, s38
    v_mfma_f32_16x16x32_bf16 v[116:119], v[28:31], v[228:231], v[116:119]
    ds_read_b64_tr_b16 v[52:53], v2 offset:12288
    v_fma_f32 v14, v14, s38, s38
    v_mfma_f32_16x16x32_bf16 v[116:119], v[24:27], v[224:227], v[116:119]
    ds_read_b64_tr_b16 v[54:55], v2 offset:14336
    v_fma_f32 v15, v15, s38, s38
    v_mfma_f32_16x16x32_bf16 v[116:119], v[32:35], v[232:235], v[116:119]
    ds_read_b64_tr_b16 v[24:25], v3 offset:49152
    v_rcp_f32 v12, v12
    v_mfma_f32_16x16x32_bf16 v[116:119], v[36:39], v[236:239], v[116:119]
    ds_read_b64_tr_b16 v[26:27], v3 offset:51200
    v_rcp_f32 v13, v13
    v_mfma_f32_16x16x32_bf16 v[100:103], v[36:39], v[172:175], v[100:103]
    ds_read_b64_tr_b16 v[28:29], v3 offset:53248
    v_mfma_f32_16x16x32_bf16 v[100:103], v[32:35], v[168:171], v[100:103]
    ds_read_b64_tr_b16 v[30:31], v3 offset:55296
    v_rcp_f32 v14, v14
    s_waitcnt lgkmcnt(4)
    v_mfma_f32_16x16x32_bf16 v[100:103], v[40:43], v[176:179], v[100:103]
    ds_read_b64_tr_b16 v[32:33], v3 offset:57344
    v_mfma_f32_16x16x32_bf16 v[100:103], v[44:47], v[180:183], v[100:103]
    ds_read_b64_tr_b16 v[34:35], v3 offset:59392
    v_rcp_f32 v15, v15
    v_mfma_f32_16x16x32_bf16 v[116:119], v[44:47], v[244:247], v[116:119]
    ds_read_b64_tr_b16 v[36:37], v3 offset:61440
    v_mul_f32 v76, v76, v12
    v_mfma_f32_16x16x32_bf16 v[116:119], v[40:43], v[240:243], v[116:119]
    ds_read_b64_tr_b16 v[38:39], v3 offset:63488
    v_mul_f32 v77, v77, v13
    v_mfma_f32_16x16x32_bf16 v[116:119], v[48:51], v[248:251], v[116:119]
    v_add_u32 v3, 0x10000, v3
    ds_read_b64_tr_b16 v[40:41], v3 offset:0
    v_mul_f32 v78, v78, v14
    v_mfma_f32_16x16x32_bf16 v[116:119], v[52:55], v[252:255], v[116:119]
    ds_read_b64_tr_b16 v[42:43], v3 offset:2048
    v_mul_f32 v79, v79, v15
    v_mfma_f32_16x16x32_bf16 v[100:103], v[52:55], v[188:191], v[100:103]
    ds_read_b64_tr_b16 v[44:45], v3 offset:4096
    v_exp_f32_e64 v16, -v92
    v_mfma_f32_16x16x32_bf16 v[100:103], v[48:51], v[184:187], v[100:103]
    ds_read_b64_tr_b16 v[46:47], v3 offset:6144
    v_exp_f32_e64 v17, -v93
    s_waitcnt lgkmcnt(4)
    v_mfma_f32_16x16x32_bf16 v[104:107], v[24:27], v[160:163], v[104:107]
    ds_read_b64_tr_b16 v[48:49], v3 offset:8192
    v_mfma_f32_16x16x32_bf16 v[104:107], v[28:31], v[164:167], v[104:107]
    ds_read_b64_tr_b16 v[50:51], v3 offset:10240
    v_exp_f32_e64 v18, -v94
    v_mfma_f32_16x16x32_bf16 v[120:123], v[28:31], v[228:231], v[120:123]
    ds_read_b64_tr_b16 v[52:53], v3 offset:12288
    v_mfma_f32_16x16x32_bf16 v[120:123], v[24:27], v[224:227], v[120:123]
    ds_read_b64_tr_b16 v[54:55], v3 offset:14336
    v_exp_f32_e64 v19, -v95
    v_mfma_f32_16x16x32_bf16 v[120:123], v[32:35], v[232:235], v[120:123]
    ds_read_b64_tr_b16 v[24:25], v4 offset:49152
    v_fma_f32 v16, v16, s38, s38
    v_mfma_f32_16x16x32_bf16 v[120:123], v[36:39], v[236:239], v[120:123]
    ds_read_b64_tr_b16 v[26:27], v4 offset:51200
    v_fma_f32 v17, v17, s38, s38
    v_mfma_f32_16x16x32_bf16 v[104:107], v[36:39], v[172:175], v[104:107]
    ds_read_b64_tr_b16 v[28:29], v4 offset:53248
    v_fma_f32 v18, v18, s38, s38
    v_mfma_f32_16x16x32_bf16 v[104:107], v[32:35], v[168:171], v[104:107]
    ds_read_b64_tr_b16 v[30:31], v4 offset:55296
    v_fma_f32 v19, v19, s38, s38
    v_rcp_f32 v16, v16
    s_waitcnt lgkmcnt(4)
    v_mfma_f32_16x16x32_bf16 v[104:107], v[40:43], v[176:179], v[104:107]
    ds_read_b64_tr_b16 v[32:33], v4 offset:57344
    v_mfma_f32_16x16x32_bf16 v[104:107], v[44:47], v[180:183], v[104:107]
    ds_read_b64_tr_b16 v[34:35], v4 offset:59392
    v_rcp_f32 v17, v17
    v_mfma_f32_16x16x32_bf16 v[120:123], v[44:47], v[244:247], v[120:123]
    ds_read_b64_tr_b16 v[36:37], v4 offset:61440
    v_mfma_f32_16x16x32_bf16 v[120:123], v[40:43], v[240:243], v[120:123]
    ds_read_b64_tr_b16 v[38:39], v4 offset:63488
    v_rcp_f32 v18, v18
    v_mfma_f32_16x16x32_bf16 v[120:123], v[48:51], v[248:251], v[120:123]
    v_add_u32 v4, 0x10000, v4
    ds_read_b64_tr_b16 v[40:41], v4 offset:0
    v_mfma_f32_16x16x32_bf16 v[120:123], v[52:55], v[252:255], v[120:123]
    ds_read_b64_tr_b16 v[42:43], v4 offset:2048
    v_rcp_f32 v19, v19
    v_mfma_f32_16x16x32_bf16 v[104:107], v[52:55], v[188:191], v[104:107]
    ds_read_b64_tr_b16 v[44:45], v4 offset:4096
    v_mul_f32 v92, v92, v16
    v_mfma_f32_16x16x32_bf16 v[104:107], v[48:51], v[184:187], v[104:107]
    ds_read_b64_tr_b16 v[46:47], v4 offset:6144
    v_mul_f32 v93, v93, v17
    s_waitcnt lgkmcnt(4)
    v_mfma_f32_16x16x32_bf16 v[108:111], v[24:27], v[160:163], v[108:111]
    ds_read_b64_tr_b16 v[48:49], v4 offset:8192
    v_mul_f32 v94, v94, v18
    v_mfma_f32_16x16x32_bf16 v[108:111], v[28:31], v[164:167], v[108:111]
    ds_read_b64_tr_b16 v[50:51], v4 offset:10240
    v_mul_f32 v95, v95, v19
    v_mul_f32 v96, v96, v64
    v_mfma_f32_16x16x32_bf16 v[124:127], v[28:31], v[228:231], v[124:127]
    ds_read_b64_tr_b16 v[52:53], v4 offset:12288
    v_mul_f32 v97, v97, v65
    v_mfma_f32_16x16x32_bf16 v[124:127], v[24:27], v[224:227], v[124:127]
    ds_read_b64_tr_b16 v[54:55], v4 offset:14336
    v_mul_f32 v98, v98, v66
    v_mfma_f32_16x16x32_bf16 v[124:127], v[32:35], v[232:235], v[124:127]
    ds_read_b64_tr_b16 v[24:25], v1 offset:16384
    v_mul_f32 v99, v99, v67
    v_mfma_f32_16x16x32_bf16 v[124:127], v[36:39], v[236:239], v[124:127]
    ds_read_b64_tr_b16 v[26:27], v1 offset:18432
    v_mul_f32 v100, v100, v68
    v_mul_f32 v101, v101, v69
    v_mfma_f32_16x16x32_bf16 v[108:111], v[36:39], v[172:175], v[108:111]
    ds_read_b64_tr_b16 v[28:29], v1 offset:20480
    v_mul_f32 v102, v102, v70
    v_mfma_f32_16x16x32_bf16 v[108:111], v[32:35], v[168:171], v[108:111]
    ds_read_b64_tr_b16 v[30:31], v1 offset:22528
    v_mul_f32 v103, v103, v71
    s_waitcnt lgkmcnt(4)
    v_mfma_f32_16x16x32_bf16 v[108:111], v[40:43], v[176:179], v[108:111]
    ds_read_b64_tr_b16 v[32:33], v1 offset:40960
    v_mul_f32 v112, v112, v80
    v_mfma_f32_16x16x32_bf16 v[108:111], v[44:47], v[180:183], v[108:111]
    ds_read_b64_tr_b16 v[34:35], v1 offset:43008
    v_mul_f32 v113, v113, v81
    v_mfma_f32_16x16x32_bf16 v[124:127], v[44:47], v[244:247], v[124:127]
    ds_read_b64_tr_b16 v[36:37], v1 offset:45056
    v_mul_f32 v114, v114, v82
    v_mul_f32 v115, v115, v83
    v_mfma_f32_16x16x32_bf16 v[124:127], v[40:43], v[240:243], v[124:127]
    ds_read_b64_tr_b16 v[38:39], v1 offset:47104
    v_mul_f32 v116, v116, v84
    v_mfma_f32_16x16x32_bf16 v[124:127], v[48:51], v[248:251], v[124:127]
    s_barrier
    ds_read_b64_tr_b16 v[40:41], v1 offset:49152
    v_mul_f32 v117, v117, v85
    v_mfma_f32_16x16x32_bf16 v[124:127], v[52:55], v[252:255], v[124:127]
    ds_read_b64_tr_b16 v[42:43], v1 offset:51200
    v_mul_f32 v118, v118, v86
    v_mfma_f32_16x16x32_bf16 v[108:111], v[52:55], v[188:191], v[108:111]
    ds_read_b64_tr_b16 v[44:45], v1 offset:53248
    v_mul_f32 v119, v119, v87
    v_cvt_pk_bf16_f32 v96, v96, v97
    v_mfma_f32_16x16x32_bf16 v[108:111], v[48:51], v[184:187], v[108:111]
    ds_read_b64_tr_b16 v[46:47], v1 offset:55296
    v_cvt_pk_bf16_f32 v97, v98, v99
    v_cvt_pk_bf16_f32 v98, v100, v101
    s_waitcnt lgkmcnt(4)
    v_mfma_f32_16x16x32_bf16 v[64:67], v[24:27], v[128:131], 0
    ds_read_b64_tr_b16 v[48:49], v1 offset:57344
    v_cvt_pk_bf16_f32 v99, v102, v103
    v_mfma_f32_16x16x32_bf16 v[64:67], v[28:31], v[132:135], v[64:67]
    ds_read_b64_tr_b16 v[50:51], v1 offset:59392
    buffer_store_dwordx4 v[96:99], v7, s[64:67], s88 offen offset:0 sc1
    v_mfma_f32_16x16x32_bf16 v[80:83], v[28:31], v[196:199], 0
    ds_read_b64_tr_b16 v[52:53], v1 offset:61440
    v_cvt_pk_bf16_f32 v112, v112, v113
    v_mfma_f32_16x16x32_bf16 v[80:83], v[24:27], v[192:195], v[80:83]
    ds_read_b64_tr_b16 v[54:55], v1 offset:63488
    v_cvt_pk_bf16_f32 v113, v114, v115
    v_mfma_f32_16x16x32_bf16 v[80:83], v[32:35], v[200:203], v[80:83]
    ds_read_b64_tr_b16 v[24:25], v2 offset:16384
    v_cvt_pk_bf16_f32 v114, v116, v117
    v_mfma_f32_16x16x32_bf16 v[80:83], v[36:39], v[204:207], v[80:83]
    ds_read_b64_tr_b16 v[26:27], v2 offset:18432
    v_cvt_pk_bf16_f32 v115, v118, v119
    v_mfma_f32_16x16x32_bf16 v[64:67], v[36:39], v[140:143], v[64:67]
    ds_read_b64_tr_b16 v[28:29], v2 offset:20480
    buffer_store_dwordx4 v[112:115], v7, s[64:67], s88 offen offset:1024 sc1
    v_mfma_f32_16x16x32_bf16 v[64:67], v[32:35], v[136:139], v[64:67]
    ds_read_b64_tr_b16 v[30:31], v2 offset:22528
    v_mul_f32 v104, v104, v72
    s_waitcnt lgkmcnt(4)
    v_mfma_f32_16x16x32_bf16 v[64:67], v[40:43], v[144:147], v[64:67]
    ds_read_b64_tr_b16 v[32:33], v2 offset:40960
    v_mul_f32 v105, v105, v73
    v_mfma_f32_16x16x32_bf16 v[64:67], v[44:47], v[148:151], v[64:67]
    ds_read_b64_tr_b16 v[34:35], v2 offset:43008
    v_mul_f32 v106, v106, v74
    v_mul_f32 v107, v107, v75
    v_mfma_f32_16x16x32_bf16 v[80:83], v[44:47], v[212:215], v[80:83]
    ds_read_b64_tr_b16 v[36:37], v2 offset:45056
    v_mul_f32 v108, v108, v76
    v_mfma_f32_16x16x32_bf16 v[80:83], v[40:43], v[208:211], v[80:83]
    ds_read_b64_tr_b16 v[38:39], v2 offset:47104
    v_mul_f32 v109, v109, v77
    v_mfma_f32_16x16x32_bf16 v[80:83], v[48:51], v[216:219], v[80:83]
    ds_read_b64_tr_b16 v[40:41], v2 offset:49152
    v_mul_f32 v110, v110, v78
    v_mfma_f32_16x16x32_bf16 v[80:83], v[52:55], v[220:223], v[80:83]
    ds_read_b64_tr_b16 v[42:43], v2 offset:51200
    v_mul_f32 v111, v111, v79
    v_mfma_f32_16x16x32_bf16 v[64:67], v[52:55], v[156:159], v[64:67]
    ds_read_b64_tr_b16 v[44:45], v2 offset:53248
    v_mul_f32 v120, v120, v88
    v_mfma_f32_16x16x32_bf16 v[64:67], v[48:51], v[152:155], v[64:67]
    ds_read_b64_tr_b16 v[46:47], v2 offset:55296
    v_mul_f32 v121, v121, v89
    s_waitcnt lgkmcnt(4)
    v_mfma_f32_16x16x32_bf16 v[68:71], v[24:27], v[128:131], 0
    ds_read_b64_tr_b16 v[48:49], v2 offset:57344
    v_mul_f32 v122, v122, v90
    v_mfma_f32_16x16x32_bf16 v[68:71], v[28:31], v[132:135], v[68:71]
    ds_read_b64_tr_b16 v[50:51], v2 offset:59392
    v_mul_f32 v123, v123, v91
    v_mfma_f32_16x16x32_bf16 v[84:87], v[28:31], v[196:199], 0
    s_branch L_pg2335x
L_pg2335:
    s_setpc_b64 s[30:31]
L_pg2335x:
    ds_read_b64_tr_b16 v[52:53], v2 offset:61440
    v_mul_f32 v124, v124, v92
    v_mfma_f32_16x16x32_bf16 v[84:87], v[24:27], v[192:195], v[84:87]
    ds_read_b64_tr_b16 v[54:55], v2 offset:63488
    v_mul_f32 v125, v125, v93
    v_mul_f32 v126, v126, v94
    v_mfma_f32_16x16x32_bf16 v[84:87], v[32:35], v[200:203], v[84:87]
    ds_read_b64_tr_b16 v[24:25], v3 offset:16384
    v_mul_f32 v127, v127, v95
    v_mfma_f32_16x16x32_bf16 v[84:87], v[36:39], v[204:207], v[84:87]
    ds_read_b64_tr_b16 v[26:27], v3 offset:18432
    v_cvt_pk_bf16_f32 v104, v104, v105
    v_mfma_f32_16x16x32_bf16 v[68:71], v[36:39], v[140:143], v[68:71]
    ds_read_b64_tr_b16 v[28:29], v3 offset:20480
    v_cvt_pk_bf16_f32 v105, v106, v107
    v_mfma_f32_16x16x32_bf16 v[68:71], v[32:35], v[136:139], v[68:71]
    ds_read_b64_tr_b16 v[30:31], v3 offset:22528
    v_cvt_pk_bf16_f32 v106, v108, v109
    s_waitcnt lgkmcnt(4)
    v_mfma_f32_16x16x32_bf16 v[68:71], v[40:43], v[144:147], v[68:71]
    ds_read_b64_tr_b16 v[32:33], v3 offset:40960
    v_cvt_pk_bf16_f32 v107, v110, v111
    v_mfma_f32_16x16x32_bf16 v[68:71], v[44:47], v[148:151], v[68:71]
    ds_read_b64_tr_b16 v[34:35], v3 offset:43008
    buffer_store_dwordx4 v[104:107], v7, s[64:67], s88 offen offset:2048 sc1
    v_mfma_f32_16x16x32_bf16 v[84:87], v[44:47], v[212:215], v[84:87]
    ds_read_b64_tr_b16 v[36:37], v3 offset:45056
    v_cvt_pk_bf16_f32 v120, v120, v121
    v_mfma_f32_16x16x32_bf16 v[84:87], v[40:43], v[208:211], v[84:87]
    ds_read_b64_tr_b16 v[38:39], v3 offset:47104
    v_cvt_pk_bf16_f32 v121, v122, v123
    v_mfma_f32_16x16x32_bf16 v[84:87], v[48:51], v[216:219], v[84:87]
    ds_read_b64_tr_b16 v[40:41], v3 offset:49152
    v_cvt_pk_bf16_f32 v122, v124, v125
    v_mfma_f32_16x16x32_bf16 v[84:87], v[52:55], v[220:223], v[84:87]
    ds_read_b64_tr_b16 v[42:43], v3 offset:51200
    v_cvt_pk_bf16_f32 v123, v126, v127
    buffer_store_dwordx4 v[120:123], v7, s[64:67], s88 offen offset:3072 sc1
    v_mfma_f32_16x16x32_bf16 v[68:71], v[52:55], v[156:159], v[68:71]
    ds_read_b64_tr_b16 v[44:45], v3 offset:53248
    v_mfma_f32_16x16x32_bf16 v[68:71], v[48:51], v[152:155], v[68:71]
    ds_read_b64_tr_b16 v[46:47], v3 offset:55296
    s_waitcnt lgkmcnt(4)
    v_mfma_f32_16x16x32_bf16 v[72:75], v[24:27], v[128:131], 0
    ds_read_b64_tr_b16 v[48:49], v3 offset:57344
    v_mfma_f32_16x16x32_bf16 v[72:75], v[28:31], v[132:135], v[72:75]
    ds_read_b64_tr_b16 v[50:51], v3 offset:59392
    v_mfma_f32_16x16x32_bf16 v[88:91], v[28:31], v[196:199], 0
    ds_read_b64_tr_b16 v[52:53], v3 offset:61440
    v_mfma_f32_16x16x32_bf16 v[88:91], v[24:27], v[192:195], v[88:91]
    ds_read_b64_tr_b16 v[54:55], v3 offset:63488
    v_mfma_f32_16x16x32_bf16 v[88:91], v[32:35], v[200:203], v[88:91]
    ds_read_b64_tr_b16 v[24:25], v4 offset:16384
    v_mfma_f32_16x16x32_bf16 v[88:91], v[36:39], v[204:207], v[88:91]
    ds_read_b64_tr_b16 v[26:27], v4 offset:18432
    v_mfma_f32_16x16x32_bf16 v[72:75], v[36:39], v[140:143], v[72:75]
    ds_read_b64_tr_b16 v[28:29], v4 offset:20480
    v_mfma_f32_16x16x32_bf16 v[72:75], v[32:35], v[136:139], v[72:75]
    ds_read_b64_tr_b16 v[30:31], v4 offset:22528
    s_waitcnt lgkmcnt(4)
    v_mfma_f32_16x16x32_bf16 v[72:75], v[40:43], v[144:147], v[72:75]
    ds_read_b64_tr_b16 v[32:33], v4 offset:40960
    v_mfma_f32_16x16x32_bf16 v[72:75], v[44:47], v[148:151], v[72:75]
    ds_read_b64_tr_b16 v[34:35], v4 offset:43008
    v_mfma_f32_16x16x32_bf16 v[88:91], v[44:47], v[212:215], v[88:91]
    ds_read_b64_tr_b16 v[36:37], v4 offset:45056
    v_mfma_f32_16x16x32_bf16 v[88:91], v[40:43], v[208:211], v[88:91]
    ds_read_b64_tr_b16 v[38:39], v4 offset:47104
    v_mfma_f32_16x16x32_bf16 v[88:91], v[48:51], v[216:219], v[88:91]
    ds_read_b64_tr_b16 v[40:41], v4 offset:49152
    v_mfma_f32_16x16x32_bf16 v[88:91], v[52:55], v[220:223], v[88:91]
    ds_read_b64_tr_b16 v[42:43], v4 offset:51200
    v_mfma_f32_16x16x32_bf16 v[72:75], v[52:55], v[156:159], v[72:75]
    ds_read_b64_tr_b16 v[44:45], v4 offset:53248
    v_mfma_f32_16x16x32_bf16 v[72:75], v[48:51], v[152:155], v[72:75]
    ds_read_b64_tr_b16 v[46:47], v4 offset:55296
    s_waitcnt lgkmcnt(4)
    v_mfma_f32_16x16x32_bf16 v[76:79], v[24:27], v[128:131], 0
    ds_read_b64_tr_b16 v[48:49], v4 offset:57344
    v_mfma_f32_16x16x32_bf16 v[76:79], v[28:31], v[132:135], v[76:79]
    ds_read_b64_tr_b16 v[50:51], v4 offset:59392
    v_mfma_f32_16x16x32_bf16 v[92:95], v[28:31], v[196:199], 0
    ds_read_b64_tr_b16 v[52:53], v4 offset:61440
    v_mfma_f32_16x16x32_bf16 v[92:95], v[24:27], v[192:195], v[92:95]
    ds_read_b64_tr_b16 v[54:55], v4 offset:63488
    v_mfma_f32_16x16x32_bf16 v[92:95], v[32:35], v[200:203], v[92:95]
    ds_read_b64_tr_b16 v[24:25], v1 offset:24576
    v_mfma_f32_16x16x32_bf16 v[92:95], v[36:39], v[204:207], v[92:95]
    ds_read_b64_tr_b16 v[26:27], v1 offset:26624
    v_mfma_f32_16x16x32_bf16 v[76:79], v[36:39], v[140:143], v[76:79]
    ds_read_b64_tr_b16 v[28:29], v1 offset:28672
    v_mfma_f32_16x16x32_bf16 v[76:79], v[32:35], v[136:139], v[76:79]
    ds_read_b64_tr_b16 v[30:31], v1 offset:30720
    s_waitcnt lgkmcnt(4)
    v_mfma_f32_16x16x32_bf16 v[76:79], v[40:43], v[144:147], v[76:79]
    ds_read_b64_tr_b16 v[32:33], v1 offset:32768
    v_mfma_f32_16x16x32_bf16 v[76:79], v[44:47], v[148:151], v[76:79]
    ds_read_b64_tr_b16 v[34:35], v1 offset:34816
    v_mfma_f32_16x16x32_bf16 v[92:95], v[44:47], v[212:215], v[92:95]
    ds_read_b64_tr_b16 v[36:37], v1 offset:36864
    v_mfma_f32_16x16x32_bf16 v[92:95], v[40:43], v[208:211], v[92:95]
    ds_read_b64_tr_b16 v[38:39], v1 offset:38912
    v_mfma_f32_16x16x32_bf16 v[92:95], v[48:51], v[216:219], v[92:95]
    s_barrier
    v_add_u32 v1, 0x10000, v1
    ds_read_b64_tr_b16 v[40:41], v1 offset:0
    v_mfma_f32_16x16x32_bf16 v[92:95], v[52:55], v[220:223], v[92:95]
    ds_read_b64_tr_b16 v[42:43], v1 offset:2048
    v_mfma_f32_16x16x32_bf16 v[76:79], v[52:55], v[156:159], v[76:79]
    ds_read_b64_tr_b16 v[44:45], v1 offset:4096
    v_mfma_f32_16x16x32_bf16 v[76:79], v[48:51], v[152:155], v[76:79]
    ds_read_b64_tr_b16 v[46:47], v1 offset:6144
    s_waitcnt lgkmcnt(4)
    v_mfma_f32_16x16x32_bf16 v[64:67], v[24:27], v[160:163], v[64:67]
    ds_read_b64_tr_b16 v[48:49], v1 offset:8192
    v_mfma_f32_16x16x32_bf16 v[64:67], v[28:31], v[164:167], v[64:67]
    ds_read_b64_tr_b16 v[50:51], v1 offset:10240
    v_mfma_f32_16x16x32_bf16 v[80:83], v[28:31], v[228:231], v[80:83]
    ds_read_b64_tr_b16 v[52:53], v1 offset:12288
    v_mfma_f32_16x16x32_bf16 v[80:83], v[24:27], v[224:227], v[80:83]
    ds_read_b64_tr_b16 v[54:55], v1 offset:14336
    v_mfma_f32_16x16x32_bf16 v[80:83], v[32:35], v[232:235], v[80:83]
    ds_read_b64_tr_b16 v[24:25], v2 offset:24576
    v_mfma_f32_16x16x32_bf16 v[80:83], v[36:39], v[236:239], v[80:83]
    ds_read_b64_tr_b16 v[26:27], v2 offset:26624
    v_mfma_f32_16x16x32_bf16 v[64:67], v[36:39], v[172:175], v[64:67]
    ds_read_b64_tr_b16 v[28:29], v2 offset:28672
    v_mfma_f32_16x16x32_bf16 v[64:67], v[32:35], v[168:171], v[64:67]
    ds_read_b64_tr_b16 v[30:31], v2 offset:30720
    s_waitcnt lgkmcnt(4)
    v_mfma_f32_16x16x32_bf16 v[64:67], v[40:43], v[176:179], v[64:67]
    ds_read_b64_tr_b16 v[32:33], v2 offset:32768
    v_mfma_f32_16x16x32_bf16 v[64:67], v[44:47], v[180:183], v[64:67]
    ds_read_b64_tr_b16 v[34:35], v2 offset:34816
    v_mfma_f32_16x16x32_bf16 v[80:83], v[44:47], v[244:247], v[80:83]
    ds_read_b64_tr_b16 v[36:37], v2 offset:36864
    s_add_u32 s81, s45, 8192
    s_waitcnt vmcnt(0)
    buffer_store_dword v10, v11, s[64:67], s81 offen sc1
    v_mfma_f32_16x16x32_bf16 v[80:83], v[40:43], v[240:243], v[80:83]
    ds_read_b64_tr_b16 v[38:39], v2 offset:38912
    v_mfma_f32_16x16x32_bf16 v[80:83], v[48:51], v[248:251], v[80:83]
    v_add_u32 v2, 0x10000, v2
    ds_read_b64_tr_b16 v[40:41], v2 offset:0
    s_add_u32 s98, s8, 0
    v_mfma_f32_16x16x32_bf16 v[80:83], v[52:55], v[252:255], v[80:83]
    ds_read_b64_tr_b16 v[42:43], v2 offset:2048
    buffer_load_dwordx4 v[128:131], v21, s[64:67], s98 offen offset:0 sc1
    v_mfma_f32_16x16x32_bf16 v[64:67], v[52:55], v[188:191], v[64:67]
    ds_read_b64_tr_b16 v[44:45], v2 offset:4096
    buffer_load_dwordx4 v[132:135], v21, s[64:67], s98 offen offset:2048 sc1
    v_mfma_f32_16x16x32_bf16 v[64:67], v[48:51], v[184:187], v[64:67]
    ds_read_b64_tr_b16 v[46:47], v2 offset:6144
    s_waitcnt lgkmcnt(4)
    v_mfma_f32_16x16x32_bf16 v[68:71], v[24:27], v[160:163], v[68:71]
    ds_read_b64_tr_b16 v[48:49], v2 offset:8192
    v_mfma_f32_16x16x32_bf16 v[68:71], v[28:31], v[164:167], v[68:71]
    ds_read_b64_tr_b16 v[50:51], v2 offset:10240
    v_mfma_f32_16x16x32_bf16 v[84:87], v[28:31], v[228:231], v[84:87]
    ds_read_b64_tr_b16 v[52:53], v2 offset:12288
    v_mfma_f32_16x16x32_bf16 v[84:87], v[24:27], v[224:227], v[84:87]
    ds_read_b64_tr_b16 v[54:55], v2 offset:14336
    v_mfma_f32_16x16x32_bf16 v[84:87], v[32:35], v[232:235], v[84:87]
    ds_read_b64_tr_b16 v[24:25], v3 offset:24576
    v_exp_f32_e64 v12, v64 clamp
    v_exp_f32_e64 v13, v65 clamp
    v_mfma_f32_16x16x32_bf16 v[84:87], v[36:39], v[236:239], v[84:87]
    ds_read_b64_tr_b16 v[26:27], v3 offset:26624
    v_exp_f32_e64 v14, v66 clamp
    v_mfma_f32_16x16x32_bf16 v[68:71], v[36:39], v[172:175], v[68:71]
    ds_read_b64_tr_b16 v[28:29], v3 offset:28672
    s_add_u32 s98, s9, 0
    v_mfma_f32_16x16x32_bf16 v[68:71], v[32:35], v[168:171], v[68:71]
    ds_read_b64_tr_b16 v[30:31], v3 offset:30720
    buffer_load_dwordx4 v[136:139], v21, s[64:67], s98 offen offset:0 sc1
    v_exp_f32_e64 v15, v67 clamp
    s_waitcnt lgkmcnt(4)
    v_mfma_f32_16x16x32_bf16 v[68:71], v[40:43], v[176:179], v[68:71]
    ds_read_b64_tr_b16 v[32:33], v3 offset:32768
    buffer_load_dwordx4 v[140:143], v21, s[64:67], s98 offen offset:2048 sc1
    v_mfma_f32_16x16x32_bf16 v[68:71], v[44:47], v[180:183], v[68:71]
    ds_read_b64_tr_b16 v[34:35], v3 offset:34816
    v_max_f32 v64, s77, v64
    v_mfma_f32_16x16x32_bf16 v[84:87], v[44:47], v[244:247], v[84:87]
    ds_read_b64_tr_b16 v[36:37], v3 offset:36864
    v_max_f32 v65, s77, v65
    v_max_f32 v66, s77, v66
    v_mfma_f32_16x16x32_bf16 v[84:87], v[40:43], v[240:243], v[84:87]
    ds_read_b64_tr_b16 v[38:39], v3 offset:38912
    v_max_f32 v67, s77, v67
    v_fmac_f32 v12, s76, v64
    v_mfma_f32_16x16x32_bf16 v[84:87], v[48:51], v[248:251], v[84:87]
    v_add_u32 v3, 0x10000, v3
    ds_read_b64_tr_b16 v[40:41], v3 offset:0
    v_fmac_f32 v13, s76, v65
    v_fmac_f32 v14, s76, v66
    v_mfma_f32_16x16x32_bf16 v[84:87], v[52:55], v[252:255], v[84:87]
    ds_read_b64_tr_b16 v[42:43], v3 offset:2048
    v_fmac_f32 v15, s76, v67
    v_mfma_f32_16x16x32_bf16 v[68:71], v[52:55], v[188:191], v[68:71]
    ds_read_b64_tr_b16 v[44:45], v3 offset:4096
    v_cvt_pk_bf16_f32 v64, v12, v13
    v_cvt_pk_bf16_f32 v65, v14, v15
    v_mfma_f32_16x16x32_bf16 v[68:71], v[48:51], v[184:187], v[68:71]
    ds_read_b64_tr_b16 v[46:47], v3 offset:6144
    v_exp_f32_e64 v16, v80 clamp
    s_waitcnt lgkmcnt(4)
    v_mfma_f32_16x16x32_bf16 v[72:75], v[24:27], v[160:163], v[72:75]
    ds_read_b64_tr_b16 v[48:49], v3 offset:8192
    s_add_u32 s98, s8, 16384
    v_exp_f32_e64 v17, v81 clamp
    v_mfma_f32_16x16x32_bf16 v[72:75], v[28:31], v[164:167], v[72:75]
    ds_read_b64_tr_b16 v[50:51], v3 offset:10240
    buffer_load_dwordx4 v[144:147], v21, s[64:67], s98 offen offset:0 sc1
    v_mfma_f32_16x16x32_bf16 v[88:91], v[28:31], v[228:231], v[88:91]
    ds_read_b64_tr_b16 v[52:53], v3 offset:12288
    buffer_load_dwordx4 v[208:211], v21, s[64:67], s98 offen offset:2048 sc1
    v_exp_f32_e64 v18, v82 clamp
    v_mfma_f32_16x16x32_bf16 v[88:91], v[24:27], v[224:227], v[88:91]
    ds_read_b64_tr_b16 v[54:55], v3 offset:14336
    v_mfma_f32_16x16x32_bf16 v[88:91], v[32:35], v[232:235], v[88:91]
    ds_read_b64_tr_b16 v[24:25], v4 offset:24576
    v_exp_f32_e64 v19, v83 clamp
    v_mfma_f32_16x16x32_bf16 v[88:91], v[36:39], v[236:239], v[88:91]
    ds_read_b64_tr_b16 v[26:27], v4 offset:26624
    v_max_f32 v80, s77, v80
    v_max_f32 v81, s77, v81
    v_mfma_f32_16x16x32_bf16 v[72:75], v[36:39], v[172:175], v[72:75]
    ds_read_b64_tr_b16 v[28:29], v4 offset:28672
    v_max_f32 v82, s77, v82
    v_max_f32 v83, s77, v83
    v_mfma_f32_16x16x32_bf16 v[72:75], v[32:35], v[168:171], v[72:75]
    ds_read_b64_tr_b16 v[30:31], v4 offset:30720
    v_fmac_f32 v16, s76, v80
    v_fmac_f32 v17, s76, v81
    s_waitcnt lgkmcnt(4)
    v_mfma_f32_16x16x32_bf16 v[72:75], v[40:43], v[176:179], v[72:75]
    ds_read_b64_tr_b16 v[32:33], v4 offset:32768
    v_fmac_f32 v18, s76, v82
    v_mfma_f32_16x16x32_bf16 v[72:75], v[44:47], v[180:183], v[72:75]
    ds_read_b64_tr_b16 v[34:35], v4 offset:34816
    v_fmac_f32 v19, s76, v83
    v_cvt_pk_bf16_f32 v80, v16, v17
    v_mfma_f32_16x16x32_bf16 v[88:91], v[44:47], v[244:247], v[88:91]
    ds_read_b64_tr_b16 v[36:37], v4 offset:36864
    s_add_u32 s98, s9, 16384
    v_cvt_pk_bf16_f32 v81, v18, v19
    v_mfma_f32_16x16x32_bf16 v[88:91], v[40:43], v[240:243], v[88:91]
    ds_read_b64_tr_b16 v[38:39], v4 offset:38912
    buffer_load_dwordx4 v[148:151], v21, s[64:67], s98 offen offset:0 sc1
    v_exp_f32_e64 v12, v68 clamp
    v_mfma_f32_16x16x32_bf16 v[88:91], v[48:51], v[248:251], v[88:91]
    v_add_u32 v4, 0x10000, v4
    ds_read_b64_tr_b16 v[40:41], v4 offset:0
    buffer_load_dwordx4 v[212:215], v21, s[64:67], s98 offen offset:2048 sc1
    v_exp_f32_e64 v13, v69 clamp
    v_mfma_f32_16x16x32_bf16 v[88:91], v[52:55], v[252:255], v[88:91]
    ds_read_b64_tr_b16 v[42:43], v4 offset:2048
    v_exp_f32_e64 v14, v70 clamp
    v_mfma_f32_16x16x32_bf16 v[72:75], v[52:55], v[188:191], v[72:75]
    ds_read_b64_tr_b16 v[44:45], v4 offset:4096
    v_mfma_f32_16x16x32_bf16 v[72:75], v[48:51], v[184:187], v[72:75]
    ds_read_b64_tr_b16 v[46:47], v4 offset:6144
    v_exp_f32_e64 v15, v71 clamp
    s_waitcnt lgkmcnt(4)
    v_mfma_f32_16x16x32_bf16 v[76:79], v[24:27], v[160:163], v[76:79]
    ds_read_b64_tr_b16 v[48:49], v4 offset:8192
    v_max_f32 v68, s77, v68
    v_max_f32 v69, s77, v69
    v_mfma_f32_16x16x32_bf16 v[76:79], v[28:31], v[164:167], v[76:79]
    ds_read_b64_tr_b16 v[50:51], v4 offset:10240
    v_max_f32 v70, s77, v70
    v_max_f32 v71, s77, v71
    v_mfma_f32_16x16x32_bf16 v[92:95], v[28:31], v[228:231], v[92:95]
    ds_read_b64_tr_b16 v[52:53], v4 offset:12288
    v_fmac_f32 v12, s76, v68
    v_fmac_f32 v13, s76, v69
    v_mfma_f32_16x16x32_bf16 v[92:95], v[24:27], v[224:227], v[92:95]
    ds_read_b64_tr_b16 v[54:55], v4 offset:14336
    v_fmac_f32 v14, s76, v70
    v_fmac_f32 v15, s76, v71
    v_mfma_f32_16x16x32_bf16 v[92:95], v[32:35], v[232:235], v[92:95]
    s_add_u32 s98, s8, 32768
    v_cvt_pk_bf16_f32 v68, v12, v13
    v_mfma_f32_16x16x32_bf16 v[92:95], v[36:39], v[236:239], v[92:95]
    buffer_load_dwordx4 v[152:155], v21, s[64:67], s98 offen offset:0 sc1
    v_cvt_pk_bf16_f32 v69, v14, v15
    v_mfma_f32_16x16x32_bf16 v[76:79], v[36:39], v[172:175], v[76:79]
    buffer_load_dwordx4 v[216:219], v21, s[64:67], s98 offen offset:2048 sc1
    v_exp_f32_e64 v16, v84 clamp
    v_mfma_f32_16x16x32_bf16 v[76:79], v[32:35], v[168:171], v[76:79]
    v_exp_f32_e64 v17, v85 clamp
    s_waitcnt lgkmcnt(0)
    v_mfma_f32_16x16x32_bf16 v[76:79], v[40:43], v[176:179], v[76:79]
    v_exp_f32_e64 v18, v86 clamp
    v_mfma_f32_16x16x32_bf16 v[76:79], v[44:47], v[180:183], v[76:79]
    v_exp_f32_e64 v19, v87 clamp
    v_mfma_f32_16x16x32_bf16 v[92:95], v[44:47], v[244:247], v[92:95]
    v_max_f32 v84, s77, v84
    v_max_f32 v85, s77, v85
    v_max_f32 v86, s77, v86
    v_mfma_f32_16x16x32_bf16 v[92:95], v[40:43], v[240:243], v[92:95]
    v_max_f32 v87, s77, v87
    v_fmac_f32 v16, s76, v84
    v_mfma_f32_16x16x32_bf16 v[92:95], v[48:51], v[248:251], v[92:95]
    v_fmac_f32 v17, s76, v85
    v_fmac_f32 v18, s76, v86
    v_mfma_f32_16x16x32_bf16 v[92:95], v[52:55], v[252:255], v[92:95]
    v_fmac_f32 v19, s76, v87
    v_cvt_pk_bf16_f32 v84, v16, v17
    v_mfma_f32_16x16x32_bf16 v[76:79], v[52:55], v[188:191], v[76:79]
    v_cvt_pk_bf16_f32 v85, v18, v19
    v_exp_f32_e64 v12, v72 clamp
    v_mfma_f32_16x16x32_bf16 v[76:79], v[48:51], v[184:187], v[76:79]
    s_barrier
    ds_read_b64 v[192:193], v5 offset:1024
    ds_read_b64 v[200:201], v6 offset:1536
    ds_read_b64 v[194:195], v5 offset:1600
    ds_read_b64 v[202:203], v6 offset:2112
    ds_read_b64 v[196:197], v5 offset:2176
    ds_read_b64 v[204:205], v6 offset:2688
    ds_read_b64 v[198:199], v5 offset:2752
    ds_read_b64 v[206:207], v6 offset:3264
    s_add_u32 s81, s9, 32768
    buffer_load_dwordx4 v[156:159], v21, s[64:67], s81 offen offset:0 sc1
    buffer_load_dwordx4 v[220:223], v21, s[64:67], s81 offen offset:2048 sc1
    v_exp_f32_e64 v13, v73 clamp
    v_exp_f32_e64 v14, v74 clamp
    v_exp_f32_e64 v15, v75 clamp
    v_max_f32 v72, s77, v72
    v_max_f32 v73, s77, v73
    v_max_f32 v74, s77, v74
    v_max_f32 v75, s77, v75
    v_fmac_f32 v12, s76, v72
    v_fmac_f32 v13, s76, v73
    v_fmac_f32 v14, s76, v74
    v_fmac_f32 v15, s76, v75
    v_cvt_pk_bf16_f32 v72, v12, v13
    v_cvt_pk_bf16_f32 v73, v14, v15
    v_exp_f32_e64 v16, v88 clamp
    v_exp_f32_e64 v17, v89 clamp
    v_exp_f32_e64 v18, v90 clamp
    v_exp_f32_e64 v19, v91 clamp
    v_max_f32 v88, s77, v88
    v_max_f32 v89, s77, v89
    v_max_f32 v90, s77, v90
    v_max_f32 v91, s77, v91
    v_fmac_f32 v16, s76, v88
    v_fmac_f32 v17, s76, v89
    v_fmac_f32 v18, s76, v90
    v_fmac_f32 v19, s76, v91
    v_cvt_pk_bf16_f32 v88, v16, v17
    v_cvt_pk_bf16_f32 v89, v18, v19
    v_exp_f32_e64 v12, v76 clamp
    s_waitcnt lgkmcnt(6)
    v_mfma_f32_16x16x16_bf16 v[96:99], v[200:201], v[64:65], 0
    v_exp_f32_e64 v13, v77 clamp
    v_exp_f32_e64 v14, v78 clamp
    v_exp_f32_e64 v15, v79 clamp
    v_mfma_f32_16x16x16_bf16 v[112:115], v[192:193], v[64:65], 0
    v_max_f32 v76, s77, v76
    v_max_f32 v77, s77, v77
    v_max_f32 v78, s77, v78
    v_mfma_f32_16x16x16_bf16 v[104:107], v[200:201], v[80:81], 0
    v_max_f32 v79, s77, v79
    v_fmac_f32 v12, s76, v76
    v_fmac_f32 v13, s76, v77
    v_mfma_f32_16x16x16_bf16 v[120:123], v[192:193], v[80:81], 0
    v_fmac_f32 v14, s76, v78
    v_fmac_f32 v15, s76, v79
    v_cvt_pk_bf16_f32 v76, v12, v13
    s_waitcnt lgkmcnt(4)
    v_mfma_f32_16x16x16_bf16 v[100:103], v[202:203], v[68:69], 0
    v_cvt_pk_bf16_f32 v77, v14, v15
    v_exp_f32_e64 v16, v92 clamp
    v_exp_f32_e64 v17, v93 clamp
    v_mfma_f32_16x16x16_bf16 v[116:119], v[194:195], v[68:69], 0
    v_exp_f32_e64 v18, v94 clamp
    v_exp_f32_e64 v19, v95 clamp
    v_max_f32 v92, s77, v92
    v_mfma_f32_16x16x16_bf16 v[108:111], v[202:203], v[84:85], 0
    v_max_f32 v93, s77, v93
    v_max_f32 v94, s77, v94
    v_max_f32 v95, s77, v95
    v_mfma_f32_16x16x16_bf16 v[124:127], v[194:195], v[84:85], 0
    v_fmac_f32 v16, s76, v92
    v_fmac_f32 v17, s76, v93
    v_fmac_f32 v18, s76, v94
    v_fmac_f32 v19, s76, v95
    v_cvt_pk_bf16_f32 v92, v16, v17
    v_cvt_pk_bf16_f32 v93, v18, v19
    v_add_f32 v96, s77, v96
    v_add_f32 v100, s77, v100
    v_rcp_f32 v96, v96
    v_rcp_f32 v100, v100
    v_mul_f32 v112, v112, v96
    v_mul_f32 v113, v113, v96
    v_mul_f32 v114, v114, v96
    v_mul_f32 v115, v115, v96
    v_mul_f32 v116, v116, v100
    v_mul_f32 v117, v117, v100
    v_mul_f32 v118, v118, v100
    v_mul_f32 v119, v119, v100
    v_cvt_pk_bf16_f32 v96, v112, v113
    v_cvt_pk_bf16_f32 v97, v114, v115
    v_cvt_pk_bf16_f32 v98, v116, v117
    v_cvt_pk_bf16_f32 v99, v118, v119
    buffer_store_dwordx4 v[96:99], v7, s[64:67], s89 offen offset:0 sc1
    v_add_f32 v104, s77, v104
    v_add_f32 v108, s77, v108
    s_waitcnt lgkmcnt(2)
    v_mfma_f32_16x16x16_bf16 v[96:99], v[204:205], v[72:73], 0
    v_rcp_f32 v104, v104
    v_rcp_f32 v108, v108
    v_mul_f32 v120, v120, v104
    v_mfma_f32_16x16x16_bf16 v[112:115], v[196:197], v[72:73], 0
    v_mul_f32 v121, v121, v104
    v_mul_f32 v122, v122, v104
    v_mul_f32 v123, v123, v104
    s_waitcnt lgkmcnt(0)
    v_mfma_f32_16x16x16_bf16 v[100:103], v[206:207], v[76:77], 0
    v_mul_f32 v124, v124, v108
    v_mul_f32 v125, v125, v108
    v_mul_f32 v126, v126, v108
    v_mfma_f32_16x16x16_bf16 v[116:119], v[198:199], v[76:77], 0
    v_mul_f32 v127, v127, v108
    v_cvt_pk_bf16_f32 v104, v120, v121
    v_cvt_pk_bf16_f32 v105, v122, v123
    v_cvt_pk_bf16_f32 v106, v124, v125
    v_cvt_pk_bf16_f32 v107, v126, v127
    buffer_store_dwordx4 v[104:107], v7, s[64:67], s89 offen offset:1024 sc1
    s_nop 1
    v_mfma_f32_16x16x16_bf16 v[104:107], v[204:205], v[88:89], 0
    v_add_f32 v96, s77, v96
    v_add_f32 v100, s77, v100
    v_mfma_f32_16x16x16_bf16 v[120:123], v[196:197], v[88:89], 0
    v_rcp_f32 v96, v96
    v_rcp_f32 v100, v100
    v_mul_f32 v112, v112, v96
    v_mfma_f32_16x16x16_bf16 v[108:111], v[206:207], v[92:93], 0
    v_mul_f32 v113, v113, v96
    v_mul_f32 v114, v114, v96
    v_mul_f32 v115, v115, v96
    v_mfma_f32_16x16x16_bf16 v[124:127], v[198:199], v[92:93], 0
    v_mul_f32 v116, v116, v100
    v_mul_f32 v117, v117, v100
    v_mul_f32 v118, v118, v100
    v_mul_f32 v119, v119, v100
    v_cvt_pk_bf16_f32 v96, v112, v113
    v_cvt_pk_bf16_f32 v97, v114, v115
    v_cvt_pk_bf16_f32 v98, v116, v117
    v_cvt_pk_bf16_f32 v99, v118, v119
    buffer_store_dwordx4 v[96:99], v7, s[64:67], s89 offen offset:2048 sc1
    v_add_u32 v1, v9, v1
    v_add_u32 v2, v9, v2
    v_add_u32 v3, v9, v3
    v_add_u32 v4, v9, v4
    ds_read_b64_tr_b16 v[24:25], v1 offset:16384
    ds_read_b64_tr_b16 v[26:27], v1 offset:18432
    ds_read_b64_tr_b16 v[28:29], v1 offset:20480
    ds_read_b64_tr_b16 v[30:31], v1 offset:22528
    ds_read_b64_tr_b16 v[32:33], v2 offset:16384
    ds_read_b64_tr_b16 v[34:35], v2 offset:18432
    ds_read_b64_tr_b16 v[36:37], v2 offset:20480
    ds_read_b64_tr_b16 v[38:39], v2 offset:22528
    ds_read_b64_tr_b16 v[40:41], v3 offset:16384
    ds_read_b64_tr_b16 v[42:43], v3 offset:18432
    ds_read_b64_tr_b16 v[44:45], v3 offset:20480
    ds_read_b64_tr_b16 v[46:47], v3 offset:22528
    v_add_f32 v104, s77, v104
    v_add_f32 v108, s77, v108
    v_rcp_f32 v104, v104
    v_rcp_f32 v108, v108
    v_mul_f32 v120, v120, v104
    v_mul_f32 v121, v121, v104
    v_mul_f32 v122, v122, v104
    v_mul_f32 v123, v123, v104
    v_mul_f32 v124, v124, v108
    v_mul_f32 v125, v125, v108
    v_mul_f32 v126, v126, v108
    v_mul_f32 v127, v127, v108
    v_cvt_pk_bf16_f32 v104, v120, v121
    v_cvt_pk_bf16_f32 v105, v122, v123
    v_cvt_pk_bf16_f32 v106, v124, v125
    v_cvt_pk_bf16_f32 v107, v126, v127
    buffer_store_dwordx4 v[104:107], v7, s[64:67], s89 offen offset:3072 sc1
    s_waitcnt vmcnt(12) lgkmcnt(4)
    v_mfma_f32_16x16x32_bf16 v[112:115], v[24:27], v[128:131], 0
    ds_read_b64_tr_b16 v[48:49], v4 offset:16384
    v_mfma_f32_16x16x32_bf16 v[112:115], v[28:31], v[132:135], v[112:115]
    ds_read_b64_tr_b16 v[50:51], v4 offset:18432
    s_add_u32 s81, s8, 49152
    v_mfma_f32_16x16x32_bf16 v[96:99], v[28:31], v[140:143], 0
    ds_read_b64_tr_b16 v[52:53], v4 offset:20480
    buffer_load_dwordx4 v[192:195], v21, s[64:67], s81 offen offset:0 sc1
    v_mfma_f32_16x16x32_bf16 v[96:99], v[24:27], v[136:139], v[96:99]
    ds_read_b64_tr_b16 v[54:55], v4 offset:22528
    buffer_load_dwordx4 v[196:199], v21, s[64:67], s81 offen offset:2048 sc1
    v_mfma_f32_16x16x32_bf16 v[116:119], v[32:35], v[128:131], 0
    v_add_u32 v1, 0xfffe0000, v1
    ds_read_b64_tr_b16 v[24:25], v1 offset:0
    v_mfma_f32_16x16x32_bf16 v[116:119], v[36:39], v[132:135], v[116:119]
    ds_read_b64_tr_b16 v[26:27], v1 offset:2048
    v_mfma_f32_16x16x32_bf16 v[100:103], v[36:39], v[140:143], 0
    ds_read_b64_tr_b16 v[28:29], v1 offset:4096
    v_mfma_f32_16x16x32_bf16 v[100:103], v[32:35], v[136:139], v[100:103]
    ds_read_b64_tr_b16 v[30:31], v1 offset:6144
    s_waitcnt lgkmcnt(4)
    v_mfma_f32_16x16x32_bf16 v[120:123], v[40:43], v[128:131], 0
    v_add_u32 v2, 0xfffe0000, v2
    ds_read_b64_tr_b16 v[32:33], v2 offset:0
    v_mfma_f32_16x16x32_bf16 v[120:123], v[44:47], v[132:135], v[120:123]
    ds_read_b64_tr_b16 v[34:35], v2 offset:2048
    s_add_u32 s81, s9, 49152
    v_mfma_f32_16x16x32_bf16 v[104:107], v[44:47], v[140:143], 0
    ds_read_b64_tr_b16 v[36:37], v2 offset:4096
    buffer_load_dwordx4 v[200:203], v21, s[64:67], s81 offen offset:0 sc1
    v_mfma_f32_16x16x32_bf16 v[104:107], v[40:43], v[136:139], v[104:107]
    ds_read_b64_tr_b16 v[38:39], v2 offset:6144
    buffer_load_dwordx4 v[204:207], v21, s[64:67], s81 offen offset:2048 sc1
    v_mfma_f32_16x16x32_bf16 v[124:127], v[48:51], v[128:131], 0
    v_add_u32 v3, 0xfffe0000, v3
    ds_read_b64_tr_b16 v[40:41], v3 offset:0
    v_mfma_f32_16x16x32_bf16 v[124:127], v[52:55], v[132:135], v[124:127]
    ds_read_b64_tr_b16 v[42:43], v3 offset:2048
    v_mfma_f32_16x16x32_bf16 v[108:111], v[52:55], v[140:143], 0
    ds_read_b64_tr_b16 v[44:45], v3 offset:4096
    v_mfma_f32_16x16x32_bf16 v[108:111], v[48:51], v[136:139], v[108:111]
    ds_read_b64_tr_b16 v[46:47], v3 offset:6144
    s_waitcnt lgkmcnt(8)
    s_barrier
    s_waitcnt vmcnt(12) lgkmcnt(4)
    v_mfma_f32_16x16x32_bf16 v[112:115], v[24:27], v[144:147], v[112:115]
    v_add_u32 v4, 0xfffe0000, v4
    ds_read_b64_tr_b16 v[48:49], v4 offset:0
    v_mfma_f32_16x16x32_bf16 v[112:115], v[28:31], v[208:211], v[112:115]
    ds_read_b64_tr_b16 v[50:51], v4 offset:2048
    s_add_u32 s81, s8, 196608
    v_mfma_f32_16x16x32_bf16 v[96:99], v[28:31], v[212:215], v[96:99]
    ds_read_b64_tr_b16 v[52:53], v4 offset:4096
    buffer_load_dwordx4 v[128:131], v21, s[64:67], s81 offen offset:0 sc1
    v_mfma_f32_16x16x32_bf16 v[96:99], v[24:27], v[148:151], v[96:99]
    ds_read_b64_tr_b16 v[54:55], v4 offset:6144
    buffer_load_dwordx4 v[132:135], v21, s[64:67], s81 offen offset:2048 sc1
    v_mfma_f32_16x16x32_bf16 v[116:119], v[32:35], v[144:147], v[116:119]
    ds_read_b64_tr_b16 v[24:25], v1 offset:8192
    v_mfma_f32_16x16x32_bf16 v[116:119], v[36:39], v[208:211], v[116:119]
    ds_read_b64_tr_b16 v[26:27], v1 offset:10240
    v_mfma_f32_16x16x32_bf16 v[100:103], v[36:39], v[212:215], v[100:103]
    ds_read_b64_tr_b16 v[28:29], v1 offset:12288
    v_mfma_f32_16x16x32_bf16 v[100:103], v[32:35], v[148:151], v[100:103]
    ds_read_b64_tr_b16 v[30:31], v1 offset:14336
    s_waitcnt lgkmcnt(4)
    v_mfma_f32_16x16x32_bf16 v[120:123], v[40:43], v[144:147], v[120:123]
    ds_read_b64_tr_b16 v[32:33], v2 offset:8192
    v_mfma_f32_16x16x32_bf16 v[120:123], v[44:47], v[208:211], v[120:123]
    ds_read_b64_tr_b16 v[34:35], v2 offset:10240
    s_add_u32 s81, s9, 196608
    v_mfma_f32_16x16x32_bf16 v[104:107], v[44:47], v[212:215], v[104:107]
    ds_read_b64_tr_b16 v[36:37], v2 offset:12288
    buffer_load_dwordx4 v[136:139], v21, s[64:67], s81 offen offset:0 sc1
    v_mfma_f32_16x16x32_bf16 v[104:107], v[40:43], v[148:151], v[104:107]
    ds_read_b64_tr_b16 v[38:39], v2 offset:14336
    buffer_load_dwordx4 v[140:143], v21, s[64:67], s81 offen offset:2048 sc1
    v_mfma_f32_16x16x32_bf16 v[124:127], v[48:51], v[144:147], v[124:127]
    ds_read_b64_tr_b16 v[40:41], v3 offset:8192
    v_mfma_f32_16x16x32_bf16 v[124:127], v[52:55], v[208:211], v[124:127]
    ds_read_b64_tr_b16 v[42:43], v3 offset:10240
    v_mfma_f32_16x16x32_bf16 v[108:111], v[52:55], v[212:215], v[108:111]
    ds_read_b64_tr_b16 v[44:45], v3 offset:12288
    v_mfma_f32_16x16x32_bf16 v[108:111], v[48:51], v[148:151], v[108:111]
    ds_read_b64_tr_b16 v[46:47], v3 offset:14336
    s_add_u32 s81, s47, 14336
    s_waitcnt vmcnt(8)
    buffer_store_dword v10, v11, s[64:67], s81 offen sc1
    s_waitcnt lgkmcnt(8)
    s_barrier
    s_waitcnt lgkmcnt(4)
    v_mfma_f32_16x16x32_bf16 v[112:115], v[24:27], v[152:155], v[112:115]
    ds_read_b64_tr_b16 v[48:49], v4 offset:8192
    v_mfma_f32_16x16x32_bf16 v[112:115], v[28:31], v[216:219], v[112:115]
    ds_read_b64_tr_b16 v[50:51], v4 offset:10240
    s_add_u32 s81, s8, 212992
    v_mfma_f32_16x16x32_bf16 v[96:99], v[28:31], v[220:223], v[96:99]
    ds_read_b64_tr_b16 v[52:53], v4 offset:12288
    buffer_load_dwordx4 v[144:147], v21, s[64:67], s81 offen offset:0 sc1
    v_mfma_f32_16x16x32_bf16 v[96:99], v[24:27], v[156:159], v[96:99]
    s_branch L_pg2926x
L_pg2926:
    s_setpc_b64 s[30:31]
L_pg2926x:
    ds_read_b64_tr_b16 v[54:55], v4 offset:14336
    buffer_load_dwordx4 v[208:211], v21, s[64:67], s81 offen offset:2048 sc1
    v_mfma_f32_16x16x32_bf16 v[116:119], v[32:35], v[152:155], v[116:119]
    ds_read_b64_tr_b16 v[24:25], v1 offset:16384
    v_mfma_f32_16x16x32_bf16 v[116:119], v[36:39], v[216:219], v[116:119]
    ds_read_b64_tr_b16 v[26:27], v1 offset:18432
    v_mfma_f32_16x16x32_bf16 v[100:103], v[36:39], v[220:223], v[100:103]
    ds_read_b64_tr_b16 v[28:29], v1 offset:20480
    v_mfma_f32_16x16x32_bf16 v[100:103], v[32:35], v[156:159], v[100:103]
    ds_read_b64_tr_b16 v[30:31], v1 offset:22528
    s_waitcnt lgkmcnt(4)
    v_mfma_f32_16x16x32_bf16 v[120:123], v[40:43], v[152:155], v[120:123]
    ds_read_b64_tr_b16 v[32:33], v2 offset:16384
    v_mfma_f32_16x16x32_bf16 v[120:123], v[44:47], v[216:219], v[120:123]
    ds_read_b64_tr_b16 v[34:35], v2 offset:18432
    s_add_u32 s81, s9, 212992
    v_mfma_f32_16x16x32_bf16 v[104:107], v[44:47], v[220:223], v[104:107]
    ds_read_b64_tr_b16 v[36:37], v2 offset:20480
    buffer_load_dwordx4 v[148:151], v21, s[64:67], s81 offen offset:0 sc1
    v_mfma_f32_16x16x32_bf16 v[104:107], v[40:43], v[156:159], v[104:107]
    ds_read_b64_tr_b16 v[38:39], v2 offset:22528
    buffer_load_dwordx4 v[212:215], v21, s[64:67], s81 offen offset:2048 sc1
    v_mfma_f32_16x16x32_bf16 v[124:127], v[48:51], v[152:155], v[124:127]
    ds_read_b64_tr_b16 v[40:41], v3 offset:16384
    v_mfma_f32_16x16x32_bf16 v[124:127], v[52:55], v[216:219], v[124:127]
    ds_read_b64_tr_b16 v[42:43], v3 offset:18432
    v_mfma_f32_16x16x32_bf16 v[108:111], v[52:55], v[220:223], v[108:111]
    ds_read_b64_tr_b16 v[44:45], v3 offset:20480
    v_mfma_f32_16x16x32_bf16 v[108:111], v[48:51], v[156:159], v[108:111]
    ds_read_b64_tr_b16 v[46:47], v3 offset:22528
    s_waitcnt lgkmcnt(8)
    s_barrier
    s_waitcnt vmcnt(9) lgkmcnt(4)
    v_mfma_f32_16x16x32_bf16 v[112:115], v[24:27], v[192:195], v[112:115]
    ds_read_b64_tr_b16 v[48:49], v4 offset:16384
    v_permlane16_swap_b32 v56, v58
    v_mfma_f32_16x16x32_bf16 v[112:115], v[28:31], v[196:199], v[112:115]
    ds_read_b64_tr_b16 v[50:51], v4 offset:18432
    s_add_u32 s81, s8, 131072
    v_mfma_f32_16x16x32_bf16 v[96:99], v[28:31], v[204:207], v[96:99]
    ds_read_b64_tr_b16 v[52:53], v4 offset:20480
    buffer_load_dwordx4 v[152:155], v21, s[64:67], s81 offen offset:0 sc1
    v_mfma_f32_16x16x32_bf16 v[96:99], v[24:27], v[200:203], v[96:99]
    ds_read_b64_tr_b16 v[54:55], v4 offset:22528
    buffer_load_dwordx4 v[216:219], v21, s[64:67], s81 offen offset:2048 sc1
    v_mfma_f32_16x16x32_bf16 v[116:119], v[32:35], v[192:195], v[116:119]
    ds_read_b64_tr_b16 v[24:25], v1 offset:24576
    v_permlane16_swap_b32 v57, v59
    v_mfma_f32_16x16x32_bf16 v[116:119], v[36:39], v[196:199], v[116:119]
    ds_read_b64_tr_b16 v[26:27], v1 offset:26624
    v_permlane16_swap_b32 v60, v62
    v_mfma_f32_16x16x32_bf16 v[100:103], v[36:39], v[204:207], v[100:103]
    ds_read_b64_tr_b16 v[28:29], v1 offset:28672
    v_permlane16_swap_b32 v61, v63
    v_mfma_f32_16x16x32_bf16 v[100:103], v[32:35], v[200:203], v[100:103]
    ds_read_b64_tr_b16 v[30:31], v1 offset:30720
    v_lshlrev_b32 v64, 16, v56
    s_waitcnt lgkmcnt(4)
    v_mfma_f32_16x16x32_bf16 v[120:123], v[40:43], v[192:195], v[120:123]
    ds_read_b64_tr_b16 v[32:33], v2 offset:24576
    v_and_b32 v65, s39, v56
    v_mfma_f32_16x16x32_bf16 v[120:123], v[44:47], v[196:199], v[120:123]
    ds_read_b64_tr_b16 v[34:35], v2 offset:26624
    s_add_u32 s81, s9, 131072
    v_mfma_f32_16x16x32_bf16 v[104:107], v[44:47], v[204:207], v[104:107]
    ds_read_b64_tr_b16 v[36:37], v2 offset:28672
    buffer_load_dwordx4 v[156:159], v21, s[64:67], s81 offen offset:0 sc1
    v_mfma_f32_16x16x32_bf16 v[104:107], v[40:43], v[200:203], v[104:107]
    ds_read_b64_tr_b16 v[38:39], v2 offset:30720
    buffer_load_dwordx4 v[220:223], v21, s[64:67], s81 offen offset:2048 sc1
    v_mfma_f32_16x16x32_bf16 v[124:127], v[48:51], v[192:195], v[124:127]
    ds_read_b64_tr_b16 v[40:41], v3 offset:24576
    v_lshlrev_b32 v66, 16, v57
    v_mfma_f32_16x16x32_bf16 v[124:127], v[52:55], v[196:199], v[124:127]
    ds_read_b64_tr_b16 v[42:43], v3 offset:26624
    v_and_b32 v67, s39, v57
    v_mfma_f32_16x16x32_bf16 v[108:111], v[52:55], v[204:207], v[108:111]
    ds_read_b64_tr_b16 v[44:45], v3 offset:28672
    v_lshlrev_b32 v68, 16, v58
    v_mfma_f32_16x16x32_bf16 v[108:111], v[48:51], v[200:203], v[108:111]
    ds_read_b64_tr_b16 v[46:47], v3 offset:30720
    v_and_b32 v69, s39, v58
    s_waitcnt vmcnt(9) lgkmcnt(4)
    v_mfma_f32_16x16x32_bf16 v[112:115], v[24:27], v[128:131], v[112:115]
    ds_read_b64_tr_b16 v[48:49], v4 offset:24576
    v_lshlrev_b32 v70, 16, v59
    v_mfma_f32_16x16x32_bf16 v[112:115], v[28:31], v[132:135], v[112:115]
    ds_read_b64_tr_b16 v[50:51], v4 offset:26624
    s_add_u32 s81, s8, 147456
    v_mfma_f32_16x16x32_bf16 v[96:99], v[28:31], v[140:143], v[96:99]
    ds_read_b64_tr_b16 v[52:53], v4 offset:28672
    buffer_load_dwordx4 v[192:195], v21, s[64:67], s81 offen offset:0 sc1
    v_mfma_f32_16x16x32_bf16 v[96:99], v[24:27], v[136:139], v[96:99]
    ds_read_b64_tr_b16 v[54:55], v4 offset:30720
    buffer_load_dwordx4 v[196:199], v21, s[64:67], s81 offen offset:2048 sc1
    v_mfma_f32_16x16x32_bf16 v[116:119], v[32:35], v[128:131], v[116:119]
    ds_read_b64_tr_b16 v[24:25], v1 offset:32768
    v_and_b32 v71, s39, v59
    v_mfma_f32_16x16x32_bf16 v[116:119], v[36:39], v[132:135], v[116:119]
    ds_read_b64_tr_b16 v[26:27], v1 offset:34816
    v_lshlrev_b32 v72, 16, v60
    v_mfma_f32_16x16x32_bf16 v[100:103], v[36:39], v[140:143], v[100:103]
    ds_read_b64_tr_b16 v[28:29], v1 offset:36864
    v_and_b32 v73, s39, v60
    v_mfma_f32_16x16x32_bf16 v[100:103], v[32:35], v[136:139], v[100:103]
    ds_read_b64_tr_b16 v[30:31], v1 offset:38912
    v_lshlrev_b32 v74, 16, v61
    s_waitcnt lgkmcnt(4)
    v_mfma_f32_16x16x32_bf16 v[120:123], v[40:43], v[128:131], v[120:123]
    ds_read_b64_tr_b16 v[32:33], v2 offset:32768
    v_and_b32 v75, s39, v61
    v_mfma_f32_16x16x32_bf16 v[120:123], v[44:47], v[132:135], v[120:123]
    ds_read_b64_tr_b16 v[34:35], v2 offset:34816
    s_add_u32 s81, s9, 147456
    v_mfma_f32_16x16x32_bf16 v[104:107], v[44:47], v[140:143], v[104:107]
    ds_read_b64_tr_b16 v[36:37], v2 offset:36864
    buffer_load_dwordx4 v[200:203], v21, s[64:67], s81 offen offset:0 sc1
    v_mfma_f32_16x16x32_bf16 v[104:107], v[40:43], v[136:139], v[104:107]
    ds_read_b64_tr_b16 v[38:39], v2 offset:38912
    buffer_load_dwordx4 v[204:207], v21, s[64:67], s81 offen offset:2048 sc1
    v_mfma_f32_16x16x32_bf16 v[124:127], v[48:51], v[128:131], v[124:127]
    ds_read_b64_tr_b16 v[40:41], v3 offset:32768
    v_lshlrev_b32 v76, 16, v62
    v_mfma_f32_16x16x32_bf16 v[124:127], v[52:55], v[132:135], v[124:127]
    ds_read_b64_tr_b16 v[42:43], v3 offset:34816
    v_and_b32 v77, s39, v62
    v_mfma_f32_16x16x32_bf16 v[108:111], v[52:55], v[140:143], v[108:111]
    ds_read_b64_tr_b16 v[44:45], v3 offset:36864
    v_lshlrev_b32 v78, 16, v63
    v_mfma_f32_16x16x32_bf16 v[108:111], v[48:51], v[136:139], v[108:111]
    ds_read_b64_tr_b16 v[46:47], v3 offset:38912
    v_and_b32 v79, s39, v63
    s_waitcnt lgkmcnt(8)
    s_barrier
    s_waitcnt vmcnt(8) lgkmcnt(4)
    v_mfma_f32_16x16x32_bf16 v[112:115], v[24:27], v[144:147], v[112:115]
    ds_read_b64_tr_b16 v[48:49], v4 offset:32768
    v_mov_b32 v12, 0x3f80
    v_mfma_f32_16x16x32_bf16 v[112:115], v[28:31], v[208:211], v[112:115]
    ds_read_b64_tr_b16 v[50:51], v4 offset:34816
    s_add_u32 s81, s8, 163840
    v_mfma_f32_16x16x32_bf16 v[96:99], v[28:31], v[212:215], v[96:99]
    ds_read_b64_tr_b16 v[52:53], v4 offset:36864
    buffer_load_dwordx4 v[128:131], v21, s[64:67], s81 offen offset:0 sc1
    v_mfma_f32_16x16x32_bf16 v[96:99], v[24:27], v[148:151], v[96:99]
    ds_read_b64_tr_b16 v[54:55], v4 offset:38912
    buffer_load_dwordx4 v[132:135], v21, s[64:67], s81 offen offset:2048 sc1
    v_mfma_f32_16x16x32_bf16 v[116:119], v[32:35], v[144:147], v[116:119]
    ds_read_b64_tr_b16 v[24:25], v1 offset:40960
    v_mov_b32 v13, 0x3f800000
    v_mfma_f32_16x16x32_bf16 v[116:119], v[36:39], v[208:211], v[116:119]
    ds_read_b64_tr_b16 v[26:27], v1 offset:43008
    v_lshlrev_b32 v15, 2, v0
    v_mfma_f32_16x16x32_bf16 v[100:103], v[36:39], v[212:215], v[100:103]
    ds_read_b64_tr_b16 v[28:29], v1 offset:45056
    v_mfma_f32_16x16x32_bf16 v[100:103], v[32:35], v[148:151], v[100:103]
    ds_read_b64_tr_b16 v[30:31], v1 offset:47104
    s_waitcnt lgkmcnt(4)
    v_mfma_f32_16x16x32_bf16 v[120:123], v[40:43], v[144:147], v[120:123]
    ds_read_b64_tr_b16 v[32:33], v2 offset:40960
    v_mfma_f32_16x16x32_bf16 v[120:123], v[44:47], v[208:211], v[120:123]
    ds_read_b64_tr_b16 v[34:35], v2 offset:43008
    s_add_u32 s81, s9, 163840
    v_mfma_f32_16x16x32_bf16 v[104:107], v[44:47], v[212:215], v[104:107]
    ds_read_b64_tr_b16 v[36:37], v2 offset:45056
    buffer_load_dwordx4 v[136:139], v21, s[64:67], s81 offen offset:0 sc1
    v_mfma_f32_16x16x32_bf16 v[104:107], v[40:43], v[148:151], v[104:107]
    ds_read_b64_tr_b16 v[38:39], v2 offset:47104
    buffer_load_dwordx4 v[140:143], v21, s[64:67], s81 offen offset:2048 sc1
    v_mfma_f32_16x16x32_bf16 v[124:127], v[48:51], v[144:147], v[124:127]
    ds_read_b64_tr_b16 v[40:41], v3 offset:40960
    v_mfma_f32_16x16x32_bf16 v[124:127], v[52:55], v[208:211], v[124:127]
    ds_read_b64_tr_b16 v[42:43], v3 offset:43008
    v_mfma_f32_16x16x32_bf16 v[108:111], v[52:55], v[212:215], v[108:111]
    ds_read_b64_tr_b16 v[44:45], v3 offset:45056
    v_mfma_f32_16x16x32_bf16 v[108:111], v[48:51], v[148:151], v[108:111]
    ds_read_b64_tr_b16 v[46:47], v3 offset:47104
    s_waitcnt vmcnt(8) lgkmcnt(4)
    v_mfma_f32_16x16x32_bf16 v[112:115], v[24:27], v[152:155], v[112:115]
    ds_read_b64_tr_b16 v[48:49], v4 offset:40960
    v_mfma_f32_16x16x32_bf16 v[112:115], v[28:31], v[216:219], v[112:115]
    ds_read_b64_tr_b16 v[50:51], v4 offset:43008
    s_add_u32 s81, s8, 180224
    v_mfma_f32_16x16x32_bf16 v[96:99], v[28:31], v[220:223], v[96:99]
    ds_read_b64_tr_b16 v[52:53], v4 offset:45056
    buffer_load_dwordx4 v[144:147], v21, s[64:67], s81 offen offset:0 sc1
    v_mfma_f32_16x16x32_bf16 v[96:99], v[24:27], v[156:159], v[96:99]
    ds_read_b64_tr_b16 v[54:55], v4 offset:47104
    buffer_load_dwordx4 v[208:211], v21, s[64:67], s81 offen offset:2048 sc1
    v_mfma_f32_16x16x32_bf16 v[116:119], v[32:35], v[152:155], v[116:119]
    ds_read_b64_tr_b16 v[24:25], v1 offset:49152
    v_mfma_f32_16x16x32_bf16 v[116:119], v[36:39], v[216:219], v[116:119]
    ds_read_b64_tr_b16 v[26:27], v1 offset:51200
    v_mfma_f32_16x16x32_bf16 v[100:103], v[36:39], v[220:223], v[100:103]
    ds_read_b64_tr_b16 v[28:29], v1 offset:53248
    v_mfma_f32_16x16x32_bf16 v[100:103], v[32:35], v[156:159], v[100:103]
    ds_read_b64_tr_b16 v[30:31], v1 offset:55296
    s_waitcnt lgkmcnt(4)
    v_mfma_f32_16x16x32_bf16 v[120:123], v[40:43], v[152:155], v[120:123]
    ds_read_b64_tr_b16 v[32:33], v2 offset:49152
    v_mfma_f32_16x16x32_bf16 v[120:123], v[44:47], v[216:219], v[120:123]
    ds_read_b64_tr_b16 v[34:35], v2 offset:51200
    s_add_u32 s81, s9, 180224
    v_mfma_f32_16x16x32_bf16 v[104:107], v[44:47], v[220:223], v[104:107]
    ds_read_b64_tr_b16 v[36:37], v2 offset:53248
    v_add_f32 v112, v112, v64
    v_add_f32 v113, v113, v65
    v_add_f32 v114, v114, v66
    v_add_f32 v115, v115, v67
    buffer_load_dwordx4 v[148:151], v21, s[64:67], s81 offen offset:0 sc1
    v_mfma_f32_16x16x32_bf16 v[104:107], v[40:43], v[156:159], v[104:107]
    ds_read_b64_tr_b16 v[38:39], v2 offset:55296
    buffer_load_dwordx4 v[212:215], v21, s[64:67], s81 offen offset:2048 sc1
    v_mfma_f32_16x16x32_bf16 v[124:127], v[48:51], v[152:155], v[124:127]
    ds_read_b64_tr_b16 v[40:41], v3 offset:49152
    v_mfma_f32_16x16x32_bf16 v[124:127], v[52:55], v[216:219], v[124:127]
    ds_read_b64_tr_b16 v[42:43], v3 offset:51200
    v_mfma_f32_16x16x32_bf16 v[108:111], v[52:55], v[220:223], v[108:111]
    ds_read_b64_tr_b16 v[44:45], v3 offset:53248
    v_add_f32 v116, v116, v68
    v_add_f32 v117, v117, v69
    v_add_f32 v118, v118, v70
    v_add_f32 v119, v119, v71
    v_mfma_f32_16x16x32_bf16 v[108:111], v[48:51], v[156:159], v[108:111]
    ds_read_b64_tr_b16 v[46:47], v3 offset:55296
    s_waitcnt lgkmcnt(8)
    s_barrier
    s_waitcnt vmcnt(8) lgkmcnt(4)
    v_mfma_f32_16x16x32_bf16 v[112:115], v[24:27], v[192:195], v[112:115]
    ds_read_b64_tr_b16 v[48:49], v4 offset:49152
    v_mfma_f32_16x16x32_bf16 v[112:115], v[28:31], v[196:199], v[112:115]
    ds_read_b64_tr_b16 v[50:51], v4 offset:51200
    s_add_u32 s81, s9, 65536
    v_mfma_f32_16x16x32_bf16 v[96:99], v[28:31], v[204:207], v[96:99]
    ds_read_b64_tr_b16 v[52:53], v4 offset:53248
    v_add_f32 v120, v120, v72
    v_add_f32 v121, v121, v73
    v_add_f32 v122, v122, v74
    v_add_f32 v123, v123, v75
    buffer_load_dwordx4 v[152:155], v21, s[64:67], s81 offen offset:0 sc1
    v_mfma_f32_16x16x32_bf16 v[96:99], v[24:27], v[200:203], v[96:99]
    ds_read_b64_tr_b16 v[54:55], v4 offset:55296
    buffer_load_dwordx4 v[216:219], v21, s[64:67], s81 offen offset:2048 sc1
    v_mfma_f32_16x16x32_bf16 v[116:119], v[32:35], v[192:195], v[116:119]
    ds_read_b64_tr_b16 v[24:25], v1 offset:57344
    v_mfma_f32_16x16x32_bf16 v[116:119], v[36:39], v[196:199], v[116:119]
    ds_read_b64_tr_b16 v[26:27], v1 offset:59392
    v_mfma_f32_16x16x32_bf16 v[100:103], v[36:39], v[204:207], v[100:103]
    ds_read_b64_tr_b16 v[28:29], v1 offset:61440
    v_add_f32 v124, v124, v76
    v_add_f32 v125, v125, v77
    v_add_f32 v126, v126, v78
    v_add_f32 v127, v127, v79
    v_mfma_f32_16x16x32_bf16 v[100:103], v[32:35], v[200:203], v[100:103]
    ds_read_b64_tr_b16 v[30:31], v1 offset:63488
    s_waitcnt lgkmcnt(4)
    v_mfma_f32_16x16x32_bf16 v[120:123], v[40:43], v[192:195], v[120:123]
    ds_read_b64_tr_b16 v[32:33], v2 offset:57344
    v_mfma_f32_16x16x32_bf16 v[120:123], v[44:47], v[196:199], v[120:123]
    ds_read_b64_tr_b16 v[34:35], v2 offset:59392
    s_add_u32 s81, s9, 81920
    v_mfma_f32_16x16x32_bf16 v[104:107], v[44:47], v[204:207], v[104:107]
    ds_read_b64_tr_b16 v[36:37], v2 offset:61440
    buffer_load_dwordx4 v[156:159], v21, s[64:67], s81 offen offset:0 sc1
    v_mfma_f32_16x16x32_bf16 v[104:107], v[40:43], v[200:203], v[104:107]
    ds_read_b64_tr_b16 v[38:39], v2 offset:63488
    buffer_load_dwordx4 v[220:223], v21, s[64:67], s81 offen offset:2048 sc1
    v_mfma_f32_16x16x32_bf16 v[124:127], v[48:51], v[192:195], v[124:127]
    ds_read_b64_tr_b16 v[40:41], v3 offset:57344
    v_mfma_f32_16x16x32_bf16 v[124:127], v[52:55], v[196:199], v[124:127]
    ds_read_b64_tr_b16 v[42:43], v3 offset:59392
    v_mfma_f32_16x16x32_bf16 v[108:111], v[52:55], v[204:207], v[108:111]
    ds_read_b64_tr_b16 v[44:45], v3 offset:61440
    v_mfma_f32_16x16x32_bf16 v[108:111], v[48:51], v[200:203], v[108:111]
    ds_read_b64_tr_b16 v[46:47], v3 offset:63488
    s_waitcnt vmcnt(8) lgkmcnt(4)
    v_mfma_f32_16x16x32_bf16 v[112:115], v[24:27], v[128:131], v[112:115]
    ds_read_b64_tr_b16 v[48:49], v4 offset:57344
    v_mfma_f32_16x16x32_bf16 v[112:115], v[28:31], v[132:135], v[112:115]
    ds_read_b64_tr_b16 v[50:51], v4 offset:59392
    s_add_u32 s81, s9, 98304
    v_mfma_f32_16x16x32_bf16 v[96:99], v[28:31], v[140:143], v[96:99]
    ds_read_b64_tr_b16 v[52:53], v4 offset:61440
    buffer_load_dwordx4 v[192:195], v21, s[64:67], s81 offen offset:0 sc1
    v_mfma_f32_16x16x32_bf16 v[96:99], v[24:27], v[136:139], v[96:99]
    ds_read_b64_tr_b16 v[54:55], v4 offset:63488
    buffer_load_dwordx4 v[196:199], v21, s[64:67], s81 offen offset:2048 sc1
    v_mfma_f32_16x16x32_bf16 v[116:119], v[32:35], v[128:131], v[116:119]
    v_add_u32 v1, 0x10000, v1
    ds_read_b64_tr_b16 v[24:25], v1 offset:0
    v_mfma_f32_16x16x32_bf16 v[116:119], v[36:39], v[132:135], v[116:119]
    ds_read_b64_tr_b16 v[26:27], v1 offset:2048
    v_mfma_f32_16x16x32_bf16 v[100:103], v[36:39], v[140:143], v[100:103]
    ds_read_b64_tr_b16 v[28:29], v1 offset:4096
    v_mfma_f32_16x16x32_bf16 v[100:103], v[32:35], v[136:139], v[100:103]
    ds_read_b64_tr_b16 v[30:31], v1 offset:6144
    s_waitcnt lgkmcnt(4)
    v_mfma_f32_16x16x32_bf16 v[120:123], v[40:43], v[128:131], v[120:123]
    v_add_u32 v2, 0x10000, v2
    ds_read_b64_tr_b16 v[32:33], v2 offset:0
    v_mfma_f32_16x16x32_bf16 v[120:123], v[44:47], v[132:135], v[120:123]
    ds_read_b64_tr_b16 v[34:35], v2 offset:2048
    s_add_u32 s81, s9, 114688
    v_mfma_f32_16x16x32_bf16 v[104:107], v[44:47], v[140:143], v[104:107]
    ds_read_b64_tr_b16 v[36:37], v2 offset:4096
    buffer_load_dwordx4 v[200:203], v21, s[64:67], s81 offen offset:0 sc1
    v_mfma_f32_16x16x32_bf16 v[104:107], v[40:43], v[136:139], v[104:107]
    ds_read_b64_tr_b16 v[38:39], v2 offset:6144
    buffer_load_dwordx4 v[204:207], v21, s[64:67], s81 offen offset:2048 sc1
    v_mfma_f32_16x16x32_bf16 v[124:127], v[48:51], v[128:131], v[124:127]
    v_add_u32 v3, 0x10000, v3
    ds_read_b64_tr_b16 v[40:41], v3 offset:0
    v_mfma_f32_16x16x32_bf16 v[124:127], v[52:55], v[132:135], v[124:127]
    ds_read_b64_tr_b16 v[42:43], v3 offset:2048
    v_mfma_f32_16x16x32_bf16 v[108:111], v[52:55], v[140:143], v[108:111]
    ds_read_b64_tr_b16 v[44:45], v3 offset:4096
    v_mfma_f32_16x16x32_bf16 v[108:111], v[48:51], v[136:139], v[108:111]
    ds_read_b64_tr_b16 v[46:47], v3 offset:6144
    s_waitcnt vmcnt(8) lgkmcnt(4)
    v_mfma_f32_16x16x32_bf16 v[112:115], v[24:27], v[144:147], v[112:115]
    v_add_u32 v4, 0x10000, v4
    ds_read_b64_tr_b16 v[48:49], v4 offset:0
    v_mfma_f32_16x16x32_bf16 v[112:115], v[28:31], v[208:211], v[112:115]
    ds_read_b64_tr_b16 v[50:51], v4 offset:2048
    s_add_u32 s81, s8, 65536
    v_mfma_f32_16x16x32_bf16 v[96:99], v[28:31], v[212:215], v[96:99]
    ds_read_b64_tr_b16 v[52:53], v4 offset:4096
    buffer_load_dwordx4 v[128:131], v21, s[64:67], s81 offen offset:0 sc1
    v_mfma_f32_16x16x32_bf16 v[96:99], v[24:27], v[148:151], v[96:99]
    ds_read_b64_tr_b16 v[54:55], v4 offset:6144
    buffer_load_dwordx4 v[132:135], v21, s[64:67], s81 offen offset:2048 sc1
    v_mfma_f32_16x16x32_bf16 v[116:119], v[32:35], v[144:147], v[116:119]
    ds_read_b64_tr_b16 v[24:25], v1 offset:8192
    v_mfma_f32_16x16x32_bf16 v[116:119], v[36:39], v[208:211], v[116:119]
    ds_read_b64_tr_b16 v[26:27], v1 offset:10240
    v_mfma_f32_16x16x32_bf16 v[100:103], v[36:39], v[212:215], v[100:103]
    ds_read_b64_tr_b16 v[28:29], v1 offset:12288
    v_mfma_f32_16x16x32_bf16 v[100:103], v[32:35], v[148:151], v[100:103]
    ds_read_b64_tr_b16 v[30:31], v1 offset:14336
    s_waitcnt lgkmcnt(4)
    v_mfma_f32_16x16x32_bf16 v[120:123], v[40:43], v[144:147], v[120:123]
    ds_read_b64_tr_b16 v[32:33], v2 offset:8192
    v_mfma_f32_16x16x32_bf16 v[120:123], v[44:47], v[208:211], v[120:123]
    ds_read_b64_tr_b16 v[34:35], v2 offset:10240
    s_add_u32 s81, s8, 81920
    v_mfma_f32_16x16x32_bf16 v[104:107], v[44:47], v[212:215], v[104:107]
    ds_read_b64_tr_b16 v[36:37], v2 offset:12288
    buffer_load_dwordx4 v[136:139], v21, s[64:67], s81 offen offset:0 sc1
    v_mfma_f32_16x16x32_bf16 v[104:107], v[40:43], v[148:151], v[104:107]
    ds_read_b64_tr_b16 v[38:39], v2 offset:14336
    buffer_load_dwordx4 v[140:143], v21, s[64:67], s81 offen offset:2048 sc1
    v_mfma_f32_16x16x32_bf16 v[124:127], v[48:51], v[144:147], v[124:127]
    ds_read_b64_tr_b16 v[40:41], v3 offset:8192
    v_mfma_f32_16x16x32_bf16 v[124:127], v[52:55], v[208:211], v[124:127]
    ds_read_b64_tr_b16 v[42:43], v3 offset:10240
    v_mfma_f32_16x16x32_bf16 v[108:111], v[52:55], v[212:215], v[108:111]
    ds_read_b64_tr_b16 v[44:45], v3 offset:12288
    v_mfma_f32_16x16x32_bf16 v[108:111], v[48:51], v[148:151], v[108:111]
    ds_read_b64_tr_b16 v[46:47], v3 offset:14336
    s_waitcnt lgkmcnt(8)
    s_barrier
    s_waitcnt vmcnt(10)
    v_mfma_f32_16x16x32_bf16 v[96:99], v[24:27], v[152:155], v[96:99]
    ds_read_b64_tr_b16 v[48:49], v4 offset:8192
    ds_read_b64_tr_b16 v[50:51], v4 offset:10240
    v_mfma_f32_16x16x32_bf16 v[96:99], v[28:31], v[216:219], v[96:99]
    ds_read_b64_tr_b16 v[52:53], v4 offset:12288
    ds_read_b64_tr_b16 v[54:55], v4 offset:14336
    s_add_u32 s81, s10, 229376
    buffer_load_dwordx4 v[144:147], v21, s[64:67], s81 offen offset:0 sc1
    buffer_load_dwordx4 v[208:211], v21, s[64:67], s81 offen offset:2048 sc1
    s_waitcnt lgkmcnt(8)
    v_mfma_f32_16x16x32_bf16 v[100:103], v[32:35], v[152:155], v[100:103]
    ds_read_b64_tr_b16 v[24:25], v1 offset:16384
    ds_read_b64_tr_b16 v[26:27], v1 offset:18432
    v_mfma_f32_16x16x32_bf16 v[100:103], v[36:39], v[216:219], v[100:103]
    ds_read_b64_tr_b16 v[28:29], v1 offset:20480
    ds_read_b64_tr_b16 v[30:31], v1 offset:22528
    s_waitcnt lgkmcnt(8)
    v_mfma_f32_16x16x32_bf16 v[104:107], v[40:43], v[152:155], v[104:107]
    ds_read_b64_tr_b16 v[32:33], v2 offset:16384
    ds_read_b64_tr_b16 v[34:35], v2 offset:18432
    v_mfma_f32_16x16x32_bf16 v[104:107], v[44:47], v[216:219], v[104:107]
    ds_read_b64_tr_b16 v[36:37], v2 offset:20480
    ds_read_b64_tr_b16 v[38:39], v2 offset:22528
    s_waitcnt lgkmcnt(8)
    v_mfma_f32_16x16x32_bf16 v[108:111], v[48:51], v[152:155], v[108:111]
    ds_read_b64_tr_b16 v[40:41], v3 offset:16384
    ds_read_b64_tr_b16 v[42:43], v3 offset:18432
    v_mfma_f32_16x16x32_bf16 v[108:111], v[52:55], v[216:219], v[108:111]
    ds_read_b64_tr_b16 v[44:45], v3 offset:20480
    ds_read_b64_tr_b16 v[46:47], v3 offset:22528
    s_waitcnt vmcnt(10) lgkmcnt(8)
    v_mfma_f32_16x16x32_bf16 v[96:99], v[24:27], v[156:159], v[96:99]
    ds_read_b64_tr_b16 v[48:49], v4 offset:16384
    ds_read_b64_tr_b16 v[50:51], v4 offset:18432
    v_mfma_f32_16x16x32_bf16 v[96:99], v[28:31], v[220:223], v[96:99]
    ds_read_b64_tr_b16 v[52:53], v4 offset:20480
    ds_read_b64_tr_b16 v[54:55], v4 offset:22528
    s_add_u32 s81, s10, 237568
    buffer_load_dwordx4 v[148:151], v21, s[64:67], s81 offen offset:0 sc1
    buffer_load_dwordx4 v[212:215], v21, s[64:67], s81 offen offset:2048 sc1
    s_waitcnt lgkmcnt(8)
    v_mfma_f32_16x16x32_bf16 v[100:103], v[32:35], v[156:159], v[100:103]
    ds_read_b64_tr_b16 v[160:161], v1 offset:40960
    ds_read_b64_tr_b16 v[162:163], v1 offset:43008
    v_mfma_f32_16x16x32_bf16 v[100:103], v[36:39], v[220:223], v[100:103]
    ds_read_b64_tr_b16 v[224:225], v1 offset:45056
    ds_read_b64_tr_b16 v[226:227], v1 offset:47104
    s_waitcnt lgkmcnt(8)
    v_mfma_f32_16x16x32_bf16 v[104:107], v[40:43], v[156:159], v[104:107]
    ds_read_b64_tr_b16 v[164:165], v2 offset:40960
    ds_read_b64_tr_b16 v[166:167], v2 offset:43008
    v_mfma_f32_16x16x32_bf16 v[104:107], v[44:47], v[220:223], v[104:107]
    ds_read_b64_tr_b16 v[228:229], v2 offset:45056
    ds_read_b64_tr_b16 v[230:231], v2 offset:47104
    s_waitcnt lgkmcnt(8)
    v_mfma_f32_16x16x32_bf16 v[108:111], v[48:51], v[156:159], v[108:111]
    ds_read_b64_tr_b16 v[168:169], v3 offset:40960
    ds_read_b64_tr_b16 v[170:171], v3 offset:43008
    v_mfma_f32_16x16x32_bf16 v[108:111], v[52:55], v[220:223], v[108:111]
    ds_read_b64_tr_b16 v[232:233], v3 offset:45056
    ds_read_b64_tr_b16 v[234:235], v3 offset:47104
    s_waitcnt vmcnt(10) lgkmcnt(8)
    v_mfma_f32_16x16x32_bf16 v[96:99], v[160:163], v[192:195], v[96:99]
    ds_read_b64_tr_b16 v[172:173], v4 offset:40960
    ds_read_b64_tr_b16 v[174:175], v4 offset:43008
    v_mfma_f32_16x16x32_bf16 v[96:99], v[224:227], v[196:199], v[96:99]
    ds_read_b64_tr_b16 v[236:237], v4 offset:45056
    ds_read_b64_tr_b16 v[238:239], v4 offset:47104
    s_add_u32 s81, s10, 245760
    buffer_load_dwordx4 v[152:155], v21, s[64:67], s81 offen offset:0 sc1
    buffer_load_dwordx4 v[216:219], v21, s[64:67], s81 offen offset:2048 sc1
    s_waitcnt lgkmcnt(8)
    v_mfma_f32_16x16x32_bf16 v[100:103], v[164:167], v[192:195], v[100:103]
    ds_read_b64_tr_b16 v[176:177], v1 offset:49152
    ds_read_b64_tr_b16 v[178:179], v1 offset:51200
    v_mfma_f32_16x16x32_bf16 v[100:103], v[228:231], v[196:199], v[100:103]
    ds_read_b64_tr_b16 v[240:241], v1 offset:53248
    ds_read_b64_tr_b16 v[242:243], v1 offset:55296
    s_waitcnt lgkmcnt(8)
    v_mfma_f32_16x16x32_bf16 v[104:107], v[168:171], v[192:195], v[104:107]
    ds_read_b64_tr_b16 v[180:181], v2 offset:49152
    ds_read_b64_tr_b16 v[182:183], v2 offset:51200
    v_mfma_f32_16x16x32_bf16 v[104:107], v[232:235], v[196:199], v[104:107]
    ds_read_b64_tr_b16 v[244:245], v2 offset:53248
    ds_read_b64_tr_b16 v[246:247], v2 offset:55296
    s_waitcnt lgkmcnt(8)
    v_mfma_f32_16x16x32_bf16 v[108:111], v[172:175], v[192:195], v[108:111]
    ds_read_b64_tr_b16 v[184:185], v3 offset:49152
    ds_read_b64_tr_b16 v[186:187], v3 offset:51200
    v_mfma_f32_16x16x32_bf16 v[108:111], v[236:239], v[196:199], v[108:111]
    ds_read_b64_tr_b16 v[248:249], v3 offset:53248
    ds_read_b64_tr_b16 v[250:251], v3 offset:55296
    s_waitcnt vmcnt(10) lgkmcnt(8)
    v_mfma_f32_16x16x32_bf16 v[96:99], v[176:179], v[200:203], v[96:99]
    ds_read_b64_tr_b16 v[188:189], v4 offset:49152
    ds_read_b64_tr_b16 v[190:191], v4 offset:51200
    v_mfma_f32_16x16x32_bf16 v[96:99], v[240:243], v[204:207], v[96:99]
    ds_read_b64_tr_b16 v[252:253], v4 offset:53248
    ds_read_b64_tr_b16 v[254:255], v4 offset:55296
    s_add_u32 s81, s10, 253952
    buffer_load_dwordx4 v[156:159], v21, s[64:67], s81 offen offset:0 sc1
    buffer_load_dwordx4 v[220:223], v21, s[64:67], s81 offen offset:2048 sc1
    s_waitcnt lgkmcnt(8)
    v_mfma_f32_16x16x32_bf16 v[100:103], v[180:183], v[200:203], v[100:103]
    ds_read_b64_tr_b16 v[24:25], v1 offset:8192
    ds_read_b64_tr_b16 v[26:27], v1 offset:10240
    v_mfma_f32_16x16x32_bf16 v[100:103], v[244:247], v[204:207], v[100:103]
    ds_read_b64_tr_b16 v[28:29], v1 offset:12288
    ds_read_b64_tr_b16 v[30:31], v1 offset:14336
    s_waitcnt lgkmcnt(8)
    v_mfma_f32_16x16x32_bf16 v[104:107], v[184:187], v[200:203], v[104:107]
    ds_read_b64_tr_b16 v[32:33], v2 offset:8192
    ds_read_b64_tr_b16 v[34:35], v2 offset:10240
    v_mfma_f32_16x16x32_bf16 v[104:107], v[248:251], v[204:207], v[104:107]
    ds_read_b64_tr_b16 v[36:37], v2 offset:12288
    ds_read_b64_tr_b16 v[38:39], v2 offset:14336
    v_cvt_pk_bf16_f32 v96, v96, v97
    v_cvt_pk_bf16_f32 v97, v98, v99
    v_add3_u32 v14, v10, v96, v97
    s_waitcnt lgkmcnt(8)
    v_mfma_f32_16x16x32_bf16 v[108:111], v[188:191], v[200:203], v[108:111]
    ds_read_b64_tr_b16 v[40:41], v3 offset:8192
    ds_read_b64_tr_b16 v[42:43], v3 offset:10240
    v_mfma_f32_16x16x32_bf16 v[108:111], v[252:255], v[204:207], v[108:111]
    ds_read_b64_tr_b16 v[44:45], v3 offset:12288
    ds_read_b64_tr_b16 v[46:47], v3 offset:14336
    v_cvt_pk_bf16_f32 v98, v100, v101
    v_cvt_pk_bf16_f32 v99, v102, v103
    v_add3_u32 v14, v14, v98, v99
    buffer_store_dwordx4 v[96:99], v7, s[64:67], s11 offen offset:0 sc1
    s_waitcnt vmcnt(11) lgkmcnt(8)
    v_mfma_f32_16x16x32_bf16 v[112:115], v[24:27], v[128:131], v[112:115]
    ds_read_b64_tr_b16 v[48:49], v4 offset:8192
    ds_read_b64_tr_b16 v[50:51], v4 offset:10240
    v_mfma_f32_16x16x32_bf16 v[112:115], v[28:31], v[132:135], v[112:115]
    ds_read_b64_tr_b16 v[52:53], v4 offset:12288
    ds_read_b64_tr_b16 v[54:55], v4 offset:14336
    s_add_u32 s81, s10, 262144
    buffer_load_dwordx4 v[192:195], v21, s[64:67], s81 offen offset:0 sc1
    buffer_load_dwordx4 v[196:199], v21, s[64:67], s81 offen offset:2048 sc1
    v_cvt_pk_bf16_f32 v100, v104, v105
    v_cvt_pk_bf16_f32 v101, v106, v107
    v_add3_u32 v14, v14, v100, v101
    s_waitcnt lgkmcnt(8)
    v_mfma_f32_16x16x32_bf16 v[116:119], v[32:35], v[128:131], v[116:119]
    ds_read_b64_tr_b16 v[24:25], v1 offset:16384
    ds_read_b64_tr_b16 v[26:27], v1 offset:18432
    v_mfma_f32_16x16x32_bf16 v[116:119], v[36:39], v[132:135], v[116:119]
    ds_read_b64_tr_b16 v[28:29], v1 offset:20480
    ds_read_b64_tr_b16 v[30:31], v1 offset:22528
    v_cvt_pk_bf16_f32 v102, v108, v109
    v_cvt_pk_bf16_f32 v103, v110, v111
    v_add3_u32 v14, v14, v102, v103
    buffer_store_dwordx4 v[100:103], v7, s[64:67], s11 offen offset:1024 sc1
    buffer_store_dword v14, v15, s[64:67], s11 offen offset:2048 sc1
    s_waitcnt lgkmcnt(8)
    v_mfma_f32_16x16x32_bf16 v[120:123], v[40:43], v[128:131], v[120:123]
    ds_read_b64_tr_b16 v[32:33], v2 offset:16384
    ds_read_b64_tr_b16 v[34:35], v2 offset:18432
    v_mfma_f32_16x16x32_bf16 v[120:123], v[44:47], v[132:135], v[120:123]
    ds_read_b64_tr_b16 v[36:37], v2 offset:20480
    ds_read_b64_tr_b16 v[38:39], v2 offset:22528
    s_waitcnt lgkmcnt(8)
    v_mfma_f32_16x16x32_bf16 v[124:127], v[48:51], v[128:131], v[124:127]
    ds_read_b64_tr_b16 v[40:41], v3 offset:16384
    ds_read_b64_tr_b16 v[42:43], v3 offset:18432
    v_mfma_f32_16x16x32_bf16 v[124:127], v[52:55], v[132:135], v[124:127]
    ds_read_b64_tr_b16 v[44:45], v3 offset:20480
    ds_read_b64_tr_b16 v[46:47], v3 offset:22528
    s_waitcnt vmcnt(13) lgkmcnt(8)
    v_mfma_f32_16x16x32_bf16 v[112:115], v[24:27], v[136:139], v[112:115]
    ds_read_b64_tr_b16 v[48:49], v4 offset:16384
    ds_read_b64_tr_b16 v[50:51], v4 offset:18432
    v_mfma_f32_16x16x32_bf16 v[112:115], v[28:31], v[140:143], v[112:115]
    ds_read_b64_tr_b16 v[52:53], v4 offset:20480
    ds_read_b64_tr_b16 v[54:55], v4 offset:22528
    s_add_u32 s81, s10, 270336
    buffer_load_dwordx4 v[200:203], v21, s[64:67], s81 offen offset:0 sc1
    buffer_load_dwordx4 v[204:207], v21, s[64:67], s81 offen offset:2048 sc1
    s_waitcnt lgkmcnt(8)
    v_mfma_f32_16x16x32_bf16 v[116:119], v[32:35], v[136:139], v[116:119]
    ds_read_b64_tr_b16 v[24:25], v1 offset:57344
    ds_read_b64_tr_b16 v[26:27], v1 offset:59392
    v_mfma_f32_16x16x32_bf16 v[116:119], v[36:39], v[140:143], v[116:119]
    ds_read_b64_tr_b16 v[28:29], v1 offset:61440
    ds_read_b64_tr_b16 v[30:31], v1 offset:63488
    s_waitcnt lgkmcnt(8)
    v_mfma_f32_16x16x32_bf16 v[120:123], v[40:43], v[136:139], v[120:123]
    ds_read_b64_tr_b16 v[32:33], v2 offset:57344
    ds_read_b64_tr_b16 v[34:35], v2 offset:59392
    v_mfma_f32_16x16x32_bf16 v[120:123], v[44:47], v[140:143], v[120:123]
    s_branch L_pg3483x
L_pg3483:
    s_setpc_b64 s[30:31]
L_pg3483x:
    ds_read_b64_tr_b16 v[36:37], v2 offset:61440
    ds_read_b64_tr_b16 v[38:39], v2 offset:63488
    s_waitcnt lgkmcnt(8)
    v_mfma_f32_16x16x32_bf16 v[124:127], v[48:51], v[136:139], v[124:127]
    ds_read_b64_tr_b16 v[40:41], v3 offset:57344
    ds_read_b64_tr_b16 v[42:43], v3 offset:59392
    v_mfma_f32_16x16x32_bf16 v[124:127], v[52:55], v[140:143], v[124:127]
    ds_read_b64_tr_b16 v[44:45], v3 offset:61440
    ds_read_b64_tr_b16 v[46:47], v3 offset:63488
    s_waitcnt vmcnt(13) lgkmcnt(8)
    v_mfma_f32_16x16x32_bf16 v[112:115], v[24:27], v[144:147], v[112:115]
    ds_read_b64_tr_b16 v[48:49], v4 offset:57344
    ds_read_b64_tr_b16 v[50:51], v4 offset:59392
    v_mfma_f32_16x16x32_bf16 v[112:115], v[28:31], v[208:211], v[112:115]
    ds_read_b64_tr_b16 v[52:53], v4 offset:61440
    ds_read_b64_tr_b16 v[54:55], v4 offset:63488
    s_add_u32 s81, s10, 278528
    buffer_load_dwordx4 v[128:131], v21, s[64:67], s81 offen offset:0 sc1
    buffer_load_dwordx4 v[132:135], v21, s[64:67], s81 offen offset:2048 sc1
    s_waitcnt lgkmcnt(8)
    v_mfma_f32_16x16x32_bf16 v[116:119], v[32:35], v[144:147], v[116:119]
    ds_read_b64_tr_b16 v[24:25], v1 offset:24576
    ds_read_b64_tr_b16 v[26:27], v1 offset:26624
    v_mfma_f32_16x16x32_bf16 v[116:119], v[36:39], v[208:211], v[116:119]
    ds_read_b64_tr_b16 v[28:29], v1 offset:28672
    ds_read_b64_tr_b16 v[30:31], v1 offset:30720
    s_waitcnt lgkmcnt(8)
    v_mfma_f32_16x16x32_bf16 v[120:123], v[40:43], v[144:147], v[120:123]
    ds_read_b64_tr_b16 v[32:33], v2 offset:24576
    ds_read_b64_tr_b16 v[34:35], v2 offset:26624
    v_mfma_f32_16x16x32_bf16 v[120:123], v[44:47], v[208:211], v[120:123]
    ds_read_b64_tr_b16 v[36:37], v2 offset:28672
    ds_read_b64_tr_b16 v[38:39], v2 offset:30720
    s_waitcnt lgkmcnt(8)
    v_mfma_f32_16x16x32_bf16 v[124:127], v[48:51], v[144:147], v[124:127]
    ds_read_b64_tr_b16 v[40:41], v3 offset:24576
    ds_read_b64_tr_b16 v[42:43], v3 offset:26624
    v_mfma_f32_16x16x32_bf16 v[124:127], v[52:55], v[208:211], v[124:127]
    ds_read_b64_tr_b16 v[44:45], v3 offset:28672
    ds_read_b64_tr_b16 v[46:47], v3 offset:30720
    s_waitcnt vmcnt(13) lgkmcnt(8)
    v_mfma_f32_16x16x32_bf16 v[112:115], v[24:27], v[148:151], v[112:115]
    ds_read_b64_tr_b16 v[48:49], v4 offset:24576
    ds_read_b64_tr_b16 v[50:51], v4 offset:26624
    v_mfma_f32_16x16x32_bf16 v[112:115], v[28:31], v[212:215], v[112:115]
    ds_read_b64_tr_b16 v[52:53], v4 offset:28672
    ds_read_b64_tr_b16 v[54:55], v4 offset:30720
    s_add_u32 s81, s10, 286720
    buffer_load_dwordx4 v[136:139], v21, s[64:67], s81 offen offset:0 sc1
    buffer_load_dwordx4 v[140:143], v21, s[64:67], s81 offen offset:2048 sc1
    s_waitcnt lgkmcnt(8)
    v_mfma_f32_16x16x32_bf16 v[116:119], v[32:35], v[148:151], v[116:119]
    ds_read_b64_tr_b16 v[24:25], v1 offset:32768
    ds_read_b64_tr_b16 v[26:27], v1 offset:34816
    v_mfma_f32_16x16x32_bf16 v[116:119], v[36:39], v[212:215], v[116:119]
    ds_read_b64_tr_b16 v[28:29], v1 offset:36864
    ds_read_b64_tr_b16 v[30:31], v1 offset:38912
    s_waitcnt lgkmcnt(8)
    v_mfma_f32_16x16x32_bf16 v[120:123], v[40:43], v[148:151], v[120:123]
    ds_read_b64_tr_b16 v[32:33], v2 offset:32768
    ds_read_b64_tr_b16 v[34:35], v2 offset:34816
    v_mfma_f32_16x16x32_bf16 v[120:123], v[44:47], v[212:215], v[120:123]
    ds_read_b64_tr_b16 v[36:37], v2 offset:36864
    ds_read_b64_tr_b16 v[38:39], v2 offset:38912
    s_waitcnt lgkmcnt(8)
    v_mfma_f32_16x16x32_bf16 v[124:127], v[48:51], v[148:151], v[124:127]
    ds_read_b64_tr_b16 v[40:41], v3 offset:32768
    ds_read_b64_tr_b16 v[42:43], v3 offset:34816
    v_mfma_f32_16x16x32_bf16 v[124:127], v[52:55], v[212:215], v[124:127]
    ds_read_b64_tr_b16 v[44:45], v3 offset:36864
    ds_read_b64_tr_b16 v[46:47], v3 offset:38912
    s_waitcnt vmcnt(13) lgkmcnt(8)
    v_mfma_f32_16x16x32_bf16 v[112:115], v[24:27], v[152:155], v[112:115]
    ds_read_b64_tr_b16 v[48:49], v4 offset:32768
    ds_read_b64_tr_b16 v[50:51], v4 offset:34816
    v_mfma_f32_16x16x32_bf16 v[112:115], v[28:31], v[216:219], v[112:115]
    ds_read_b64_tr_b16 v[52:53], v4 offset:36864
    ds_read_b64_tr_b16 v[54:55], v4 offset:38912
    s_add_u32 s81, s8, 98304
    buffer_load_dwordx4 v[144:147], v21, s[64:67], s81 offen offset:0 sc1
    buffer_load_dwordx4 v[208:211], v21, s[64:67], s81 offen offset:2048 sc1
    s_waitcnt lgkmcnt(8)
    v_mfma_f32_16x16x32_bf16 v[116:119], v[32:35], v[152:155], v[116:119]
    v_add_u32 v1, 0x10000, v1
    ds_read_b64_tr_b16 v[24:25], v1 offset:0
    ds_read_b64_tr_b16 v[26:27], v1 offset:2048
    v_mfma_f32_16x16x32_bf16 v[116:119], v[36:39], v[216:219], v[116:119]
    ds_read_b64_tr_b16 v[28:29], v1 offset:4096
    ds_read_b64_tr_b16 v[30:31], v1 offset:6144
    s_waitcnt lgkmcnt(8)
    v_mfma_f32_16x16x32_bf16 v[120:123], v[40:43], v[152:155], v[120:123]
    v_add_u32 v2, 0x10000, v2
    ds_read_b64_tr_b16 v[32:33], v2 offset:0
    ds_read_b64_tr_b16 v[34:35], v2 offset:2048
    v_mfma_f32_16x16x32_bf16 v[120:123], v[44:47], v[216:219], v[120:123]
    ds_read_b64_tr_b16 v[36:37], v2 offset:4096
    ds_read_b64_tr_b16 v[38:39], v2 offset:6144
    s_waitcnt lgkmcnt(8)
    v_mfma_f32_16x16x32_bf16 v[124:127], v[48:51], v[152:155], v[124:127]
    v_add_u32 v3, 0x10000, v3
    ds_read_b64_tr_b16 v[40:41], v3 offset:0
    ds_read_b64_tr_b16 v[42:43], v3 offset:2048
    v_mfma_f32_16x16x32_bf16 v[124:127], v[52:55], v[216:219], v[124:127]
    ds_read_b64_tr_b16 v[44:45], v3 offset:4096
    ds_read_b64_tr_b16 v[46:47], v3 offset:6144
    s_waitcnt vmcnt(13) lgkmcnt(8)
    v_mfma_f32_16x16x32_bf16 v[112:115], v[24:27], v[156:159], v[112:115]
    v_add_u32 v4, 0x10000, v4
    ds_read_b64_tr_b16 v[48:49], v4 offset:0
    ds_read_b64_tr_b16 v[50:51], v4 offset:2048
    v_mfma_f32_16x16x32_bf16 v[112:115], v[28:31], v[220:223], v[112:115]
    ds_read_b64_tr_b16 v[52:53], v4 offset:4096
    ds_read_b64_tr_b16 v[54:55], v4 offset:6144
    s_add_u32 s81, s8, 114688
    buffer_load_dwordx4 v[148:151], v21, s[64:67], s81 offen offset:0 sc1
    buffer_load_dwordx4 v[212:215], v21, s[64:67], s81 offen offset:2048 sc1
    s_waitcnt lgkmcnt(8)
    v_mfma_f32_16x16x32_bf16 v[116:119], v[32:35], v[156:159], v[116:119]
    ds_read_b64_tr_b16 v[24:25], v1 offset:8192
    ds_read_b64_tr_b16 v[26:27], v1 offset:10240
    v_mfma_f32_16x16x32_bf16 v[116:119], v[36:39], v[220:223], v[116:119]
    ds_read_b64_tr_b16 v[28:29], v1 offset:12288
    ds_read_b64_tr_b16 v[30:31], v1 offset:14336
    s_waitcnt lgkmcnt(8)
    v_mfma_f32_16x16x32_bf16 v[120:123], v[40:43], v[156:159], v[120:123]
    ds_read_b64_tr_b16 v[32:33], v2 offset:8192
    ds_read_b64_tr_b16 v[34:35], v2 offset:10240
    v_mfma_f32_16x16x32_bf16 v[120:123], v[44:47], v[220:223], v[120:123]
    ds_read_b64_tr_b16 v[36:37], v2 offset:12288
    ds_read_b64_tr_b16 v[38:39], v2 offset:14336
    s_waitcnt lgkmcnt(8)
    v_mfma_f32_16x16x32_bf16 v[124:127], v[48:51], v[156:159], v[124:127]
    ds_read_b64_tr_b16 v[40:41], v3 offset:8192
    ds_read_b64_tr_b16 v[42:43], v3 offset:10240
    v_mfma_f32_16x16x32_bf16 v[124:127], v[52:55], v[220:223], v[124:127]
    ds_read_b64_tr_b16 v[44:45], v3 offset:12288
    ds_read_b64_tr_b16 v[46:47], v3 offset:14336
    s_waitcnt vmcnt(12) lgkmcnt(8)
    v_mfma_f32_16x16x32_bf16 v[112:115], v[24:27], v[192:195], v[112:115]
    ds_read_b64_tr_b16 v[48:49], v4 offset:8192
    ds_read_b64_tr_b16 v[50:51], v4 offset:10240
    v_mfma_f32_16x16x32_bf16 v[112:115], v[28:31], v[196:199], v[112:115]
    ds_read_b64_tr_b16 v[52:53], v4 offset:12288
    ds_read_b64_tr_b16 v[54:55], v4 offset:14336
    s_waitcnt lgkmcnt(8)
    v_mfma_f32_16x16x32_bf16 v[116:119], v[32:35], v[192:195], v[116:119]
    ds_read_b64_tr_b16 v[24:25], v1 offset:16384
    ds_read_b64_tr_b16 v[26:27], v1 offset:18432
    v_mfma_f32_16x16x32_bf16 v[116:119], v[36:39], v[196:199], v[116:119]
    ds_read_b64_tr_b16 v[28:29], v1 offset:20480
    ds_read_b64_tr_b16 v[30:31], v1 offset:22528
    s_waitcnt lgkmcnt(8)
    v_mfma_f32_16x16x32_bf16 v[120:123], v[40:43], v[192:195], v[120:123]
    ds_read_b64_tr_b16 v[32:33], v2 offset:16384
    ds_read_b64_tr_b16 v[34:35], v2 offset:18432
    v_mfma_f32_16x16x32_bf16 v[120:123], v[44:47], v[196:199], v[120:123]
    ds_read_b64_tr_b16 v[36:37], v2 offset:20480
    ds_read_b64_tr_b16 v[38:39], v2 offset:22528
    s_waitcnt lgkmcnt(8)
    v_mfma_f32_16x16x32_bf16 v[124:127], v[48:51], v[192:195], v[124:127]
    ds_read_b64_tr_b16 v[40:41], v3 offset:16384
    ds_read_b64_tr_b16 v[42:43], v3 offset:18432
    v_mfma_f32_16x16x32_bf16 v[124:127], v[52:55], v[196:199], v[124:127]
    ds_read_b64_tr_b16 v[44:45], v3 offset:20480
    ds_read_b64_tr_b16 v[46:47], v3 offset:22528
    s_waitcnt vmcnt(8) lgkmcnt(8)
    v_mfma_f32_16x16x32_bf16 v[112:115], v[24:27], v[200:203], v[112:115]
    ds_read_b64_tr_b16 v[48:49], v4 offset:16384
    ds_read_b64_tr_b16 v[50:51], v4 offset:18432
    v_mfma_f32_16x16x32_bf16 v[112:115], v[28:31], v[204:207], v[112:115]
    ds_read_b64_tr_b16 v[52:53], v4 offset:20480
    ds_read_b64_tr_b16 v[54:55], v4 offset:22528
    s_waitcnt lgkmcnt(8)
    v_mfma_f32_16x16x32_bf16 v[116:119], v[32:35], v[200:203], v[116:119]
    v_add_u32 v1, 0xfffe0000, v1
    ds_read_b64_tr_b16 v[24:25], v1 offset:0
    ds_read_b64_tr_b16 v[26:27], v1 offset:2048
    v_mfma_f32_16x16x32_bf16 v[116:119], v[36:39], v[204:207], v[116:119]
    ds_read_b64_tr_b16 v[28:29], v1 offset:4096
    ds_read_b64_tr_b16 v[30:31], v1 offset:6144
    s_waitcnt lgkmcnt(8)
    v_mfma_f32_16x16x32_bf16 v[120:123], v[40:43], v[200:203], v[120:123]
    v_add_u32 v2, 0xfffe0000, v2
    ds_read_b64_tr_b16 v[32:33], v2 offset:0
    ds_read_b64_tr_b16 v[34:35], v2 offset:2048
    v_mfma_f32_16x16x32_bf16 v[120:123], v[44:47], v[204:207], v[120:123]
    ds_read_b64_tr_b16 v[36:37], v2 offset:4096
    ds_read_b64_tr_b16 v[38:39], v2 offset:6144
    buffer_load_dwordx4 v[64:67], v7, s[64:67], s12 offen offset:0 sc1
    buffer_load_dwordx4 v[68:71], v7, s[64:67], s12 offen offset:1024 sc1
    buffer_load_dword v72, v15, s[64:67], s12 offen offset:2048 sc1
    s_waitcnt lgkmcnt(8)
    v_mfma_f32_16x16x32_bf16 v[124:127], v[48:51], v[200:203], v[124:127]
    v_add_u32 v3, 0xfffe0000, v3
    ds_read_b64_tr_b16 v[40:41], v3 offset:0
    ds_read_b64_tr_b16 v[42:43], v3 offset:2048
    v_mfma_f32_16x16x32_bf16 v[124:127], v[52:55], v[204:207], v[124:127]
    ds_read_b64_tr_b16 v[44:45], v3 offset:4096
    ds_read_b64_tr_b16 v[46:47], v3 offset:6144
    s_waitcnt vmcnt(9) lgkmcnt(8)
    v_mfma_f32_16x16x32_bf16 v[112:115], v[24:27], v[128:131], v[112:115]
    v_add_u32 v4, 0xfffe0000, v4
    ds_read_b64_tr_b16 v[48:49], v4 offset:0
    ds_read_b64_tr_b16 v[50:51], v4 offset:2048
    v_mfma_f32_16x16x32_bf16 v[112:115], v[28:31], v[132:135], v[112:115]
    ds_read_b64_tr_b16 v[52:53], v4 offset:4096
    ds_read_b64_tr_b16 v[54:55], v4 offset:6144
    s_waitcnt lgkmcnt(8)
    v_mfma_f32_16x16x32_bf16 v[116:119], v[32:35], v[128:131], v[116:119]
    ds_read_b64_tr_b16 v[24:25], v1 offset:8192
    ds_read_b64_tr_b16 v[26:27], v1 offset:10240
    v_mfma_f32_16x16x32_bf16 v[116:119], v[36:39], v[132:135], v[116:119]
    ds_read_b64_tr_b16 v[28:29], v1 offset:12288
    ds_read_b64_tr_b16 v[30:31], v1 offset:14336
    s_waitcnt lgkmcnt(8)
    v_mfma_f32_16x16x32_bf16 v[120:123], v[40:43], v[128:131], v[120:123]
    ds_read_b64_tr_b16 v[32:33], v2 offset:8192
    ds_read_b64_tr_b16 v[34:35], v2 offset:10240
    v_mfma_f32_16x16x32_bf16 v[120:123], v[44:47], v[132:135], v[120:123]
    ds_read_b64_tr_b16 v[36:37], v2 offset:12288
    ds_read_b64_tr_b16 v[38:39], v2 offset:14336
    s_waitcnt lgkmcnt(8)
    v_mfma_f32_16x16x32_bf16 v[124:127], v[48:51], v[128:131], v[124:127]
    ds_read_b64_tr_b16 v[40:41], v3 offset:8192
    ds_read_b64_tr_b16 v[42:43], v3 offset:10240
    v_mfma_f32_16x16x32_bf16 v[124:127], v[52:55], v[132:135], v[124:127]
    ds_read_b64_tr_b16 v[44:45], v3 offset:12288
    ds_read_b64_tr_b16 v[46:47], v3 offset:14336
    s_waitcnt vmcnt(7) lgkmcnt(8)
    v_mfma_f32_16x16x32_bf16 v[112:115], v[24:27], v[136:139], v[112:115]
    ds_read_b64_tr_b16 v[48:49], v4 offset:8192
    ds_read_b64_tr_b16 v[50:51], v4 offset:10240
    v_mfma_f32_16x16x32_bf16 v[112:115], v[28:31], v[140:143], v[112:115]
    ds_read_b64_tr_b16 v[52:53], v4 offset:12288
    ds_read_b64_tr_b16 v[54:55], v4 offset:14336
    s_waitcnt lgkmcnt(8)
    v_mfma_f32_16x16x32_bf16 v[116:119], v[32:35], v[136:139], v[116:119]
    v_mfma_f32_16x16x32_bf16 v[116:119], v[36:39], v[140:143], v[116:119]
    s_waitcnt lgkmcnt(4)
    v_mfma_f32_16x16x32_bf16 v[120:123], v[40:43], v[136:139], v[120:123]
    v_mfma_f32_16x16x32_bf16 v[120:123], v[44:47], v[140:143], v[120:123]
    s_waitcnt lgkmcnt(0)
    v_mfma_f32_16x16x32_bf16 v[124:127], v[48:51], v[136:139], v[124:127]
    v_mfma_f32_16x16x32_bf16 v[124:127], v[52:55], v[140:143], v[124:127]
    s_waitcnt vmcnt(5)
    v_mfma_f32_16x16x32_bf16 v[112:115], v[160:163], v[144:147], v[112:115]
    v_mfma_f32_16x16x32_bf16 v[112:115], v[224:227], v[208:211], v[112:115]
    v_mfma_f32_16x16x32_bf16 v[116:119], v[164:167], v[144:147], v[116:119]
    v_mfma_f32_16x16x32_bf16 v[116:119], v[228:231], v[208:211], v[116:119]
    v_mfma_f32_16x16x32_bf16 v[120:123], v[168:171], v[144:147], v[120:123]
    v_mfma_f32_16x16x32_bf16 v[120:123], v[232:235], v[208:211], v[120:123]
    v_mfma_f32_16x16x32_bf16 v[124:127], v[172:175], v[144:147], v[124:127]
    v_mfma_f32_16x16x32_bf16 v[124:127], v[236:239], v[208:211], v[124:127]
    s_waitcnt vmcnt(3)
    v_mfma_f32_16x16x32_bf16 v[112:115], v[176:179], v[148:151], v[112:115]
    v_mfma_f32_16x16x32_bf16 v[112:115], v[240:243], v[212:215], v[112:115]
    v_mfma_f32_16x16x32_bf16 v[116:119], v[180:183], v[148:151], v[116:119]
    v_mfma_f32_16x16x32_bf16 v[116:119], v[244:247], v[212:215], v[116:119]
    v_mfma_f32_16x16x32_bf16 v[120:123], v[184:187], v[148:151], v[120:123]
    v_mfma_f32_16x16x32_bf16 v[120:123], v[248:251], v[212:215], v[120:123]
    v_mfma_f32_16x16x32_bf16 v[124:127], v[188:191], v[148:151], v[124:127]
    v_mfma_f32_16x16x32_bf16 v[124:127], v[252:255], v[212:215], v[124:127]
    s_waitcnt vmcnt(0)
    v_add3_u32 v14, v10, v64, v65
    v_add3_u32 v14, v14, v66, v67
    v_add3_u32 v14, v14, v68, v69
    v_add3_u32 v14, v14, v70, v71
    v_cmp_ne_u32 vcc, v14, v72
    s_cbranch_vccnz Lx_1003
Lc_1004:
    v_dot2_f32_bf16 v112, v64, v12, v112
    v_dot2_f32_bf16 v113, v64, v13, v113
    v_dot2_f32_bf16 v114, v65, v12, v114
    v_dot2_f32_bf16 v115, v65, v13, v115
    v_dot2_f32_bf16 v116, v66, v12, v116
    v_dot2_f32_bf16 v117, v66, v13, v117
    v_dot2_f32_bf16 v118, v67, v12, v118
    v_dot2_f32_bf16 v119, v67, v13, v119
    v_dot2_f32_bf16 v120, v68, v12, v120
    v_dot2_f32_bf16 v121, v68, v13, v121
    v_dot2_f32_bf16 v122, v69, v12, v122
    v_dot2_f32_bf16 v123, v69, v13, v123
    v_cvt_pk_bf16_f32 v56, v112, v113
    v_cvt_pk_bf16_f32 v57, v114, v115
    v_cvt_pk_bf16_f32 v58, v116, v117
    v_cvt_pk_bf16_f32 v59, v118, v119
    v_dot2_f32_bf16 v124, v70, v12, v124
    v_dot2_f32_bf16 v125, v70, v13, v125
    v_dot2_f32_bf16 v126, v71, v12, v126
    v_dot2_f32_bf16 v127, v71, v13, v127
    v_permlane16_swap_b32 v56, v58
    v_permlane16_swap_b32 v57, v59
    buffer_store_dwordx4 v[56:59], v8, s[68:71], s99 offen offset:0 sc1
    v_cvt_pk_bf16_f32 v60, v120, v121
    v_cvt_pk_bf16_f32 v61, v122, v123
    v_cvt_pk_bf16_f32 v62, v124, v125
    v_cvt_pk_bf16_f32 v63, v126, v127
    s_nop 0
    v_permlane16_swap_b32 v60, v62
    v_permlane16_swap_b32 v61, v63
    buffer_store_dwordx4 v[60:63], v8, s[68:71], s99 offen offset:64 sc1
    s_endpgm
Ln_1001:
    buffer_load_dword v10, off, s[72:75], 0 sc1
    s_sub_u32 s37, s37, 1
    s_cbranch_scc1 L_end
    s_waitcnt vmcnt(0)
    v_cmp_eq_u32 vcc, 0, v10
    s_cbranch_vccnz Ln_1001
    s_branch Lc_1002
Lx_1003:
    buffer_load_dwordx4 v[64:67], v7, s[64:67], s12 offen offset:0 sc1
    buffer_load_dwordx4 v[68:71], v7, s[64:67], s12 offen offset:1024 sc1
    buffer_load_dword v72, v15, s[64:67], s12 offen offset:2048 sc1
    s_sub_u32 s37, s37, 1
    s_cbranch_scc1 L_end
    s_waitcnt vmcnt(0)
    v_add3_u32 v14, v10, v64, v65
    v_add3_u32 v14, v14, v66, v67
    v_add3_u32 v14, v14, v68, v69
    v_add3_u32 v14, v14, v70, v71
    v_cmp_ne_u32 vcc, v14, v72
    s_cbranch_vccnz Lx_1003
    s_branch Lc_1004
    s_nop 0
    s_nop 0
L_pg3813:
    s_setpc_b64 s[30:31]
    s_nop 0
L_compF:
    s_waitcnt lgkmcnt(4)
    v_mfma_f32_16x16x32_bf16 v[64:67], v[24:27], v[128:131], 0
    v_add_u32 v4, 0x22000, v4
    ds_read_b64_tr_b16 v[48:49], v4 offset:0
    v_mfma_f32_32x32x16_bf16 v[112:127], v[56:59], v[232:235], 0
    v_fma_f32 v96, v96, v8, v9
    v_fma_f32 v97, v97, v8, v9
    v_fma_f32 v98, v98, v8, v9
    v_fma_f32 v99, v99, v8, v9
    v_mfma_f32_16x16x32_bf16 v[64:67], v[28:31], v[132:135], v[64:67]
    ds_read_b64_tr_b16 v[50:51], v4 offset:2048
    v_mfma_f32_16x16x32_bf16 v[80:83], v[28:31], v[196:199], 0
    ds_read_b64_tr_b16 v[52:53], v4 offset:4096
    v_mfma_f32_16x16x32_bf16 v[80:83], v[24:27], v[192:195], v[80:83]
    ds_read_b64_tr_b16 v[54:55], v4 offset:6144
    v_mfma_f32_16x16x32_bf16 v[68:71], v[32:35], v[128:131], 0
    ds_read_b64_tr_b16 v[24:25], v1 offset:8192
    v_mfma_f32_16x16x32_bf16 v[68:71], v[36:39], v[132:135], v[68:71]
    ds_read_b64_tr_b16 v[26:27], v1 offset:10240
    v_mfma_f32_16x16x32_bf16 v[84:87], v[36:39], v[196:199], 0
    ds_read_b64_tr_b16 v[28:29], v1 offset:12288
    v_cvt_pk_bf16_f32 v224, v96, v97
    v_mfma_f32_16x16x32_bf16 v[84:87], v[32:35], v[192:195], v[84:87]
    ds_read_b64_tr_b16 v[30:31], v1 offset:14336
    v_cvt_pk_bf16_f32 v225, v98, v99
    s_waitcnt lgkmcnt(4)
    v_mfma_f32_16x16x32_bf16 v[72:75], v[40:43], v[128:131], 0
    ds_read_b64_tr_b16 v[32:33], v2 offset:8192
    v_fma_f32 v100, v100, v8, v9
    v_mfma_f32_16x16x32_bf16 v[72:75], v[44:47], v[132:135], v[72:75]
    ds_read_b64_tr_b16 v[34:35], v2 offset:10240
    v_fma_f32 v101, v101, v8, v9
    v_mfma_f32_16x16x32_bf16 v[88:91], v[44:47], v[196:199], 0
    ds_read_b64_tr_b16 v[36:37], v2 offset:12288
    v_mfma_f32_32x32x16_bf16 v[112:127], v[60:63], v[236:239], v[112:127]
    v_fma_f32 v102, v102, v8, v9
    v_fma_f32 v103, v103, v8, v9
    v_cvt_pk_bf16_f32 v226, v100, v101
    v_cvt_pk_bf16_f32 v227, v102, v103
    v_mfma_f32_16x16x32_bf16 v[88:91], v[40:43], v[192:195], v[88:91]
    ds_read_b64_tr_b16 v[38:39], v2 offset:14336
    v_mfma_f32_16x16x32_bf16 v[76:79], v[48:51], v[128:131], 0
    ds_read_b64_tr_b16 v[40:41], v3 offset:8192
    v_mfma_f32_16x16x32_bf16 v[76:79], v[52:55], v[132:135], v[76:79]
    ds_read_b64_tr_b16 v[42:43], v3 offset:10240
    v_mfma_f32_16x16x32_bf16 v[92:95], v[52:55], v[196:199], 0
    ds_read_b64_tr_b16 v[44:45], v3 offset:12288
    v_mfma_f32_16x16x32_bf16 v[92:95], v[48:51], v[192:195], v[92:95]
    ds_read_b64_tr_b16 v[46:47], v3 offset:14336
    s_waitcnt lgkmcnt(4)
    v_mfma_f32_16x16x32_bf16 v[64:67], v[24:27], v[136:139], v[64:67]
    ds_read_b64_tr_b16 v[48:49], v4 offset:8192
    v_mfma_f32_16x16x32_bf16 v[64:67], v[28:31], v[140:143], v[64:67]
    ds_read_b64_tr_b16 v[50:51], v4 offset:10240
    v_fma_f32 v104, v104, v8, v9
    v_mfma_f32_16x16x32_bf16 v[80:83], v[28:31], v[204:207], v[80:83]
    ds_read_b64_tr_b16 v[52:53], v4 offset:12288
    v_fma_f32 v105, v105, v8, v9
    v_mfma_f32_16x16x32_bf16 v[80:83], v[24:27], v[200:203], v[80:83]
    ds_read_b64_tr_b16 v[54:55], v4 offset:14336
    v_fma_f32 v106, v106, v8, v9
    v_mfma_f32_16x16x32_bf16 v[68:71], v[32:35], v[136:139], v[68:71]
    s_barrier
    ds_read_b64_tr_b16 v[24:25], v1 offset:16384
    v_fma_f32 v107, v107, v8, v9
    v_mfma_f32_16x16x32_bf16 v[68:71], v[36:39], v[140:143], v[68:71]
    ds_read_b64_tr_b16 v[26:27], v1 offset:18432
    v_cvt_pk_bf16_f32 v228, v104, v105
    v_mfma_f32_16x16x32_bf16 v[84:87], v[36:39], v[204:207], v[84:87]
    ds_read_b64_tr_b16 v[28:29], v1 offset:20480
    v_cvt_pk_bf16_f32 v229, v106, v107
    v_mfma_f32_16x16x32_bf16 v[84:87], v[32:35], v[200:203], v[84:87]
    ds_read_b64_tr_b16 v[30:31], v1 offset:22528
    v_fma_f32 v108, v108, v8, v9
    s_waitcnt lgkmcnt(4)
    v_mfma_f32_16x16x32_bf16 v[72:75], v[40:43], v[136:139], v[72:75]
    ds_read_b64_tr_b16 v[32:33], v2 offset:16384
    v_fma_f32 v109, v109, v8, v9
    v_mfma_f32_16x16x32_bf16 v[72:75], v[44:47], v[140:143], v[72:75]
    ds_read_b64_tr_b16 v[34:35], v2 offset:18432
    v_fma_f32 v110, v110, v8, v9
    v_mfma_f32_16x16x32_bf16 v[88:91], v[44:47], v[204:207], v[88:91]
    ds_read_b64_tr_b16 v[36:37], v2 offset:20480
    v_fma_f32 v111, v111, v8, v9
    v_mfma_f32_16x16x32_bf16 v[88:91], v[40:43], v[200:203], v[88:91]
    ds_read_b64_tr_b16 v[38:39], v2 offset:22528
    v_cvt_pk_bf16_f32 v230, v108, v109
    v_mfma_f32_16x16x32_bf16 v[76:79], v[48:51], v[136:139], v[76:79]
    ds_read_b64_tr_b16 v[40:41], v3 offset:16384
    v_cvt_pk_bf16_f32 v231, v110, v111
    v_mfma_f32_16x16x32_bf16 v[76:79], v[52:55], v[140:143], v[76:79]
    ds_read_b64_tr_b16 v[42:43], v3 offset:18432
    v_mfma_f32_32x32x16_bf16 v[96:111], v[56:59], v[240:243], 0
    v_mfma_f32_16x16x32_bf16 v[92:95], v[52:55], v[204:207], v[92:95]
    ds_read_b64_tr_b16 v[44:45], v3 offset:20480
    v_mfma_f32_16x16x32_bf16 v[92:95], v[48:51], v[200:203], v[92:95]
    ds_read_b64_tr_b16 v[46:47], v3 offset:22528
    v_fma_f32 v112, v112, v8, v9
    s_waitcnt lgkmcnt(4)
    v_mfma_f32_16x16x32_bf16 v[64:67], v[24:27], v[144:147], v[64:67]
    ds_read_b64_tr_b16 v[48:49], v4 offset:16384
    v_fma_f32 v113, v113, v8, v9
    v_mfma_f32_16x16x32_bf16 v[64:67], v[28:31], v[148:151], v[64:67]
    ds_read_b64_tr_b16 v[50:51], v4 offset:18432
    v_fma_f32 v114, v114, v8, v9
    v_mfma_f32_16x16x32_bf16 v[80:83], v[28:31], v[212:215], v[80:83]
    ds_read_b64_tr_b16 v[52:53], v4 offset:20480
    v_fma_f32 v115, v115, v8, v9
    v_mfma_f32_16x16x32_bf16 v[80:83], v[24:27], v[208:211], v[80:83]
    ds_read_b64_tr_b16 v[54:55], v4 offset:22528
    v_cvt_pk_bf16_f32 v232, v112, v113
    v_mfma_f32_16x16x32_bf16 v[68:71], v[32:35], v[144:147], v[68:71]
    v_add_u32 v1, 0xfffde000, v1
    ds_read_b64_tr_b16 v[24:25], v1 offset:0
    v_cvt_pk_bf16_f32 v233, v114, v115
    v_mfma_f32_16x16x32_bf16 v[68:71], v[36:39], v[148:151], v[68:71]
    ds_read_b64_tr_b16 v[26:27], v1 offset:2048
    v_fma_f32 v116, v116, v8, v9
    v_mfma_f32_16x16x32_bf16 v[84:87], v[36:39], v[212:215], v[84:87]
    ds_read_b64_tr_b16 v[28:29], v1 offset:4096
    v_fma_f32 v117, v117, v8, v9
    v_mfma_f32_16x16x32_bf16 v[84:87], v[32:35], v[208:211], v[84:87]
    ds_read_b64_tr_b16 v[30:31], v1 offset:6144
    v_mfma_f32_32x32x16_bf16 v[96:111], v[60:63], v[244:247], v[96:111]
    v_fma_f32 v118, v118, v8, v9
    v_fma_f32 v119, v119, v8, v9
    v_cvt_pk_bf16_f32 v234, v116, v117
    v_cvt_pk_bf16_f32 v235, v118, v119
    s_waitcnt lgkmcnt(4)
    v_mfma_f32_16x16x32_bf16 v[72:75], v[40:43], v[144:147], v[72:75]
    v_add_u32 v2, 0xfffde000, v2
    ds_read_b64_tr_b16 v[32:33], v2 offset:0
    v_mfma_f32_16x16x32_bf16 v[72:75], v[44:47], v[148:151], v[72:75]
    ds_read_b64_tr_b16 v[34:35], v2 offset:2048
    v_mfma_f32_16x16x32_bf16 v[88:91], v[44:47], v[212:215], v[88:91]
    ds_read_b64_tr_b16 v[36:37], v2 offset:4096
    v_mfma_f32_16x16x32_bf16 v[88:91], v[40:43], v[208:211], v[88:91]
    ds_read_b64_tr_b16 v[38:39], v2 offset:6144
    v_mfma_f32_16x16x32_bf16 v[76:79], v[48:51], v[144:147], v[76:79]
    v_add_u32 v3, 0xfffde000, v3
    ds_read_b64_tr_b16 v[40:41], v3 offset:0
    v_mfma_f32_16x16x32_bf16 v[76:79], v[52:55], v[148:151], v[76:79]
    ds_read_b64_tr_b16 v[42:43], v3 offset:2048
    v_fma_f32 v120, v120, v8, v9
    v_mfma_f32_16x16x32_bf16 v[92:95], v[52:55], v[212:215], v[92:95]
    ds_read_b64_tr_b16 v[44:45], v3 offset:4096
    v_mfma_f32_16x16x32_bf16 v[92:95], v[48:51], v[208:211], v[92:95]
    ds_read_b64_tr_b16 v[46:47], v3 offset:6144
    v_fma_f32 v121, v121, v8, v9
    s_waitcnt lgkmcnt(4)
    v_mfma_f32_16x16x32_bf16 v[64:67], v[24:27], v[152:155], v[64:67]
    v_add_u32 v4, 0xfffde000, v4
    ds_read_b64_tr_b16 v[48:49], v4 offset:0
    v_fma_f32 v122, v122, v8, v9
    v_mfma_f32_16x16x32_bf16 v[64:67], v[28:31], v[156:159], v[64:67]
    ds_read_b64_tr_b16 v[50:51], v4 offset:2048
    v_fma_f32 v123, v123, v8, v9
    v_mfma_f32_16x16x32_bf16 v[80:83], v[28:31], v[220:223], v[80:83]
    ds_read_b64_tr_b16 v[52:53], v4 offset:4096
    v_cvt_pk_bf16_f32 v236, v120, v121
    v_mfma_f32_16x16x32_bf16 v[80:83], v[24:27], v[216:219], v[80:83]
    ds_read_b64_tr_b16 v[54:55], v4 offset:6144
    v_cvt_pk_bf16_f32 v237, v122, v123
    v_mfma_f32_16x16x32_bf16 v[68:71], v[32:35], v[152:155], v[68:71]
    ds_read_b64_tr_b16 v[24:25], v1 offset:8192
    v_fma_f32 v124, v124, v8, v9
    v_mfma_f32_16x16x32_bf16 v[68:71], v[36:39], v[156:159], v[68:71]
    ds_read_b64_tr_b16 v[26:27], v1 offset:10240
    v_fma_f32 v125, v125, v8, v9
    v_mfma_f32_16x16x32_bf16 v[84:87], v[36:39], v[220:223], v[84:87]
    ds_read_b64_tr_b16 v[28:29], v1 offset:12288
    v_fma_f32 v126, v126, v8, v9
    v_mfma_f32_16x16x32_bf16 v[84:87], v[32:35], v[216:219], v[84:87]
    ds_read_b64_tr_b16 v[30:31], v1 offset:14336
    v_fma_f32 v127, v127, v8, v9
    s_waitcnt lgkmcnt(4)
    v_mfma_f32_16x16x32_bf16 v[72:75], v[40:43], v[152:155], v[72:75]
    ds_read_b64_tr_b16 v[32:33], v2 offset:8192
    v_cvt_pk_bf16_f32 v238, v124, v125
    v_mfma_f32_16x16x32_bf16 v[72:75], v[44:47], v[156:159], v[72:75]
    ds_read_b64_tr_b16 v[34:35], v2 offset:10240
    v_cvt_pk_bf16_f32 v239, v126, v127
    v_mfma_f32_16x16x32_bf16 v[88:91], v[44:47], v[220:223], v[88:91]
    ds_read_b64_tr_b16 v[36:37], v2 offset:12288
    v_mfma_f32_32x32x16_bf16 v[112:127], v[56:59], v[248:251], 0
    v_mfma_f32_16x16x32_bf16 v[88:91], v[40:43], v[216:219], v[88:91]
    ds_read_b64_tr_b16 v[38:39], v2 offset:14336
    v_mfma_f32_16x16x32_bf16 v[76:79], v[48:51], v[152:155], v[76:79]
    s_barrier
    ds_read_b64_tr_b16 v[40:41], v3 offset:8192
    v_fma_f32 v96, v96, v8, v9
    v_mfma_f32_16x16x32_bf16 v[76:79], v[52:55], v[156:159], v[76:79]
    ds_read_b64_tr_b16 v[42:43], v3 offset:10240
    v_fma_f32 v97, v97, v8, v9
    v_mfma_f32_16x16x32_bf16 v[92:95], v[52:55], v[220:223], v[92:95]
    ds_read_b64_tr_b16 v[44:45], v3 offset:12288
    v_fma_f32 v98, v98, v8, v9
    v_mfma_f32_16x16x32_bf16 v[92:95], v[48:51], v[216:219], v[92:95]
    ds_read_b64_tr_b16 v[46:47], v3 offset:14336
    v_fma_f32 v99, v99, v8, v9
    s_waitcnt lgkmcnt(4)
    v_mfma_f32_16x16x32_bf16 v[64:67], v[24:27], v[160:163], v[64:67]
    ds_read_b64_tr_b16 v[48:49], v4 offset:8192
    v_cvt_pk_bf16_f32 v240, v96, v97
    v_mfma_f32_16x16x32_bf16 v[64:67], v[28:31], v[164:167], v[64:67]
    ds_read_b64_tr_b16 v[50:51], v4 offset:10240
    v_cvt_pk_bf16_f32 v241, v98, v99
    v_mfma_f32_16x16x32_bf16 v[80:83], v[28:31], v[228:231], v[80:83]
    ds_read_b64_tr_b16 v[52:53], v4 offset:12288
    v_fma_f32 v100, v100, v8, v9
    v_mfma_f32_16x16x32_bf16 v[80:83], v[24:27], v[224:227], v[80:83]
    ds_read_b64_tr_b16 v[54:55], v4 offset:14336
    v_fma_f32 v101, v101, v8, v9
    v_mfma_f32_16x16x32_bf16 v[68:71], v[32:35], v[160:163], v[68:71]
    ds_read_b64_tr_b16 v[24:25], v1 offset:16384
    v_mfma_f32_32x32x16_bf16 v[112:127], v[60:63], v[252:255], v[112:127]
    v_fma_f32 v102, v102, v8, v9
    v_fma_f32 v103, v103, v8, v9
    v_cvt_pk_bf16_f32 v242, v100, v101
    v_cvt_pk_bf16_f32 v243, v102, v103
    v_mfma_f32_16x16x32_bf16 v[68:71], v[36:39], v[164:167], v[68:71]
    s_branch L_pg4038x
L_pg4038:
    s_setpc_b64 s[30:31]
L_pg4038x:
    ds_read_b64_tr_b16 v[26:27], v1 offset:18432
    v_mfma_f32_16x16x32_bf16 v[84:87], v[36:39], v[228:231], v[84:87]
    ds_read_b64_tr_b16 v[28:29], v1 offset:20480
    v_mfma_f32_16x16x32_bf16 v[84:87], v[32:35], v[224:227], v[84:87]
    ds_read_b64_tr_b16 v[30:31], v1 offset:22528
    s_waitcnt lgkmcnt(4)
    v_mfma_f32_16x16x32_bf16 v[72:75], v[40:43], v[160:163], v[72:75]
    ds_read_b64_tr_b16 v[32:33], v2 offset:16384
    v_mfma_f32_16x16x32_bf16 v[72:75], v[44:47], v[164:167], v[72:75]
    ds_read_b64_tr_b16 v[34:35], v2 offset:18432
    v_mfma_f32_16x16x32_bf16 v[88:91], v[44:47], v[228:231], v[88:91]
    ds_read_b64_tr_b16 v[36:37], v2 offset:20480
    v_fma_f32 v104, v104, v8, v9
    v_mfma_f32_16x16x32_bf16 v[88:91], v[40:43], v[224:227], v[88:91]
    ds_read_b64_tr_b16 v[38:39], v2 offset:22528
    v_fma_f32 v105, v105, v8, v9
    v_mfma_f32_16x16x32_bf16 v[76:79], v[48:51], v[160:163], v[76:79]
    ds_read_b64_tr_b16 v[40:41], v3 offset:16384
    v_fma_f32 v106, v106, v8, v9
    v_mfma_f32_16x16x32_bf16 v[76:79], v[52:55], v[164:167], v[76:79]
    ds_read_b64_tr_b16 v[42:43], v3 offset:18432
    v_fma_f32 v107, v107, v8, v9
    v_mfma_f32_16x16x32_bf16 v[92:95], v[52:55], v[228:231], v[92:95]
    ds_read_b64_tr_b16 v[44:45], v3 offset:20480
    v_cvt_pk_bf16_f32 v244, v104, v105
    v_mfma_f32_16x16x32_bf16 v[92:95], v[48:51], v[224:227], v[92:95]
    ds_read_b64_tr_b16 v[46:47], v3 offset:22528
    v_cvt_pk_bf16_f32 v245, v106, v107
    s_waitcnt lgkmcnt(4)
    v_mfma_f32_16x16x32_bf16 v[64:67], v[24:27], v[168:171], v[64:67]
    ds_read_b64_tr_b16 v[48:49], v4 offset:16384
    v_fma_f32 v108, v108, v8, v9
    v_mfma_f32_16x16x32_bf16 v[64:67], v[28:31], v[172:175], v[64:67]
    ds_read_b64_tr_b16 v[50:51], v4 offset:18432
    v_fma_f32 v109, v109, v8, v9
    v_mfma_f32_16x16x32_bf16 v[80:83], v[28:31], v[236:239], v[80:83]
    ds_read_b64_tr_b16 v[52:53], v4 offset:20480
    v_fma_f32 v110, v110, v8, v9
    v_mfma_f32_16x16x32_bf16 v[80:83], v[24:27], v[232:235], v[80:83]
    ds_read_b64_tr_b16 v[54:55], v4 offset:22528
    v_fma_f32 v111, v111, v8, v9
    v_mfma_f32_16x16x32_bf16 v[68:71], v[32:35], v[168:171], v[68:71]
    ds_read_b64_tr_b16 v[24:25], v1 offset:24576
    v_cvt_pk_bf16_f32 v246, v108, v109
    v_mfma_f32_16x16x32_bf16 v[68:71], v[36:39], v[172:175], v[68:71]
    ds_read_b64_tr_b16 v[26:27], v1 offset:26624
    v_cvt_pk_bf16_f32 v247, v110, v111
    v_mfma_f32_16x16x32_bf16 v[84:87], v[36:39], v[236:239], v[84:87]
    ds_read_b64_tr_b16 v[28:29], v1 offset:28672
    v_fma_f32 v112, v112, v8, v9
    v_mfma_f32_16x16x32_bf16 v[84:87], v[32:35], v[232:235], v[84:87]
    ds_read_b64_tr_b16 v[30:31], v1 offset:30720
    v_fma_f32 v113, v113, v8, v9
    s_waitcnt lgkmcnt(4)
    v_mfma_f32_16x16x32_bf16 v[72:75], v[40:43], v[168:171], v[72:75]
    ds_read_b64_tr_b16 v[32:33], v2 offset:24576
    v_fma_f32 v114, v114, v8, v9
    v_mfma_f32_16x16x32_bf16 v[72:75], v[44:47], v[172:175], v[72:75]
    ds_read_b64_tr_b16 v[34:35], v2 offset:26624
    v_fma_f32 v115, v115, v8, v9
    v_mfma_f32_16x16x32_bf16 v[88:91], v[44:47], v[236:239], v[88:91]
    ds_read_b64_tr_b16 v[36:37], v2 offset:28672
    v_cvt_pk_bf16_f32 v248, v112, v113
    v_mfma_f32_16x16x32_bf16 v[88:91], v[40:43], v[232:235], v[88:91]
    ds_read_b64_tr_b16 v[38:39], v2 offset:30720
    v_mfma_f32_16x16x32_bf16 v[76:79], v[48:51], v[168:171], v[76:79]
    ds_read_b64_tr_b16 v[40:41], v3 offset:24576
    v_cvt_pk_bf16_f32 v249, v114, v115
    v_fma_f32 v116, v116, v8, v9
    v_mfma_f32_16x16x32_bf16 v[76:79], v[52:55], v[172:175], v[76:79]
    ds_read_b64_tr_b16 v[42:43], v3 offset:26624
    v_mfma_f32_16x16x32_bf16 v[92:95], v[52:55], v[236:239], v[92:95]
    ds_read_b64_tr_b16 v[44:45], v3 offset:28672
    v_fma_f32 v117, v117, v8, v9
    v_fma_f32 v118, v118, v8, v9
    v_mfma_f32_16x16x32_bf16 v[92:95], v[48:51], v[232:235], v[92:95]
    ds_read_b64_tr_b16 v[46:47], v3 offset:30720
    s_waitcnt lgkmcnt(4)
    v_mfma_f32_16x16x32_bf16 v[64:67], v[24:27], v[176:179], v[64:67]
    ds_read_b64_tr_b16 v[48:49], v4 offset:24576
    v_fma_f32 v119, v119, v8, v9
    v_cvt_pk_bf16_f32 v250, v116, v117
    v_mfma_f32_16x16x32_bf16 v[64:67], v[28:31], v[180:183], v[64:67]
    ds_read_b64_tr_b16 v[50:51], v4 offset:26624
    v_mfma_f32_16x16x32_bf16 v[80:83], v[28:31], v[244:247], v[80:83]
    ds_read_b64_tr_b16 v[52:53], v4 offset:28672
    v_cvt_pk_bf16_f32 v251, v118, v119
    v_fma_f32 v120, v120, v8, v9
    v_mfma_f32_16x16x32_bf16 v[80:83], v[24:27], v[240:243], v[80:83]
    ds_read_b64_tr_b16 v[54:55], v4 offset:30720
    v_mfma_f32_16x16x32_bf16 v[68:71], v[32:35], v[176:179], v[68:71]
    ds_read_b64_tr_b16 v[24:25], v1 offset:32768
    v_fma_f32 v121, v121, v8, v9
    v_fma_f32 v122, v122, v8, v9
    v_mfma_f32_16x16x32_bf16 v[68:71], v[36:39], v[180:183], v[68:71]
    ds_read_b64_tr_b16 v[26:27], v1 offset:34816
    v_mfma_f32_16x16x32_bf16 v[84:87], v[36:39], v[244:247], v[84:87]
    ds_read_b64_tr_b16 v[28:29], v1 offset:36864
    v_fma_f32 v123, v123, v8, v9
    v_cvt_pk_bf16_f32 v252, v120, v121
    v_mfma_f32_16x16x32_bf16 v[84:87], v[32:35], v[240:243], v[84:87]
    ds_read_b64_tr_b16 v[30:31], v1 offset:38912
    s_waitcnt lgkmcnt(4)
    v_mfma_f32_16x16x32_bf16 v[72:75], v[40:43], v[176:179], v[72:75]
    ds_read_b64_tr_b16 v[32:33], v2 offset:32768
    v_cvt_pk_bf16_f32 v253, v122, v123
    v_fma_f32 v124, v124, v8, v9
    v_mfma_f32_16x16x32_bf16 v[72:75], v[44:47], v[180:183], v[72:75]
    ds_read_b64_tr_b16 v[34:35], v2 offset:34816
    v_mfma_f32_16x16x32_bf16 v[88:91], v[44:47], v[244:247], v[88:91]
    ds_read_b64_tr_b16 v[36:37], v2 offset:36864
    v_fma_f32 v125, v125, v8, v9
    v_fma_f32 v126, v126, v8, v9
    v_mfma_f32_16x16x32_bf16 v[88:91], v[40:43], v[240:243], v[88:91]
    ds_read_b64_tr_b16 v[38:39], v2 offset:38912
    v_mfma_f32_16x16x32_bf16 v[76:79], v[48:51], v[176:179], v[76:79]
    ds_read_b64_tr_b16 v[40:41], v3 offset:32768
    v_fma_f32 v127, v127, v8, v9
    v_cvt_pk_bf16_f32 v254, v124, v125
    v_mfma_f32_16x16x32_bf16 v[76:79], v[52:55], v[180:183], v[76:79]
    ds_read_b64_tr_b16 v[42:43], v3 offset:34816
    v_mfma_f32_16x16x32_bf16 v[92:95], v[52:55], v[244:247], v[92:95]
    ds_read_b64_tr_b16 v[44:45], v3 offset:36864
    v_cvt_pk_bf16_f32 v255, v126, v127
    v_mfma_f32_16x16x32_bf16 v[92:95], v[48:51], v[240:243], v[92:95]
    ds_read_b64_tr_b16 v[46:47], v3 offset:38912
    s_waitcnt lgkmcnt(4)
    v_mfma_f32_16x16x32_bf16 v[64:67], v[24:27], v[184:187], v[64:67]
    ds_read_b64_tr_b16 v[48:49], v4 offset:32768
    v_mfma_f32_16x16x32_bf16 v[64:67], v[28:31], v[188:191], v[64:67]
    ds_read_b64_tr_b16 v[50:51], v4 offset:34816
    v_mfma_f32_16x16x32_bf16 v[80:83], v[28:31], v[252:255], v[80:83]
    ds_read_b64_tr_b16 v[52:53], v4 offset:36864
    v_mfma_f32_16x16x32_bf16 v[80:83], v[24:27], v[248:251], v[80:83]
    ds_read_b64_tr_b16 v[54:55], v4 offset:38912
    v_mfma_f32_16x16x32_bf16 v[68:71], v[32:35], v[184:187], v[68:71]
    ds_read_b64_tr_b16 v[24:25], v1 offset:40960
    v_mfma_f32_16x16x32_bf16 v[68:71], v[36:39], v[188:191], v[68:71]
    ds_read_b64_tr_b16 v[26:27], v1 offset:43008
    v_mfma_f32_16x16x32_bf16 v[84:87], v[36:39], v[252:255], v[84:87]
    ds_read_b64_tr_b16 v[28:29], v1 offset:45056
    v_mfma_f32_16x16x32_bf16 v[84:87], v[32:35], v[248:251], v[84:87]
    ds_read_b64_tr_b16 v[30:31], v1 offset:47104
    s_waitcnt lgkmcnt(4)
    v_mfma_f32_16x16x32_bf16 v[72:75], v[40:43], v[184:187], v[72:75]
    ds_read_b64_tr_b16 v[32:33], v1 offset:49152
    v_mfma_f32_16x16x32_bf16 v[72:75], v[44:47], v[188:191], v[72:75]
    ds_read_b64_tr_b16 v[34:35], v1 offset:51200
    v_mfma_f32_16x16x32_bf16 v[88:91], v[44:47], v[252:255], v[88:91]
    ds_read_b64_tr_b16 v[36:37], v1 offset:53248
    v_mfma_f32_16x16x32_bf16 v[88:91], v[40:43], v[248:251], v[88:91]
    ds_read_b64_tr_b16 v[38:39], v1 offset:55296
    v_mfma_f32_16x16x32_bf16 v[76:79], v[48:51], v[184:187], v[76:79]
    s_barrier
    ds_read_b64_tr_b16 v[40:41], v1 offset:57344
    v_mfma_f32_16x16x32_bf16 v[76:79], v[52:55], v[188:191], v[76:79]
    ds_read_b64_tr_b16 v[42:43], v1 offset:59392
    v_mfma_f32_16x16x32_bf16 v[92:95], v[52:55], v[252:255], v[92:95]
    ds_read_b64_tr_b16 v[44:45], v1 offset:61440
    v_mfma_f32_16x16x32_bf16 v[92:95], v[48:51], v[248:251], v[92:95]
    ds_read_b64_tr_b16 v[46:47], v1 offset:63488
    s_waitcnt lgkmcnt(4)
    v_mfma_f32_16x16x32_bf16 v[96:99], v[24:27], v[128:131], 0
    v_add_u32 v1, 0x10000, v1
    ds_read_b64_tr_b16 v[48:49], v1 offset:0
    v_mfma_f32_16x16x32_bf16 v[96:99], v[28:31], v[132:135], v[96:99]
    ds_read_b64_tr_b16 v[50:51], v1 offset:2048
    v_mfma_f32_16x16x32_bf16 v[112:115], v[28:31], v[196:199], 0
    ds_read_b64_tr_b16 v[52:53], v1 offset:4096
    buffer_load_dword v10, off, s[72:75], 0 sc1
    v_exp_f32_e64 v12, -v64
    v_mfma_f32_16x16x32_bf16 v[112:115], v[24:27], v[192:195], v[112:115]
    ds_read_b64_tr_b16 v[54:55], v1 offset:6144
    v_exp_f32_e64 v13, -v65
    v_mfma_f32_16x16x32_bf16 v[112:115], v[32:35], v[200:203], v[112:115]
    ds_read_b64_tr_b16 v[24:25], v2 offset:40960
    v_exp_f32_e64 v14, -v66
    v_mfma_f32_16x16x32_bf16 v[112:115], v[36:39], v[204:207], v[112:115]
    ds_read_b64_tr_b16 v[26:27], v2 offset:43008
    v_mfma_f32_16x16x32_bf16 v[96:99], v[36:39], v[140:143], v[96:99]
    ds_read_b64_tr_b16 v[28:29], v2 offset:45056
    v_exp_f32_e64 v15, -v67
    v_mfma_f32_16x16x32_bf16 v[96:99], v[32:35], v[136:139], v[96:99]
    ds_read_b64_tr_b16 v[30:31], v2 offset:47104
    v_fma_f32 v12, v12, s38, s38
    s_waitcnt lgkmcnt(4)
    v_mfma_f32_16x16x32_bf16 v[96:99], v[40:43], v[144:147], v[96:99]
    ds_read_b64_tr_b16 v[32:33], v2 offset:49152
    v_fma_f32 v13, v13, s38, s38
    v_mfma_f32_16x16x32_bf16 v[96:99], v[44:47], v[148:151], v[96:99]
    ds_read_b64_tr_b16 v[34:35], v2 offset:51200
    v_fma_f32 v14, v14, s38, s38
    v_fma_f32 v15, v15, s38, s38
    v_mfma_f32_16x16x32_bf16 v[112:115], v[44:47], v[212:215], v[112:115]
    ds_read_b64_tr_b16 v[36:37], v2 offset:53248
    v_rcp_f32 v12, v12
    v_mfma_f32_16x16x32_bf16 v[112:115], v[40:43], v[208:211], v[112:115]
    ds_read_b64_tr_b16 v[38:39], v2 offset:55296
    v_mfma_f32_16x16x32_bf16 v[112:115], v[48:51], v[216:219], v[112:115]
    ds_read_b64_tr_b16 v[40:41], v2 offset:57344
    v_rcp_f32 v13, v13
    v_mfma_f32_16x16x32_bf16 v[112:115], v[52:55], v[220:223], v[112:115]
    ds_read_b64_tr_b16 v[42:43], v2 offset:59392
    v_rcp_f32 v14, v14
    v_mfma_f32_16x16x32_bf16 v[96:99], v[52:55], v[156:159], v[96:99]
    ds_read_b64_tr_b16 v[44:45], v2 offset:61440
    v_mfma_f32_16x16x32_bf16 v[96:99], v[48:51], v[152:155], v[96:99]
    ds_read_b64_tr_b16 v[46:47], v2 offset:63488
    v_rcp_f32 v15, v15
    s_waitcnt lgkmcnt(4)
    v_mfma_f32_16x16x32_bf16 v[100:103], v[24:27], v[128:131], 0
    v_add_u32 v2, 0x10000, v2
    ds_read_b64_tr_b16 v[48:49], v2 offset:0
    v_mul_f32 v64, v64, v12
    v_mfma_f32_16x16x32_bf16 v[100:103], v[28:31], v[132:135], v[100:103]
    ds_read_b64_tr_b16 v[50:51], v2 offset:2048
    v_mul_f32 v65, v65, v13
    v_mul_f32 v66, v66, v14
    v_mfma_f32_16x16x32_bf16 v[116:119], v[28:31], v[196:199], 0
    ds_read_b64_tr_b16 v[52:53], v2 offset:4096
    v_mul_f32 v67, v67, v15
    v_mfma_f32_16x16x32_bf16 v[116:119], v[24:27], v[192:195], v[116:119]
    ds_read_b64_tr_b16 v[54:55], v2 offset:6144
    v_exp_f32_e64 v16, -v80
    v_mfma_f32_16x16x32_bf16 v[116:119], v[32:35], v[200:203], v[116:119]
    ds_read_b64_tr_b16 v[24:25], v3 offset:40960
    v_exp_f32_e64 v17, -v81
    v_mfma_f32_16x16x32_bf16 v[116:119], v[36:39], v[204:207], v[116:119]
    ds_read_b64_tr_b16 v[26:27], v3 offset:43008
    v_mfma_f32_16x16x32_bf16 v[100:103], v[36:39], v[140:143], v[100:103]
    ds_read_b64_tr_b16 v[28:29], v3 offset:45056
    v_exp_f32_e64 v18, -v82
    v_mfma_f32_16x16x32_bf16 v[100:103], v[32:35], v[136:139], v[100:103]
    ds_read_b64_tr_b16 v[30:31], v3 offset:47104
    v_exp_f32_e64 v19, -v83
    s_waitcnt lgkmcnt(4)
    v_mfma_f32_16x16x32_bf16 v[100:103], v[40:43], v[144:147], v[100:103]
    ds_read_b64_tr_b16 v[32:33], v3 offset:49152
    v_mfma_f32_16x16x32_bf16 v[100:103], v[44:47], v[148:151], v[100:103]
    ds_read_b64_tr_b16 v[34:35], v3 offset:51200
    v_fma_f32 v16, v16, s38, s38
    v_fma_f32 v17, v17, s38, s38
    v_mfma_f32_16x16x32_bf16 v[116:119], v[44:47], v[212:215], v[116:119]
    ds_read_b64_tr_b16 v[36:37], v3 offset:53248
    v_fma_f32 v18, v18, s38, s38
    v_mfma_f32_16x16x32_bf16 v[116:119], v[40:43], v[208:211], v[116:119]
    ds_read_b64_tr_b16 v[38:39], v3 offset:55296
    v_fma_f32 v19, v19, s38, s38
    v_mfma_f32_16x16x32_bf16 v[116:119], v[48:51], v[216:219], v[116:119]
    ds_read_b64_tr_b16 v[40:41], v3 offset:57344
    v_rcp_f32 v16, v16
    v_mfma_f32_16x16x32_bf16 v[116:119], v[52:55], v[220:223], v[116:119]
    ds_read_b64_tr_b16 v[42:43], v3 offset:59392
    v_rcp_f32 v17, v17
    v_mfma_f32_16x16x32_bf16 v[100:103], v[52:55], v[156:159], v[100:103]
    ds_read_b64_tr_b16 v[44:45], v3 offset:61440
    v_mfma_f32_16x16x32_bf16 v[100:103], v[48:51], v[152:155], v[100:103]
    ds_read_b64_tr_b16 v[46:47], v3 offset:63488
    v_rcp_f32 v18, v18
    s_waitcnt lgkmcnt(4)
    v_mfma_f32_16x16x32_bf16 v[104:107], v[24:27], v[128:131], 0
    v_add_u32 v3, 0x10000, v3
    ds_read_b64_tr_b16 v[48:49], v3 offset:0
    v_rcp_f32 v19, v19
    v_mfma_f32_16x16x32_bf16 v[104:107], v[28:31], v[132:135], v[104:107]
    ds_read_b64_tr_b16 v[50:51], v3 offset:2048
    v_mul_f32 v80, v80, v16
    v_mfma_f32_16x16x32_bf16 v[120:123], v[28:31], v[196:199], 0
    ds_read_b64_tr_b16 v[52:53], v3 offset:4096
    v_mul_f32 v81, v81, v17
    v_mfma_f32_16x16x32_bf16 v[120:123], v[24:27], v[192:195], v[120:123]
    ds_read_b64_tr_b16 v[54:55], v3 offset:6144
    v_mul_f32 v82, v82, v18
    v_mfma_f32_16x16x32_bf16 v[120:123], v[32:35], v[200:203], v[120:123]
    ds_read_b64_tr_b16 v[24:25], v4 offset:40960
    v_mul_f32 v83, v83, v19
    v_exp_f32_e64 v12, -v68
    v_mfma_f32_16x16x32_bf16 v[120:123], v[36:39], v[204:207], v[120:123]
    ds_read_b64_tr_b16 v[26:27], v4 offset:43008
    v_mfma_f32_16x16x32_bf16 v[104:107], v[36:39], v[140:143], v[104:107]
    ds_read_b64_tr_b16 v[28:29], v4 offset:45056
    v_exp_f32_e64 v13, -v69
    v_mfma_f32_16x16x32_bf16 v[104:107], v[32:35], v[136:139], v[104:107]
    ds_read_b64_tr_b16 v[30:31], v4 offset:47104
    v_exp_f32_e64 v14, -v70
    s_waitcnt lgkmcnt(4)
    v_mfma_f32_16x16x32_bf16 v[104:107], v[40:43], v[144:147], v[104:107]
    ds_read_b64_tr_b16 v[32:33], v4 offset:49152
    v_mfma_f32_16x16x32_bf16 v[104:107], v[44:47], v[148:151], v[104:107]
    ds_read_b64_tr_b16 v[34:35], v4 offset:51200
    v_exp_f32_e64 v15, -v71
    v_mfma_f32_16x16x32_bf16 v[120:123], v[44:47], v[212:215], v[120:123]
    ds_read_b64_tr_b16 v[36:37], v4 offset:53248
    v_fma_f32 v12, v12, s38, s38
    v_mfma_f32_16x16x32_bf16 v[120:123], v[40:43], v[208:211], v[120:123]
    ds_read_b64_tr_b16 v[38:39], v4 offset:55296
    v_fma_f32 v13, v13, s38, s38
    v_mfma_f32_16x16x32_bf16 v[120:123], v[48:51], v[216:219], v[120:123]
    ds_read_b64_tr_b16 v[40:41], v4 offset:57344
    v_fma_f32 v14, v14, s38, s38
    v_fma_f32 v15, v15, s38, s38
    v_mfma_f32_16x16x32_bf16 v[120:123], v[52:55], v[220:223], v[120:123]
    ds_read_b64_tr_b16 v[42:43], v4 offset:59392
    v_rcp_f32 v12, v12
    v_mfma_f32_16x16x32_bf16 v[104:107], v[52:55], v[156:159], v[104:107]
    ds_read_b64_tr_b16 v[44:45], v4 offset:61440
    v_mfma_f32_16x16x32_bf16 v[104:107], v[48:51], v[152:155], v[104:107]
    ds_read_b64_tr_b16 v[46:47], v4 offset:63488
    v_rcp_f32 v13, v13
    s_waitcnt lgkmcnt(4)
    v_mfma_f32_16x16x32_bf16 v[108:111], v[24:27], v[128:131], 0
    v_add_u32 v4, 0x10000, v4
    ds_read_b64_tr_b16 v[48:49], v4 offset:0
    v_rcp_f32 v14, v14
    v_mfma_f32_16x16x32_bf16 v[108:111], v[28:31], v[132:135], v[108:111]
    ds_read_b64_tr_b16 v[50:51], v4 offset:2048
    v_rcp_f32 v15, v15
    v_mfma_f32_16x16x32_bf16 v[124:127], v[28:31], v[196:199], 0
    ds_read_b64_tr_b16 v[52:53], v4 offset:4096
    v_mfma_f32_16x16x32_bf16 v[124:127], v[24:27], v[192:195], v[124:127]
    ds_read_b64_tr_b16 v[54:55], v4 offset:6144
    v_mul_f32 v68, v68, v12
    v_mfma_f32_16x16x32_bf16 v[124:127], v[32:35], v[200:203], v[124:127]
    ds_read_b64_tr_b16 v[24:25], v1 offset:8192
    v_mul_f32 v69, v69, v13
    v_mul_f32 v70, v70, v14
    v_mfma_f32_16x16x32_bf16 v[124:127], v[36:39], v[204:207], v[124:127]
    ds_read_b64_tr_b16 v[26:27], v1 offset:10240
    v_mul_f32 v71, v71, v15
    v_mfma_f32_16x16x32_bf16 v[108:111], v[36:39], v[140:143], v[108:111]
    ds_read_b64_tr_b16 v[28:29], v1 offset:12288
    v_exp_f32_e64 v16, -v84
    v_mfma_f32_16x16x32_bf16 v[108:111], v[32:35], v[136:139], v[108:111]
    ds_read_b64_tr_b16 v[30:31], v1 offset:14336
    v_exp_f32_e64 v17, -v85
    s_waitcnt lgkmcnt(4)
    v_mfma_f32_16x16x32_bf16 v[108:111], v[40:43], v[144:147], v[108:111]
    ds_read_b64_tr_b16 v[32:33], v1 offset:16384
    v_mfma_f32_16x16x32_bf16 v[108:111], v[44:47], v[148:151], v[108:111]
    ds_read_b64_tr_b16 v[34:35], v1 offset:18432
    v_exp_f32_e64 v18, -v86
    v_mfma_f32_16x16x32_bf16 v[124:127], v[44:47], v[212:215], v[124:127]
    ds_read_b64_tr_b16 v[36:37], v1 offset:20480
    v_exp_f32_e64 v19, -v87
    v_mfma_f32_16x16x32_bf16 v[124:127], v[40:43], v[208:211], v[124:127]
    ds_read_b64_tr_b16 v[38:39], v1 offset:22528
    v_mfma_f32_16x16x32_bf16 v[124:127], v[48:51], v[216:219], v[124:127]
    s_barrier
    ds_read_b64_tr_b16 v[40:41], v1 offset:24576
    v_fma_f32 v16, v16, s38, s38
    v_fma_f32 v17, v17, s38, s38
    v_mfma_f32_16x16x32_bf16 v[124:127], v[52:55], v[220:223], v[124:127]
    ds_read_b64_tr_b16 v[42:43], v1 offset:26624
    v_fma_f32 v18, v18, s38, s38
    v_mfma_f32_16x16x32_bf16 v[108:111], v[52:55], v[156:159], v[108:111]
    ds_read_b64_tr_b16 v[44:45], v1 offset:28672
    v_fma_f32 v19, v19, s38, s38
    v_mfma_f32_16x16x32_bf16 v[108:111], v[48:51], v[152:155], v[108:111]
    ds_read_b64_tr_b16 v[46:47], v1 offset:30720
    v_rcp_f32 v16, v16
    s_waitcnt lgkmcnt(4)
    v_mfma_f32_16x16x32_bf16 v[96:99], v[24:27], v[160:163], v[96:99]
    ds_read_b64_tr_b16 v[48:49], v1 offset:32768
    v_rcp_f32 v17, v17
    v_mfma_f32_16x16x32_bf16 v[96:99], v[28:31], v[164:167], v[96:99]
    ds_read_b64_tr_b16 v[50:51], v1 offset:34816
    v_rcp_f32 v18, v18
    v_mfma_f32_16x16x32_bf16 v[112:115], v[28:31], v[228:231], v[112:115]
    ds_read_b64_tr_b16 v[52:53], v1 offset:36864
    v_mfma_f32_16x16x32_bf16 v[112:115], v[24:27], v[224:227], v[112:115]
    ds_read_b64_tr_b16 v[54:55], v1 offset:38912
    v_rcp_f32 v19, v19
    v_mfma_f32_16x16x32_bf16 v[112:115], v[32:35], v[232:235], v[112:115]
    ds_read_b64_tr_b16 v[24:25], v2 offset:8192
    v_mul_f32 v84, v84, v16
    v_mfma_f32_16x16x32_bf16 v[112:115], v[36:39], v[236:239], v[112:115]
    ds_read_b64_tr_b16 v[26:27], v2 offset:10240
    v_mul_f32 v85, v85, v17
    v_mfma_f32_16x16x32_bf16 v[96:99], v[36:39], v[172:175], v[96:99]
    ds_read_b64_tr_b16 v[28:29], v2 offset:12288
    v_mul_f32 v86, v86, v18
    v_mfma_f32_16x16x32_bf16 v[96:99], v[32:35], v[168:171], v[96:99]
    ds_read_b64_tr_b16 v[30:31], v2 offset:14336
    v_mul_f32 v87, v87, v19
    v_exp_f32_e64 v12, -v72
    s_waitcnt lgkmcnt(4)
    v_mfma_f32_16x16x32_bf16 v[96:99], v[40:43], v[176:179], v[96:99]
    ds_read_b64_tr_b16 v[32:33], v2 offset:16384
    v_mfma_f32_16x16x32_bf16 v[96:99], v[44:47], v[180:183], v[96:99]
    ds_read_b64_tr_b16 v[34:35], v2 offset:18432
    v_exp_f32_e64 v13, -v73
    v_mfma_f32_16x16x32_bf16 v[112:115], v[44:47], v[244:247], v[112:115]
    ds_read_b64_tr_b16 v[36:37], v2 offset:20480
    v_exp_f32_e64 v14, -v74
    v_mfma_f32_16x16x32_bf16 v[112:115], v[40:43], v[240:243], v[112:115]
    ds_read_b64_tr_b16 v[38:39], v2 offset:22528
    v_mfma_f32_16x16x32_bf16 v[112:115], v[48:51], v[248:251], v[112:115]
    ds_read_b64_tr_b16 v[40:41], v2 offset:24576
    v_exp_f32_e64 v15, -v75
    v_mfma_f32_16x16x32_bf16 v[112:115], v[52:55], v[252:255], v[112:115]
    ds_read_b64_tr_b16 v[42:43], v2 offset:26624
    v_fma_f32 v12, v12, s38, s38
    v_mfma_f32_16x16x32_bf16 v[96:99], v[52:55], v[188:191], v[96:99]
    ds_read_b64_tr_b16 v[44:45], v2 offset:28672
    v_fma_f32 v13, v13, s38, s38
    v_mfma_f32_16x16x32_bf16 v[96:99], v[48:51], v[184:187], v[96:99]
    ds_read_b64_tr_b16 v[46:47], v2 offset:30720
    v_fma_f32 v14, v14, s38, s38
    v_fma_f32 v15, v15, s38, s38
    s_waitcnt lgkmcnt(4)
    v_mfma_f32_16x16x32_bf16 v[100:103], v[24:27], v[160:163], v[100:103]
    ds_read_b64_tr_b16 v[48:49], v2 offset:32768
    v_rcp_f32 v12, v12
    v_mfma_f32_16x16x32_bf16 v[100:103], v[28:31], v[164:167], v[100:103]
    ds_read_b64_tr_b16 v[50:51], v2 offset:34816
    v_rcp_f32 v13, v13
    v_mfma_f32_16x16x32_bf16 v[116:119], v[28:31], v[228:231], v[116:119]
    ds_read_b64_tr_b16 v[52:53], v2 offset:36864
    v_mfma_f32_16x16x32_bf16 v[116:119], v[24:27], v[224:227], v[116:119]
    ds_read_b64_tr_b16 v[54:55], v2 offset:38912
    v_rcp_f32 v14, v14
    v_mfma_f32_16x16x32_bf16 v[116:119], v[32:35], v[232:235], v[116:119]
    ds_read_b64_tr_b16 v[24:25], v3 offset:8192
    v_rcp_f32 v15, v15
    v_mfma_f32_16x16x32_bf16 v[116:119], v[36:39], v[236:239], v[116:119]
    ds_read_b64_tr_b16 v[26:27], v3 offset:10240
    v_mfma_f32_16x16x32_bf16 v[100:103], v[36:39], v[172:175], v[100:103]
    ds_read_b64_tr_b16 v[28:29], v3 offset:12288
    v_mul_f32 v72, v72, v12
    v_mfma_f32_16x16x32_bf16 v[100:103], v[32:35], v[168:171], v[100:103]
    ds_read_b64_tr_b16 v[30:31], v3 offset:14336
    v_mul_f32 v73, v73, v13
    v_mul_f32 v74, v74, v14
    s_waitcnt lgkmcnt(4)
    v_mfma_f32_16x16x32_bf16 v[100:103], v[40:43], v[176:179], v[100:103]
    ds_read_b64_tr_b16 v[32:33], v3 offset:16384
    v_mul_f32 v75, v75, v15
    v_mfma_f32_16x16x32_bf16 v[100:103], v[44:47], v[180:183], v[100:103]
    ds_read_b64_tr_b16 v[34:35], v3 offset:18432
    v_exp_f32_e64 v16, -v88
    v_mfma_f32_16x16x32_bf16 v[116:119], v[44:47], v[244:247], v[116:119]
    ds_read_b64_tr_b16 v[36:37], v3 offset:20480
    v_exp_f32_e64 v17, -v89
    v_mfma_f32_16x16x32_bf16 v[116:119], v[40:43], v[240:243], v[116:119]
    ds_read_b64_tr_b16 v[38:39], v3 offset:22528
    v_mfma_f32_16x16x32_bf16 v[116:119], v[48:51], v[248:251], v[116:119]
    ds_read_b64_tr_b16 v[40:41], v3 offset:24576
    v_exp_f32_e64 v18, -v90
    v_mfma_f32_16x16x32_bf16 v[116:119], v[52:55], v[252:255], v[116:119]
    ds_read_b64_tr_b16 v[42:43], v3 offset:26624
    v_exp_f32_e64 v19, -v91
    v_mfma_f32_16x16x32_bf16 v[100:103], v[52:55], v[188:191], v[100:103]
    ds_read_b64_tr_b16 v[44:45], v3 offset:28672
    v_mfma_f32_16x16x32_bf16 v[100:103], v[48:51], v[184:187], v[100:103]
    ds_read_b64_tr_b16 v[46:47], v3 offset:30720
    v_fma_f32 v16, v16, s38, s38
    v_fma_f32 v17, v17, s38, s38
    s_waitcnt lgkmcnt(4)
    v_mfma_f32_16x16x32_bf16 v[104:107], v[24:27], v[160:163], v[104:107]
    ds_read_b64_tr_b16 v[48:49], v3 offset:32768
    v_fma_f32 v18, v18, s38, s38
    v_mfma_f32_16x16x32_bf16 v[104:107], v[28:31], v[164:167], v[104:107]
    ds_read_b64_tr_b16 v[50:51], v3 offset:34816
    v_fma_f32 v19, v19, s38, s38
    v_rcp_f32 v16, v16
    v_mfma_f32_16x16x32_bf16 v[120:123], v[28:31], v[228:231], v[120:123]
    ds_read_b64_tr_b16 v[52:53], v3 offset:36864
    v_mfma_f32_16x16x32_bf16 v[120:123], v[24:27], v[224:227], v[120:123]
    ds_read_b64_tr_b16 v[54:55], v3 offset:38912
    v_rcp_f32 v17, v17
    v_mfma_f32_16x16x32_bf16 v[120:123], v[32:35], v[232:235], v[120:123]
    ds_read_b64_tr_b16 v[24:25], v4 offset:8192
    v_rcp_f32 v18, v18
    v_mfma_f32_16x16x32_bf16 v[120:123], v[36:39], v[236:239], v[120:123]
    ds_read_b64_tr_b16 v[26:27], v4 offset:10240
    v_mfma_f32_16x16x32_bf16 v[104:107], v[36:39], v[172:175], v[104:107]
    ds_read_b64_tr_b16 v[28:29], v4 offset:12288
    v_rcp_f32 v19, v19
    v_mfma_f32_16x16x32_bf16 v[104:107], v[32:35], v[168:171], v[104:107]
    ds_read_b64_tr_b16 v[30:31], v4 offset:14336
    v_mul_f32 v88, v88, v16
    s_waitcnt lgkmcnt(4)
    v_mfma_f32_16x16x32_bf16 v[104:107], v[40:43], v[176:179], v[104:107]
    ds_read_b64_tr_b16 v[32:33], v4 offset:16384
    v_mul_f32 v89, v89, v17
    v_mfma_f32_16x16x32_bf16 v[104:107], v[44:47], v[180:183], v[104:107]
    ds_read_b64_tr_b16 v[34:35], v4 offset:18432
    v_mul_f32 v90, v90, v18
    v_mul_f32 v91, v91, v19
    v_mfma_f32_16x16x32_bf16 v[120:123], v[44:47], v[244:247], v[120:123]
    ds_read_b64_tr_b16 v[36:37], v4 offset:20480
    s_waitcnt vmcnt(0)
    v_cmp_eq_u32 vcc, 0, v10
    s_cbranch_vccnz Ln_2001
Lc_2002:
    v_mfma_f32_16x16x32_bf16 v[120:123], v[40:43], v[240:243], v[120:123]
    ds_read_b64_tr_b16 v[38:39], v4 offset:22528
    v_mul_f32 v96, v96, v64
    v_mfma_f32_16x16x32_bf16 v[120:123], v[48:51], v[248:251], v[120:123]
    ds_read_b64_tr_b16 v[40:41], v4 offset:24576
    v_mul_f32 v97, v97, v65
    v_mul_f32 v98, v98, v66
    v_mfma_f32_16x16x32_bf16 v[120:123], v[52:55], v[252:255], v[120:123]
    ds_read_b64_tr_b16 v[42:43], v4 offset:26624
    v_mul_f32 v99, v99, v67
    v_mfma_f32_16x16x32_bf16 v[104:107], v[52:55], v[188:191], v[104:107]
    ds_read_b64_tr_b16 v[44:45], v4 offset:28672
    v_mul_f32 v100, v100, v68
    v_mfma_f32_16x16x32_bf16 v[104:107], v[48:51], v[184:187], v[104:107]
    ds_read_b64_tr_b16 v[46:47], v4 offset:30720
    v_mul_f32 v101, v101, v69
    v_mul_f32 v102, v102, v70
    s_waitcnt lgkmcnt(4)
    v_mfma_f32_16x16x32_bf16 v[108:111], v[24:27], v[160:163], v[108:111]
    ds_read_b64_tr_b16 v[48:49], v4 offset:32768
    v_mul_f32 v103, v103, v71
    v_mfma_f32_16x16x32_bf16 v[108:111], v[28:31], v[164:167], v[108:111]
    ds_read_b64_tr_b16 v[50:51], v4 offset:34816
    v_mul_f32 v112, v112, v80
    v_mul_f32 v113, v113, v81
    v_mfma_f32_16x16x32_bf16 v[124:127], v[28:31], v[228:231], v[124:127]
    ds_read_b64_tr_b16 v[52:53], v4 offset:36864
    v_mul_f32 v114, v114, v82
    v_mfma_f32_16x16x32_bf16 v[124:127], v[24:27], v[224:227], v[124:127]
    ds_read_b64_tr_b16 v[54:55], v4 offset:38912
    v_mul_f32 v115, v115, v83
    v_mfma_f32_16x16x32_bf16 v[124:127], v[32:35], v[232:235], v[124:127]
    v_add_u32 v5, 0x1a000, v5
    ds_read_b64_tr_b16 v[24:25], v5 offset:0
    v_mul_f32 v116, v116, v84
    v_mul_f32 v117, v117, v85
    v_mfma_f32_16x16x32_bf16 v[124:127], v[36:39], v[236:239], v[124:127]
    ds_read_b64_tr_b16 v[26:27], v5 offset:1024
    v_mul_f32 v118, v118, v86
    v_mfma_f32_16x16x32_bf16 v[108:111], v[36:39], v[172:175], v[108:111]
    ds_read_b64_tr_b16 v[28:29], v5 offset:2048
    v_mul_f32 v119, v119, v87
    v_mfma_f32_16x16x32_bf16 v[108:111], v[32:35], v[168:171], v[108:111]
    ds_read_b64_tr_b16 v[30:31], v5 offset:3072
    v_cvt_pk_bf16_f32 v96, v96, v97
    v_cvt_pk_bf16_f32 v97, v98, v99
    s_waitcnt lgkmcnt(4)
    v_mfma_f32_16x16x32_bf16 v[108:111], v[40:43], v[176:179], v[108:111]
    ds_read_b64_tr_b16 v[32:33], v5 offset:4096
    v_cvt_pk_bf16_f32 v98, v100, v101
    v_mfma_f32_16x16x32_bf16 v[108:111], v[44:47], v[180:183], v[108:111]
    ds_read_b64_tr_b16 v[34:35], v5 offset:5120
    v_cvt_pk_bf16_f32 v99, v102, v103
    buffer_store_dwordx4 v[96:99], v7, s[64:67], s78 offen offset:0 sc1
    v_mfma_f32_16x16x32_bf16 v[124:127], v[44:47], v[244:247], v[124:127]
    ds_read_b64_tr_b16 v[36:37], v5 offset:6144
    v_cvt_pk_bf16_f32 v112, v112, v113
    v_mfma_f32_16x16x32_bf16 v[124:127], v[40:43], v[240:243], v[124:127]
    ds_read_b64_tr_b16 v[38:39], v5 offset:7168
    v_cvt_pk_bf16_f32 v113, v114, v115
    v_mfma_f32_16x16x32_bf16 v[124:127], v[48:51], v[248:251], v[124:127]
    s_barrier
    ds_read_b64_tr_b16 v[40:41], v5 offset:8192
    v_cvt_pk_bf16_f32 v114, v116, v117
    v_cvt_pk_bf16_f32 v115, v118, v119
    v_mfma_f32_16x16x32_bf16 v[124:127], v[52:55], v[252:255], v[124:127]
    s_branch L_pg4603x
L_pg4603:
    s_setpc_b64 s[30:31]
L_pg4603x:
    ds_read_b64_tr_b16 v[42:43], v5 offset:9216
    buffer_store_dwordx4 v[112:115], v7, s[64:67], s78 offen offset:1024 sc1
    v_mfma_f32_16x16x32_bf16 v[108:111], v[52:55], v[188:191], v[108:111]
    ds_read_b64_tr_b16 v[44:45], v5 offset:10240
    v_exp_f32_e64 v12, -v76
    v_mfma_f32_16x16x32_bf16 v[108:111], v[48:51], v[184:187], v[108:111]
    ds_read_b64_tr_b16 v[46:47], v5 offset:11264
    v_exp_f32_e64 v13, -v77
    s_waitcnt lgkmcnt(4)
    v_mfma_f32_16x16x32_bf16 v[64:67], v[24:27], v[128:131], 0
    ds_read_b64_tr_b16 v[48:49], v5 offset:12288
    v_mfma_f32_16x16x32_bf16 v[64:67], v[28:31], v[132:135], v[64:67]
    ds_read_b64_tr_b16 v[50:51], v5 offset:13312
    v_exp_f32_e64 v14, -v78
    v_mfma_f32_16x16x32_bf16 v[80:83], v[28:31], v[196:199], 0
    ds_read_b64_tr_b16 v[52:53], v5 offset:14336
    v_exp_f32_e64 v15, -v79
    v_mfma_f32_16x16x32_bf16 v[80:83], v[24:27], v[192:195], v[80:83]
    ds_read_b64_tr_b16 v[54:55], v5 offset:15360
    v_mfma_f32_16x16x32_bf16 v[80:83], v[32:35], v[200:203], v[80:83]
    ds_read_b64_tr_b16 v[24:25], v5 offset:16384
    v_fma_f32 v12, v12, s38, s38
    v_fma_f32 v13, v13, s38, s38
    v_mfma_f32_16x16x32_bf16 v[80:83], v[36:39], v[204:207], v[80:83]
    ds_read_b64_tr_b16 v[26:27], v5 offset:17408
    v_fma_f32 v14, v14, s38, s38
    v_mfma_f32_16x16x32_bf16 v[64:67], v[36:39], v[140:143], v[64:67]
    ds_read_b64_tr_b16 v[28:29], v5 offset:18432
    v_fma_f32 v15, v15, s38, s38
    v_rcp_f32 v12, v12
    v_mfma_f32_16x16x32_bf16 v[64:67], v[32:35], v[136:139], v[64:67]
    ds_read_b64_tr_b16 v[30:31], v5 offset:19456
    s_waitcnt lgkmcnt(4)
    v_mfma_f32_16x16x32_bf16 v[64:67], v[40:43], v[144:147], v[64:67]
    ds_read_b64_tr_b16 v[32:33], v5 offset:20480
    v_rcp_f32 v13, v13
    v_mfma_f32_16x16x32_bf16 v[64:67], v[44:47], v[148:151], v[64:67]
    ds_read_b64_tr_b16 v[34:35], v5 offset:21504
    v_rcp_f32 v14, v14
    v_mfma_f32_16x16x32_bf16 v[80:83], v[44:47], v[212:215], v[80:83]
    ds_read_b64_tr_b16 v[36:37], v5 offset:22528
    v_mfma_f32_16x16x32_bf16 v[80:83], v[40:43], v[208:211], v[80:83]
    ds_read_b64_tr_b16 v[38:39], v5 offset:23552
    v_rcp_f32 v15, v15
    v_mfma_f32_16x16x32_bf16 v[80:83], v[48:51], v[216:219], v[80:83]
    ds_read_b64_tr_b16 v[40:41], v5 offset:24576
    v_mul_f32 v76, v76, v12
    v_mfma_f32_16x16x32_bf16 v[80:83], v[52:55], v[220:223], v[80:83]
    ds_read_b64_tr_b16 v[42:43], v5 offset:25600
    v_mul_f32 v77, v77, v13
    v_mfma_f32_16x16x32_bf16 v[64:67], v[52:55], v[156:159], v[64:67]
    ds_read_b64_tr_b16 v[44:45], v5 offset:26624
    v_mul_f32 v78, v78, v14
    v_mfma_f32_16x16x32_bf16 v[64:67], v[48:51], v[152:155], v[64:67]
    ds_read_b64_tr_b16 v[46:47], v5 offset:27648
    v_mul_f32 v79, v79, v15
    v_exp_f32_e64 v16, -v92
    s_waitcnt lgkmcnt(4)
    v_mfma_f32_16x16x32_bf16 v[64:67], v[24:27], v[160:163], v[64:67]
    ds_read_b64_tr_b16 v[48:49], v5 offset:28672
    v_mfma_f32_16x16x32_bf16 v[64:67], v[28:31], v[164:167], v[64:67]
    ds_read_b64_tr_b16 v[50:51], v5 offset:29696
    v_exp_f32_e64 v17, -v93
    v_mfma_f32_16x16x32_bf16 v[80:83], v[28:31], v[228:231], v[80:83]
    ds_read_b64_tr_b16 v[52:53], v5 offset:30720
    v_exp_f32_e64 v18, -v94
    v_mfma_f32_16x16x32_bf16 v[80:83], v[24:27], v[224:227], v[80:83]
    ds_read_b64_tr_b16 v[54:55], v5 offset:31744
    v_mfma_f32_16x16x32_bf16 v[80:83], v[32:35], v[232:235], v[80:83]
    v_add_u32 v6, 0x1a000, v6
    ds_read_b64_tr_b16 v[24:25], v6 offset:0
    v_exp_f32_e64 v19, -v95
    v_mfma_f32_16x16x32_bf16 v[80:83], v[36:39], v[236:239], v[80:83]
    ds_read_b64_tr_b16 v[26:27], v6 offset:1024
    v_fma_f32 v16, v16, s38, s38
    v_mfma_f32_16x16x32_bf16 v[64:67], v[36:39], v[172:175], v[64:67]
    ds_read_b64_tr_b16 v[28:29], v6 offset:2048
    v_fma_f32 v17, v17, s38, s38
    v_fma_f32 v18, v18, s38, s38
    v_mfma_f32_16x16x32_bf16 v[64:67], v[32:35], v[168:171], v[64:67]
    ds_read_b64_tr_b16 v[30:31], v6 offset:3072
    v_fma_f32 v19, v19, s38, s38
    s_waitcnt lgkmcnt(4)
    v_mfma_f32_16x16x32_bf16 v[64:67], v[40:43], v[176:179], v[64:67]
    ds_read_b64_tr_b16 v[32:33], v6 offset:4096
    v_rcp_f32 v16, v16
    v_mfma_f32_16x16x32_bf16 v[64:67], v[44:47], v[180:183], v[64:67]
    ds_read_b64_tr_b16 v[34:35], v6 offset:5120
    v_rcp_f32 v17, v17
    v_mfma_f32_16x16x32_bf16 v[80:83], v[44:47], v[244:247], v[80:83]
    ds_read_b64_tr_b16 v[36:37], v6 offset:6144
    v_mfma_f32_16x16x32_bf16 v[80:83], v[40:43], v[240:243], v[80:83]
    ds_read_b64_tr_b16 v[38:39], v6 offset:7168
    v_rcp_f32 v18, v18
    v_mfma_f32_16x16x32_bf16 v[80:83], v[48:51], v[248:251], v[80:83]
    ds_read_b64_tr_b16 v[40:41], v6 offset:8192
    v_rcp_f32 v19, v19
    v_mfma_f32_16x16x32_bf16 v[80:83], v[52:55], v[252:255], v[80:83]
    ds_read_b64_tr_b16 v[42:43], v6 offset:9216
    v_mfma_f32_16x16x32_bf16 v[64:67], v[52:55], v[188:191], v[64:67]
    ds_read_b64_tr_b16 v[44:45], v6 offset:10240
    v_mul_f32 v92, v92, v16
    v_mfma_f32_16x16x32_bf16 v[64:67], v[48:51], v[184:187], v[64:67]
    ds_read_b64_tr_b16 v[46:47], v6 offset:11264
    v_mul_f32 v93, v93, v17
    v_mul_f32 v94, v94, v18
    s_waitcnt lgkmcnt(4)
    v_mfma_f32_16x16x32_bf16 v[68:71], v[24:27], v[128:131], 0
    ds_read_b64_tr_b16 v[48:49], v6 offset:12288
    v_mul_f32 v95, v95, v19
    v_mfma_f32_16x16x32_bf16 v[68:71], v[28:31], v[132:135], v[68:71]
    ds_read_b64_tr_b16 v[50:51], v6 offset:13312
    v_mul_f32 v104, v104, v72
    v_mul_f32 v105, v105, v73
    v_mfma_f32_16x16x32_bf16 v[84:87], v[28:31], v[196:199], 0
    ds_read_b64_tr_b16 v[52:53], v6 offset:14336
    v_mul_f32 v106, v106, v74
    v_mfma_f32_16x16x32_bf16 v[84:87], v[24:27], v[192:195], v[84:87]
    ds_read_b64_tr_b16 v[54:55], v6 offset:15360
    v_mul_f32 v107, v107, v75
    v_mfma_f32_16x16x32_bf16 v[84:87], v[32:35], v[200:203], v[84:87]
    ds_read_b64_tr_b16 v[24:25], v6 offset:16384
    v_mul_f32 v108, v108, v76
    v_mul_f32 v109, v109, v77
    v_mfma_f32_16x16x32_bf16 v[84:87], v[36:39], v[204:207], v[84:87]
    ds_read_b64_tr_b16 v[26:27], v6 offset:17408
    v_mul_f32 v110, v110, v78
    v_mfma_f32_16x16x32_bf16 v[68:71], v[36:39], v[140:143], v[68:71]
    ds_read_b64_tr_b16 v[28:29], v6 offset:18432
    v_mul_f32 v111, v111, v79
    v_mul_f32 v120, v120, v88
    v_mfma_f32_16x16x32_bf16 v[68:71], v[32:35], v[136:139], v[68:71]
    ds_read_b64_tr_b16 v[30:31], v6 offset:19456
    v_mul_f32 v121, v121, v89
    s_waitcnt lgkmcnt(4)
    v_mfma_f32_16x16x32_bf16 v[68:71], v[40:43], v[144:147], v[68:71]
    ds_read_b64_tr_b16 v[32:33], v6 offset:20480
    v_mul_f32 v122, v122, v90
    v_mfma_f32_16x16x32_bf16 v[68:71], v[44:47], v[148:151], v[68:71]
    ds_read_b64_tr_b16 v[34:35], v6 offset:21504
    v_mul_f32 v123, v123, v91
    v_mul_f32 v124, v124, v92
    v_mfma_f32_16x16x32_bf16 v[84:87], v[44:47], v[212:215], v[84:87]
    ds_read_b64_tr_b16 v[36:37], v6 offset:22528
    v_mul_f32 v125, v125, v93
    v_mfma_f32_16x16x32_bf16 v[84:87], v[40:43], v[208:211], v[84:87]
    ds_read_b64_tr_b16 v[38:39], v6 offset:23552
    v_mul_f32 v126, v126, v94
    v_mul_f32 v127, v127, v95
    v_mfma_f32_16x16x32_bf16 v[84:87], v[48:51], v[216:219], v[84:87]
    ds_read_b64_tr_b16 v[40:41], v6 offset:24576
    v_cvt_pk_bf16_f32 v104, v104, v105
    v_mfma_f32_16x16x32_bf16 v[84:87], v[52:55], v[220:223], v[84:87]
    ds_read_b64_tr_b16 v[42:43], v6 offset:25600
    v_cvt_pk_bf16_f32 v105, v106, v107
    v_mfma_f32_16x16x32_bf16 v[68:71], v[52:55], v[156:159], v[68:71]
    ds_read_b64_tr_b16 v[44:45], v6 offset:26624
    v_cvt_pk_bf16_f32 v106, v108, v109
    v_cvt_pk_bf16_f32 v107, v110, v111
    v_mfma_f32_16x16x32_bf16 v[68:71], v[48:51], v[152:155], v[68:71]
    ds_read_b64_tr_b16 v[46:47], v6 offset:27648
    buffer_store_dwordx4 v[104:107], v7, s[64:67], s78 offen offset:2048 sc1
    s_waitcnt lgkmcnt(4)
    v_mfma_f32_16x16x32_bf16 v[68:71], v[24:27], v[160:163], v[68:71]
    ds_read_b64_tr_b16 v[48:49], v6 offset:28672
    v_cvt_pk_bf16_f32 v120, v120, v121
    v_cvt_pk_bf16_f32 v121, v122, v123
    v_mfma_f32_16x16x32_bf16 v[68:71], v[28:31], v[164:167], v[68:71]
    ds_read_b64_tr_b16 v[50:51], v6 offset:29696
    v_cvt_pk_bf16_f32 v122, v124, v125
    v_mfma_f32_16x16x32_bf16 v[84:87], v[28:31], v[228:231], v[84:87]
    ds_read_b64_tr_b16 v[52:53], v6 offset:30720
    v_cvt_pk_bf16_f32 v123, v126, v127
    v_mfma_f32_16x16x32_bf16 v[84:87], v[24:27], v[224:227], v[84:87]
    ds_read_b64_tr_b16 v[54:55], v6 offset:31744
    buffer_store_dwordx4 v[120:123], v7, s[64:67], s78 offen offset:3072 sc1
    v_exp_f32_e64 v12, -v64
    v_mfma_f32_16x16x32_bf16 v[84:87], v[32:35], v[232:235], v[84:87]
    ds_read_b64_tr_b16 v[24:25], v5 offset:32768
    v_mfma_f32_16x16x32_bf16 v[84:87], v[36:39], v[236:239], v[84:87]
    ds_read_b64_tr_b16 v[26:27], v5 offset:33792
    v_exp_f32_e64 v13, -v65
    v_mfma_f32_16x16x32_bf16 v[68:71], v[36:39], v[172:175], v[68:71]
    ds_read_b64_tr_b16 v[28:29], v5 offset:34816
    v_mfma_f32_16x16x32_bf16 v[68:71], v[32:35], v[168:171], v[68:71]
    ds_read_b64_tr_b16 v[30:31], v5 offset:35840
    v_exp_f32_e64 v14, -v66
    s_waitcnt lgkmcnt(4)
    v_mfma_f32_16x16x32_bf16 v[68:71], v[40:43], v[176:179], v[68:71]
    ds_read_b64_tr_b16 v[32:33], v5 offset:36864
    v_mfma_f32_16x16x32_bf16 v[68:71], v[44:47], v[180:183], v[68:71]
    ds_read_b64_tr_b16 v[34:35], v5 offset:37888
    v_exp_f32_e64 v15, -v67
    v_mfma_f32_16x16x32_bf16 v[84:87], v[44:47], v[244:247], v[84:87]
    ds_read_b64_tr_b16 v[36:37], v5 offset:38912
    v_fma_f32 v12, v12, s38, s38
    v_mfma_f32_16x16x32_bf16 v[84:87], v[40:43], v[240:243], v[84:87]
    ds_read_b64_tr_b16 v[38:39], v5 offset:39936
    v_fma_f32 v13, v13, s38, s38
    v_mfma_f32_16x16x32_bf16 v[84:87], v[48:51], v[248:251], v[84:87]
    s_barrier
    ds_read_b64_tr_b16 v[40:41], v5 offset:40960
    v_fma_f32 v14, v14, s38, s38
    v_mfma_f32_16x16x32_bf16 v[84:87], v[52:55], v[252:255], v[84:87]
    ds_read_b64_tr_b16 v[42:43], v5 offset:41984
    v_fma_f32 v15, v15, s38, s38
    v_mfma_f32_16x16x32_bf16 v[68:71], v[52:55], v[188:191], v[68:71]
    ds_read_b64_tr_b16 v[44:45], v5 offset:43008
    v_rcp_f32 v12, v12
    v_mfma_f32_16x16x32_bf16 v[68:71], v[48:51], v[184:187], v[68:71]
    ds_read_b64_tr_b16 v[46:47], v5 offset:44032
    s_waitcnt lgkmcnt(4)
    v_mfma_f32_16x16x32_bf16 v[72:75], v[24:27], v[128:131], 0
    ds_read_b64_tr_b16 v[48:49], v5 offset:45056
    v_rcp_f32 v13, v13
    v_mfma_f32_16x16x32_bf16 v[72:75], v[28:31], v[132:135], v[72:75]
    ds_read_b64_tr_b16 v[50:51], v5 offset:46080
    v_mfma_f32_16x16x32_bf16 v[88:91], v[28:31], v[196:199], 0
    ds_read_b64_tr_b16 v[52:53], v5 offset:47104
    v_rcp_f32 v14, v14
    v_mfma_f32_16x16x32_bf16 v[88:91], v[24:27], v[192:195], v[88:91]
    ds_read_b64_tr_b16 v[54:55], v5 offset:48128
    v_mfma_f32_16x16x32_bf16 v[88:91], v[32:35], v[200:203], v[88:91]
    ds_read_b64_tr_b16 v[24:25], v5 offset:49152
    v_rcp_f32 v15, v15
    v_mfma_f32_16x16x32_bf16 v[88:91], v[36:39], v[204:207], v[88:91]
    ds_read_b64_tr_b16 v[26:27], v5 offset:50176
    v_mfma_f32_16x16x32_bf16 v[72:75], v[36:39], v[140:143], v[72:75]
    ds_read_b64_tr_b16 v[28:29], v5 offset:51200
    v_mul_f32 v64, v64, v12
    v_mfma_f32_16x16x32_bf16 v[72:75], v[32:35], v[136:139], v[72:75]
    ds_read_b64_tr_b16 v[30:31], v5 offset:52224
    v_mul_f32 v65, v65, v13
    v_mul_f32 v66, v66, v14
    s_waitcnt lgkmcnt(4)
    v_mfma_f32_16x16x32_bf16 v[72:75], v[40:43], v[144:147], v[72:75]
    ds_read_b64_tr_b16 v[32:33], v5 offset:53248
    v_mul_f32 v67, v67, v15
    v_mfma_f32_16x16x32_bf16 v[72:75], v[44:47], v[148:151], v[72:75]
    ds_read_b64_tr_b16 v[34:35], v5 offset:54272
    v_exp_f32_e64 v16, -v80
    v_mfma_f32_16x16x32_bf16 v[88:91], v[44:47], v[212:215], v[88:91]
    ds_read_b64_tr_b16 v[36:37], v5 offset:55296
    v_mfma_f32_16x16x32_bf16 v[88:91], v[40:43], v[208:211], v[88:91]
    ds_read_b64_tr_b16 v[38:39], v5 offset:56320
    v_exp_f32_e64 v17, -v81
    v_mfma_f32_16x16x32_bf16 v[88:91], v[48:51], v[216:219], v[88:91]
    v_add_u32 v5, 0xfffe6000, v5
    ds_read_b64_tr_b16 v[40:41], v5 offset:0
    v_mfma_f32_16x16x32_bf16 v[88:91], v[52:55], v[220:223], v[88:91]
    ds_read_b64_tr_b16 v[42:43], v5 offset:1024
    v_exp_f32_e64 v18, -v82
    v_mfma_f32_16x16x32_bf16 v[72:75], v[52:55], v[156:159], v[72:75]
    ds_read_b64_tr_b16 v[44:45], v5 offset:2048
    v_mfma_f32_16x16x32_bf16 v[72:75], v[48:51], v[152:155], v[72:75]
    ds_read_b64_tr_b16 v[46:47], v5 offset:3072
    v_exp_f32_e64 v19, -v83
    s_waitcnt lgkmcnt(4)
    v_mfma_f32_16x16x32_bf16 v[72:75], v[24:27], v[160:163], v[72:75]
    ds_read_b64_tr_b16 v[48:49], v5 offset:4096
    v_mfma_f32_16x16x32_bf16 v[72:75], v[28:31], v[164:167], v[72:75]
    ds_read_b64_tr_b16 v[50:51], v5 offset:5120
    v_fma_f32 v16, v16, s38, s38
    v_mfma_f32_16x16x32_bf16 v[88:91], v[28:31], v[228:231], v[88:91]
    ds_read_b64_tr_b16 v[52:53], v5 offset:6144
    v_fma_f32 v17, v17, s38, s38
    v_mfma_f32_16x16x32_bf16 v[88:91], v[24:27], v[224:227], v[88:91]
    ds_read_b64_tr_b16 v[54:55], v5 offset:7168
    v_fma_f32 v18, v18, s38, s38
    v_mfma_f32_16x16x32_bf16 v[88:91], v[32:35], v[232:235], v[88:91]
    ds_read_b64_tr_b16 v[24:25], v6 offset:32768
    v_fma_f32 v19, v19, s38, s38
    v_mfma_f32_16x16x32_bf16 v[88:91], v[36:39], v[236:239], v[88:91]
    ds_read_b64_tr_b16 v[26:27], v6 offset:33792
    v_rcp_f32 v16, v16
    v_mfma_f32_16x16x32_bf16 v[72:75], v[36:39], v[172:175], v[72:75]
    ds_read_b64_tr_b16 v[28:29], v6 offset:34816
    v_rcp_f32 v17, v17
    v_mfma_f32_16x16x32_bf16 v[72:75], v[32:35], v[168:171], v[72:75]
    ds_read_b64_tr_b16 v[30:31], v6 offset:35840
    s_waitcnt lgkmcnt(4)
    v_mfma_f32_16x16x32_bf16 v[72:75], v[40:43], v[176:179], v[72:75]
    ds_read_b64_tr_b16 v[32:33], v6 offset:36864
    v_rcp_f32 v18, v18
    v_mfma_f32_16x16x32_bf16 v[72:75], v[44:47], v[180:183], v[72:75]
    ds_read_b64_tr_b16 v[34:35], v6 offset:37888
    v_mfma_f32_16x16x32_bf16 v[88:91], v[44:47], v[244:247], v[88:91]
    ds_read_b64_tr_b16 v[36:37], v6 offset:38912
    v_rcp_f32 v19, v19
    v_mfma_f32_16x16x32_bf16 v[88:91], v[40:43], v[240:243], v[88:91]
    ds_read_b64_tr_b16 v[38:39], v6 offset:39936
    v_mfma_f32_16x16x32_bf16 v[88:91], v[48:51], v[248:251], v[88:91]
    ds_read_b64_tr_b16 v[40:41], v6 offset:40960
    v_mul_f32 v80, v80, v16
    v_mfma_f32_16x16x32_bf16 v[88:91], v[52:55], v[252:255], v[88:91]
    ds_read_b64_tr_b16 v[42:43], v6 offset:41984
    v_mul_f32 v81, v81, v17
    v_mfma_f32_16x16x32_bf16 v[72:75], v[52:55], v[188:191], v[72:75]
    ds_read_b64_tr_b16 v[44:45], v6 offset:43008
    v_mul_f32 v82, v82, v18
    v_mfma_f32_16x16x32_bf16 v[72:75], v[48:51], v[184:187], v[72:75]
    ds_read_b64_tr_b16 v[46:47], v6 offset:44032
    v_mul_f32 v83, v83, v19
    s_waitcnt lgkmcnt(4)
    v_mfma_f32_16x16x32_bf16 v[76:79], v[24:27], v[128:131], 0
    ds_read_b64_tr_b16 v[48:49], v6 offset:45056
    v_exp_f32_e64 v12, -v68
    v_mfma_f32_16x16x32_bf16 v[76:79], v[28:31], v[132:135], v[76:79]
    ds_read_b64_tr_b16 v[50:51], v6 offset:46080
    v_mfma_f32_16x16x32_bf16 v[92:95], v[28:31], v[196:199], 0
    ds_read_b64_tr_b16 v[52:53], v6 offset:47104
    v_exp_f32_e64 v13, -v69
    v_mfma_f32_16x16x32_bf16 v[92:95], v[24:27], v[192:195], v[92:95]
    ds_read_b64_tr_b16 v[54:55], v6 offset:48128
    v_exp_f32_e64 v14, -v70
    v_mfma_f32_16x16x32_bf16 v[92:95], v[32:35], v[200:203], v[92:95]
    ds_read_b64_tr_b16 v[24:25], v6 offset:49152
    v_mfma_f32_16x16x32_bf16 v[92:95], v[36:39], v[204:207], v[92:95]
    ds_read_b64_tr_b16 v[26:27], v6 offset:50176
    v_exp_f32_e64 v15, -v71
    v_mfma_f32_16x16x32_bf16 v[76:79], v[36:39], v[140:143], v[76:79]
    ds_read_b64_tr_b16 v[28:29], v6 offset:51200
    v_mfma_f32_16x16x32_bf16 v[76:79], v[32:35], v[136:139], v[76:79]
    ds_read_b64_tr_b16 v[30:31], v6 offset:52224
    v_fma_f32 v12, v12, s38, s38
    s_waitcnt lgkmcnt(4)
    v_mfma_f32_16x16x32_bf16 v[76:79], v[40:43], v[144:147], v[76:79]
    ds_read_b64_tr_b16 v[32:33], v6 offset:53248
    v_fma_f32 v13, v13, s38, s38
    v_mfma_f32_16x16x32_bf16 v[76:79], v[44:47], v[148:151], v[76:79]
    ds_read_b64_tr_b16 v[34:35], v6 offset:54272
    v_fma_f32 v14, v14, s38, s38
    v_mfma_f32_16x16x32_bf16 v[92:95], v[44:47], v[212:215], v[92:95]
    ds_read_b64_tr_b16 v[36:37], v6 offset:55296
    v_fma_f32 v15, v15, s38, s38
    v_mfma_f32_16x16x32_bf16 v[92:95], v[40:43], v[208:211], v[92:95]
    ds_read_b64_tr_b16 v[38:39], v6 offset:56320
    v_rcp_f32 v12, v12
    v_mfma_f32_16x16x32_bf16 v[92:95], v[48:51], v[216:219], v[92:95]
    v_add_u32 v6, 0xfffe6000, v6
    ds_read_b64_tr_b16 v[40:41], v6 offset:0
    s_add_u32 s81, s79, 0
    s_waitcnt vmcnt(0)
    buffer_store_dword v10, v11, s[64:67], s81 offen sc1
    v_mfma_f32_16x16x32_bf16 v[92:95], v[52:55], v[220:223], v[92:95]
    ds_read_b64_tr_b16 v[42:43], v6 offset:1024
    v_rcp_f32 v13, v13
    v_mfma_f32_16x16x32_bf16 v[76:79], v[52:55], v[156:159], v[76:79]
    ds_read_b64_tr_b16 v[44:45], v6 offset:2048
    v_mfma_f32_16x16x32_bf16 v[76:79], v[48:51], v[152:155], v[76:79]
    ds_read_b64_tr_b16 v[46:47], v6 offset:3072
    v_rcp_f32 v14, v14
    s_waitcnt lgkmcnt(4)
    v_mfma_f32_16x16x32_bf16 v[76:79], v[24:27], v[160:163], v[76:79]
    ds_read_b64_tr_b16 v[48:49], v6 offset:4096
    v_mfma_f32_16x16x32_bf16 v[76:79], v[28:31], v[164:167], v[76:79]
    ds_read_b64_tr_b16 v[50:51], v6 offset:5120
    v_rcp_f32 v15, v15
    v_mfma_f32_16x16x32_bf16 v[92:95], v[28:31], v[228:231], v[92:95]
    ds_read_b64_tr_b16 v[52:53], v6 offset:6144
    v_mfma_f32_16x16x32_bf16 v[92:95], v[24:27], v[224:227], v[92:95]
    ds_read_b64_tr_b16 v[54:55], v6 offset:7168
    v_mul_f32 v68, v68, v12
    v_mfma_f32_16x16x32_bf16 v[92:95], v[32:35], v[232:235], v[92:95]
    v_add_u32 v1, 0xffff2000, v1
    ds_read_b64_tr_b16 v[24:25], v1 offset:0
    v_mul_f32 v69, v69, v13
    v_mfma_f32_16x16x32_bf16 v[92:95], v[36:39], v[236:239], v[92:95]
    ds_read_b64_tr_b16 v[26:27], v1 offset:2048
    v_mul_f32 v70, v70, v14
    v_mfma_f32_16x16x32_bf16 v[76:79], v[36:39], v[172:175], v[76:79]
    ds_read_b64_tr_b16 v[28:29], v1 offset:4096
    v_mul_f32 v71, v71, v15
    v_mfma_f32_16x16x32_bf16 v[76:79], v[32:35], v[168:171], v[76:79]
    ds_read_b64_tr_b16 v[30:31], v1 offset:6144
    v_exp_f32_e64 v16, -v84
    s_waitcnt lgkmcnt(4)
    v_mfma_f32_16x16x32_bf16 v[76:79], v[40:43], v[176:179], v[76:79]
    ds_read_b64_tr_b16 v[32:33], v1 offset:8192
    v_mfma_f32_16x16x32_bf16 v[76:79], v[44:47], v[180:183], v[76:79]
    ds_read_b64_tr_b16 v[34:35], v1 offset:10240
    v_exp_f32_e64 v17, -v85
    v_mfma_f32_16x16x32_bf16 v[92:95], v[44:47], v[244:247], v[92:95]
    ds_read_b64_tr_b16 v[36:37], v1 offset:12288
    v_exp_f32_e64 v18, -v86
    v_mfma_f32_16x16x32_bf16 v[92:95], v[40:43], v[240:243], v[92:95]
    ds_read_b64_tr_b16 v[38:39], v1 offset:14336
    v_mfma_f32_16x16x32_bf16 v[92:95], v[48:51], v[248:251], v[92:95]
    s_barrier
    ds_read_b64_tr_b16 v[40:41], v1 offset:16384
    v_exp_f32_e64 v19, -v87
    v_mfma_f32_16x16x32_bf16 v[92:95], v[52:55], v[252:255], v[92:95]
    ds_read_b64_tr_b16 v[42:43], v1 offset:18432
    v_mfma_f32_16x16x32_bf16 v[76:79], v[52:55], v[188:191], v[76:79]
    ds_read_b64_tr_b16 v[44:45], v1 offset:20480
    v_fma_f32 v16, v16, s38, s38
    v_mfma_f32_16x16x32_bf16 v[76:79], v[48:51], v[184:187], v[76:79]
    ds_read_b64_tr_b16 v[46:47], v1 offset:22528
    v_fma_f32 v17, v17, s38, s38
    s_waitcnt lgkmcnt(4)
    v_mfma_f32_16x16x32_bf16 v[96:99], v[24:27], v[128:131], 0
    ds_read_b64_tr_b16 v[48:49], v1 offset:24576
    v_fma_f32 v18, v18, s38, s38
    v_mfma_f32_16x16x32_bf16 v[96:99], v[28:31], v[132:135], v[96:99]
    ds_read_b64_tr_b16 v[50:51], v1 offset:26624
    v_fma_f32 v19, v19, s38, s38
    v_mfma_f32_16x16x32_bf16 v[112:115], v[28:31], v[196:199], 0
    ds_read_b64_tr_b16 v[52:53], v1 offset:28672
    v_rcp_f32 v16, v16
    v_mfma_f32_16x16x32_bf16 v[112:115], v[24:27], v[192:195], v[112:115]
    ds_read_b64_tr_b16 v[54:55], v1 offset:30720
    v_mfma_f32_16x16x32_bf16 v[112:115], v[32:35], v[200:203], v[112:115]
    v_add_u32 v2, 0xffff2000, v2
    ds_read_b64_tr_b16 v[24:25], v2 offset:0
    v_rcp_f32 v17, v17
    v_mfma_f32_16x16x32_bf16 v[112:115], v[36:39], v[204:207], v[112:115]
    ds_read_b64_tr_b16 v[26:27], v2 offset:2048
    v_mfma_f32_16x16x32_bf16 v[96:99], v[36:39], v[140:143], v[96:99]
    ds_read_b64_tr_b16 v[28:29], v2 offset:4096
    v_rcp_f32 v18, v18
    v_mfma_f32_16x16x32_bf16 v[96:99], v[32:35], v[136:139], v[96:99]
    ds_read_b64_tr_b16 v[30:31], v2 offset:6144
    v_rcp_f32 v19, v19
    s_waitcnt lgkmcnt(4)
    v_mfma_f32_16x16x32_bf16 v[96:99], v[40:43], v[144:147], v[96:99]
    ds_read_b64_tr_b16 v[32:33], v2 offset:8192
    v_mfma_f32_16x16x32_bf16 v[96:99], v[44:47], v[148:151], v[96:99]
    ds_read_b64_tr_b16 v[34:35], v2 offset:10240
    v_mul_f32 v84, v84, v16
    v_mfma_f32_16x16x32_bf16 v[112:115], v[44:47], v[212:215], v[112:115]
    ds_read_b64_tr_b16 v[36:37], v2 offset:12288
    v_mul_f32 v85, v85, v17
    v_mfma_f32_16x16x32_bf16 v[112:115], v[40:43], v[208:211], v[112:115]
    ds_read_b64_tr_b16 v[38:39], v2 offset:14336
    v_mul_f32 v86, v86, v18
    v_mfma_f32_16x16x32_bf16 v[112:115], v[48:51], v[216:219], v[112:115]
    ds_read_b64_tr_b16 v[40:41], v2 offset:16384
    v_mul_f32 v87, v87, v19
    v_mfma_f32_16x16x32_bf16 v[112:115], v[52:55], v[220:223], v[112:115]
    ds_read_b64_tr_b16 v[42:43], v2 offset:18432
    v_mul_f32 v64, v64, v72
    v_mfma_f32_16x16x32_bf16 v[96:99], v[52:55], v[156:159], v[96:99]
    ds_read_b64_tr_b16 v[44:45], v2 offset:20480
    v_mul_f32 v65, v65, v73
    v_mfma_f32_16x16x32_bf16 v[96:99], v[48:51], v[152:155], v[96:99]
    ds_read_b64_tr_b16 v[46:47], v2 offset:22528
    v_mul_f32 v66, v66, v74
    s_waitcnt lgkmcnt(4)
    v_mfma_f32_16x16x32_bf16 v[100:103], v[24:27], v[128:131], 0
    ds_read_b64_tr_b16 v[48:49], v2 offset:24576
    v_mul_f32 v67, v67, v75
    v_mfma_f32_16x16x32_bf16 v[100:103], v[28:31], v[132:135], v[100:103]
    ds_read_b64_tr_b16 v[50:51], v2 offset:26624
    v_mul_f32 v68, v68, v76
    v_mfma_f32_16x16x32_bf16 v[116:119], v[28:31], v[196:199], 0
    ds_read_b64_tr_b16 v[52:53], v2 offset:28672
    v_mul_f32 v69, v69, v77
    v_mfma_f32_16x16x32_bf16 v[116:119], v[24:27], v[192:195], v[116:119]
    ds_read_b64_tr_b16 v[54:55], v2 offset:30720
    v_mul_f32 v70, v70, v78
    v_mfma_f32_16x16x32_bf16 v[116:119], v[32:35], v[200:203], v[116:119]
    v_add_u32 v3, 0xffff2000, v3
    ds_read_b64_tr_b16 v[24:25], v3 offset:0
    v_mul_f32 v71, v71, v79
    v_mul_f32 v80, v80, v88
    v_mfma_f32_16x16x32_bf16 v[116:119], v[36:39], v[204:207], v[116:119]
    ds_read_b64_tr_b16 v[26:27], v3 offset:2048
    v_mul_f32 v81, v81, v89
    v_mfma_f32_16x16x32_bf16 v[100:103], v[36:39], v[140:143], v[100:103]
    ds_read_b64_tr_b16 v[28:29], v3 offset:4096
    v_mul_f32 v82, v82, v90
    v_mfma_f32_16x16x32_bf16 v[100:103], v[32:35], v[136:139], v[100:103]
    ds_read_b64_tr_b16 v[30:31], v3 offset:6144
    v_mul_f32 v83, v83, v91
    s_waitcnt lgkmcnt(4)
    v_mfma_f32_16x16x32_bf16 v[100:103], v[40:43], v[144:147], v[100:103]
    ds_read_b64_tr_b16 v[32:33], v3 offset:8192
    v_mul_f32 v84, v84, v92
    v_mfma_f32_16x16x32_bf16 v[100:103], v[44:47], v[148:151], v[100:103]
    ds_read_b64_tr_b16 v[34:35], v3 offset:10240
    v_mul_f32 v85, v85, v93
    v_mfma_f32_16x16x32_bf16 v[116:119], v[44:47], v[212:215], v[116:119]
    ds_read_b64_tr_b16 v[36:37], v3 offset:12288
    v_mul_f32 v86, v86, v94
    v_mfma_f32_16x16x32_bf16 v[116:119], v[40:43], v[208:211], v[116:119]
    ds_read_b64_tr_b16 v[38:39], v3 offset:14336
    v_mul_f32 v87, v87, v95
    v_mfma_f32_16x16x32_bf16 v[116:119], v[48:51], v[216:219], v[116:119]
    ds_read_b64_tr_b16 v[40:41], v3 offset:16384
    v_cvt_pk_bf16_f32 v64, v64, v65
    v_mfma_f32_16x16x32_bf16 v[116:119], v[52:55], v[220:223], v[116:119]
    ds_read_b64_tr_b16 v[42:43], v3 offset:18432
    v_cvt_pk_bf16_f32 v65, v66, v67
    v_mfma_f32_16x16x32_bf16 v[100:103], v[52:55], v[156:159], v[100:103]
    ds_read_b64_tr_b16 v[44:45], v3 offset:20480
    v_cvt_pk_bf16_f32 v66, v68, v69
    v_mfma_f32_16x16x32_bf16 v[100:103], v[48:51], v[152:155], v[100:103]
    ds_read_b64_tr_b16 v[46:47], v3 offset:22528
    v_cvt_pk_bf16_f32 v67, v70, v71
    s_waitcnt lgkmcnt(4)
    v_mfma_f32_16x16x32_bf16 v[104:107], v[24:27], v[128:131], 0
    ds_read_b64_tr_b16 v[48:49], v3 offset:24576
    buffer_store_dwordx4 v[64:67], v7, s[64:67], s100 offen offset:0 sc1
    v_mfma_f32_16x16x32_bf16 v[104:107], v[28:31], v[132:135], v[104:107]
    ds_read_b64_tr_b16 v[50:51], v3 offset:26624
    v_cvt_pk_bf16_f32 v80, v80, v81
    v_cvt_pk_bf16_f32 v81, v82, v83
    v_mfma_f32_16x16x32_bf16 v[120:123], v[28:31], v[196:199], 0
    ds_read_b64_tr_b16 v[52:53], v3 offset:28672
    v_cvt_pk_bf16_f32 v82, v84, v85
    v_mfma_f32_16x16x32_bf16 v[120:123], v[24:27], v[192:195], v[120:123]
    ds_read_b64_tr_b16 v[54:55], v3 offset:30720
    v_cvt_pk_bf16_f32 v83, v86, v87
    v_mfma_f32_16x16x32_bf16 v[120:123], v[32:35], v[200:203], v[120:123]
    v_add_u32 v4, 0xffff2000, v4
    ds_read_b64_tr_b16 v[24:25], v4 offset:0
    buffer_store_dwordx4 v[80:83], v7, s[64:67], s100 offen offset:1024 sc1
    v_mfma_f32_16x16x32_bf16 v[120:123], v[36:39], v[204:207], v[120:123]
    ds_read_b64_tr_b16 v[26:27], v4 offset:2048
    v_bfe_u32 v9, v0, 4, 1
    v_mfma_f32_16x16x32_bf16 v[104:107], v[36:39], v[140:143], v[104:107]
    ds_read_b64_tr_b16 v[28:29], v4 offset:4096
    v_lshrrev_b32 v8, 5, v0
    v_mfma_f32_16x16x32_bf16 v[104:107], v[32:35], v[136:139], v[104:107]
    ds_read_b64_tr_b16 v[30:31], v4 offset:6144
    v_lshl_add_u32 v8, v9, 1, v8
    s_waitcnt lgkmcnt(4)
    v_mfma_f32_16x16x32_bf16 v[104:107], v[40:43], v[144:147], v[104:107]
    ds_read_b64_tr_b16 v[32:33], v4 offset:8192
    v_lshlrev_b32 v8, 4, v8
    v_mfma_f32_16x16x32_bf16 v[104:107], v[44:47], v[148:151], v[104:107]
    ds_read_b64_tr_b16 v[34:35], v4 offset:10240
    v_and_b32 v9, 15, v0
    v_mfma_f32_16x16x32_bf16 v[120:123], v[44:47], v[212:215], v[120:123]
    ds_read_b64_tr_b16 v[36:37], v4 offset:12288
    v_lshl_add_u32 v8, v9, 10, v8
    v_mfma_f32_16x16x32_bf16 v[120:123], v[40:43], v[208:211], v[120:123]
    ds_read_b64_tr_b16 v[38:39], v4 offset:14336
    v_lshrrev_b32 v9, 5, v0
    v_mfma_f32_16x16x32_bf16 v[120:123], v[48:51], v[216:219], v[120:123]
    ds_read_b64_tr_b16 v[40:41], v4 offset:16384
    v_bfe_u32 v20, v0, 4, 1
    v_mfma_f32_16x16x32_bf16 v[120:123], v[52:55], v[220:223], v[120:123]
    ds_read_b64_tr_b16 v[42:43], v4 offset:18432
    v_sub_u32 v9, v9, v20
    v_mfma_f32_16x16x32_bf16 v[104:107], v[52:55], v[156:159], v[104:107]
    ds_read_b64_tr_b16 v[44:45], v4 offset:20480
    v_lshlrev_b32 v9, 9, v9
    s_and_b32 s96, s3, 2
    v_mfma_f32_16x16x32_bf16 v[104:107], v[48:51], v[152:155], v[104:107]
    ds_read_b64_tr_b16 v[46:47], v4 offset:22528
    s_add_u32 s96, s96, s3
    s_waitcnt lgkmcnt(4)
    v_mfma_f32_16x16x32_bf16 v[108:111], v[24:27], v[128:131], 0
    ds_read_b64_tr_b16 v[48:49], v4 offset:24576
    v_lshl_add_u32 v21, s96, 10, v7
    v_mfma_f32_16x16x32_bf16 v[108:111], v[28:31], v[132:135], v[108:111]
    ds_read_b64_tr_b16 v[50:51], v4 offset:26624
    buffer_load_dwordx4 v[56:59], v8, s[40:43], s99 offen offset:0
    v_mfma_f32_16x16x32_bf16 v[124:127], v[28:31], v[196:199], 0
    ds_read_b64_tr_b16 v[52:53], v4 offset:28672
    buffer_load_dwordx4 v[60:63], v8, s[40:43], s99 offen offset:64
    v_mfma_f32_16x16x32_bf16 v[124:127], v[24:27], v[192:195], v[124:127]
    ds_read_b64_tr_b16 v[54:55], v4 offset:30720
    s_add_u32 s88, s44, 65536
    v_mfma_f32_16x16x32_bf16 v[124:127], v[32:35], v[200:203], v[124:127]
    s_branch L_pg5173x
L_pg5173:
    s_setpc_b64 s[30:31]
L_pg5173x:
    ds_read_b64_tr_b16 v[24:25], v1 offset:32768
    v_mfma_f32_16x16x32_bf16 v[124:127], v[36:39], v[204:207], v[124:127]
    ds_read_b64_tr_b16 v[26:27], v1 offset:34816
    v_mfma_f32_16x16x32_bf16 v[108:111], v[36:39], v[140:143], v[108:111]
    ds_read_b64_tr_b16 v[28:29], v1 offset:36864
    v_mfma_f32_16x16x32_bf16 v[108:111], v[32:35], v[136:139], v[108:111]
    ds_read_b64_tr_b16 v[30:31], v1 offset:38912
    s_waitcnt lgkmcnt(4)
    v_mfma_f32_16x16x32_bf16 v[108:111], v[40:43], v[144:147], v[108:111]
    ds_read_b64_tr_b16 v[32:33], v1 offset:40960
    v_mfma_f32_16x16x32_bf16 v[108:111], v[44:47], v[148:151], v[108:111]
    ds_read_b64_tr_b16 v[34:35], v1 offset:43008
    v_mfma_f32_16x16x32_bf16 v[124:127], v[44:47], v[212:215], v[124:127]
    ds_read_b64_tr_b16 v[36:37], v1 offset:45056
    v_mfma_f32_16x16x32_bf16 v[124:127], v[40:43], v[208:211], v[124:127]
    ds_read_b64_tr_b16 v[38:39], v1 offset:47104
    v_mfma_f32_16x16x32_bf16 v[124:127], v[48:51], v[216:219], v[124:127]
    s_barrier
    ds_read_b64_tr_b16 v[40:41], v1 offset:49152
    v_mfma_f32_16x16x32_bf16 v[124:127], v[52:55], v[220:223], v[124:127]
    ds_read_b64_tr_b16 v[42:43], v1 offset:51200
    v_mfma_f32_16x16x32_bf16 v[108:111], v[52:55], v[156:159], v[108:111]
    ds_read_b64_tr_b16 v[44:45], v1 offset:53248
    v_mfma_f32_16x16x32_bf16 v[108:111], v[48:51], v[152:155], v[108:111]
    ds_read_b64_tr_b16 v[46:47], v1 offset:55296
    s_waitcnt lgkmcnt(4)
    v_mfma_f32_16x16x32_bf16 v[96:99], v[24:27], v[160:163], v[96:99]
    ds_read_b64_tr_b16 v[48:49], v1 offset:57344
    v_mfma_f32_16x16x32_bf16 v[96:99], v[28:31], v[164:167], v[96:99]
    ds_read_b64_tr_b16 v[50:51], v1 offset:59392
    v_mfma_f32_16x16x32_bf16 v[112:115], v[28:31], v[228:231], v[112:115]
    ds_read_b64_tr_b16 v[52:53], v1 offset:61440
    v_mfma_f32_16x16x32_bf16 v[112:115], v[24:27], v[224:227], v[112:115]
    ds_read_b64_tr_b16 v[54:55], v1 offset:63488
    v_mfma_f32_16x16x32_bf16 v[112:115], v[32:35], v[232:235], v[112:115]
    ds_read_b64_tr_b16 v[24:25], v2 offset:32768
    v_mfma_f32_16x16x32_bf16 v[112:115], v[36:39], v[236:239], v[112:115]
    ds_read_b64_tr_b16 v[26:27], v2 offset:34816
    v_mfma_f32_16x16x32_bf16 v[96:99], v[36:39], v[172:175], v[96:99]
    ds_read_b64_tr_b16 v[28:29], v2 offset:36864
    v_mfma_f32_16x16x32_bf16 v[96:99], v[32:35], v[168:171], v[96:99]
    ds_read_b64_tr_b16 v[30:31], v2 offset:38912
    s_waitcnt lgkmcnt(4)
    v_mfma_f32_16x16x32_bf16 v[96:99], v[40:43], v[176:179], v[96:99]
    ds_read_b64_tr_b16 v[32:33], v2 offset:40960
    v_mfma_f32_16x16x32_bf16 v[96:99], v[44:47], v[180:183], v[96:99]
    ds_read_b64_tr_b16 v[34:35], v2 offset:43008
    v_mfma_f32_16x16x32_bf16 v[112:115], v[44:47], v[244:247], v[112:115]
    ds_read_b64_tr_b16 v[36:37], v2 offset:45056
    v_mfma_f32_16x16x32_bf16 v[112:115], v[40:43], v[240:243], v[112:115]
    ds_read_b64_tr_b16 v[38:39], v2 offset:47104
    v_mfma_f32_16x16x32_bf16 v[112:115], v[48:51], v[248:251], v[112:115]
    ds_read_b64_tr_b16 v[40:41], v2 offset:49152
    v_mfma_f32_16x16x32_bf16 v[112:115], v[52:55], v[252:255], v[112:115]
    ds_read_b64_tr_b16 v[42:43], v2 offset:51200
    v_mfma_f32_16x16x32_bf16 v[96:99], v[52:55], v[188:191], v[96:99]
    ds_read_b64_tr_b16 v[44:45], v2 offset:53248
    v_mfma_f32_16x16x32_bf16 v[96:99], v[48:51], v[184:187], v[96:99]
    ds_read_b64_tr_b16 v[46:47], v2 offset:55296
    s_waitcnt lgkmcnt(4)
    v_mfma_f32_16x16x32_bf16 v[100:103], v[24:27], v[160:163], v[100:103]
    ds_read_b64_tr_b16 v[48:49], v2 offset:57344
    v_mfma_f32_16x16x32_bf16 v[100:103], v[28:31], v[164:167], v[100:103]
    ds_read_b64_tr_b16 v[50:51], v2 offset:59392
    v_mfma_f32_16x16x32_bf16 v[116:119], v[28:31], v[228:231], v[116:119]
    ds_read_b64_tr_b16 v[52:53], v2 offset:61440
    v_mfma_f32_16x16x32_bf16 v[116:119], v[24:27], v[224:227], v[116:119]
    ds_read_b64_tr_b16 v[54:55], v2 offset:63488
    v_mfma_f32_16x16x32_bf16 v[116:119], v[32:35], v[232:235], v[116:119]
    ds_read_b64_tr_b16 v[24:25], v3 offset:32768
    v_exp_f32_e64 v12, -v96
    v_exp_f32_e64 v13, -v97
    v_mfma_f32_16x16x32_bf16 v[116:119], v[36:39], v[236:239], v[116:119]
    ds_read_b64_tr_b16 v[26:27], v3 offset:34816
    v_mfma_f32_16x16x32_bf16 v[100:103], v[36:39], v[172:175], v[100:103]
    ds_read_b64_tr_b16 v[28:29], v3 offset:36864
    v_exp_f32_e64 v14, -v98
    v_mfma_f32_16x16x32_bf16 v[100:103], v[32:35], v[168:171], v[100:103]
    ds_read_b64_tr_b16 v[30:31], v3 offset:38912
    v_exp_f32_e64 v15, -v99
    s_waitcnt lgkmcnt(4)
    v_mfma_f32_16x16x32_bf16 v[100:103], v[40:43], v[176:179], v[100:103]
    ds_read_b64_tr_b16 v[32:33], v3 offset:40960
    v_mfma_f32_16x16x32_bf16 v[100:103], v[44:47], v[180:183], v[100:103]
    ds_read_b64_tr_b16 v[34:35], v3 offset:43008
    v_fma_f32 v12, v12, s38, s38
    v_mfma_f32_16x16x32_bf16 v[116:119], v[44:47], v[244:247], v[116:119]
    ds_read_b64_tr_b16 v[36:37], v3 offset:45056
    v_fma_f32 v13, v13, s38, s38
    v_mfma_f32_16x16x32_bf16 v[116:119], v[40:43], v[240:243], v[116:119]
    ds_read_b64_tr_b16 v[38:39], v3 offset:47104
    v_fma_f32 v14, v14, s38, s38
    v_fma_f32 v15, v15, s38, s38
    v_mfma_f32_16x16x32_bf16 v[116:119], v[48:51], v[248:251], v[116:119]
    ds_read_b64_tr_b16 v[40:41], v3 offset:49152
    v_rcp_f32 v12, v12
    v_mfma_f32_16x16x32_bf16 v[116:119], v[52:55], v[252:255], v[116:119]
    ds_read_b64_tr_b16 v[42:43], v3 offset:51200
    v_mfma_f32_16x16x32_bf16 v[100:103], v[52:55], v[188:191], v[100:103]
    ds_read_b64_tr_b16 v[44:45], v3 offset:53248
    v_rcp_f32 v13, v13
    v_mfma_f32_16x16x32_bf16 v[100:103], v[48:51], v[184:187], v[100:103]
    ds_read_b64_tr_b16 v[46:47], v3 offset:55296
    v_rcp_f32 v14, v14
    s_waitcnt lgkmcnt(4)
    v_mfma_f32_16x16x32_bf16 v[104:107], v[24:27], v[160:163], v[104:107]
    ds_read_b64_tr_b16 v[48:49], v3 offset:57344
    v_mfma_f32_16x16x32_bf16 v[104:107], v[28:31], v[164:167], v[104:107]
    ds_read_b64_tr_b16 v[50:51], v3 offset:59392
    v_rcp_f32 v15, v15
    v_mfma_f32_16x16x32_bf16 v[120:123], v[28:31], v[228:231], v[120:123]
    ds_read_b64_tr_b16 v[52:53], v3 offset:61440
    v_mul_f32 v96, v96, v12
    v_mfma_f32_16x16x32_bf16 v[120:123], v[24:27], v[224:227], v[120:123]
    ds_read_b64_tr_b16 v[54:55], v3 offset:63488
    v_mul_f32 v97, v97, v13
    v_mfma_f32_16x16x32_bf16 v[120:123], v[32:35], v[232:235], v[120:123]
    ds_read_b64_tr_b16 v[24:25], v4 offset:32768
    v_mul_f32 v98, v98, v14
    v_mfma_f32_16x16x32_bf16 v[120:123], v[36:39], v[236:239], v[120:123]
    ds_read_b64_tr_b16 v[26:27], v4 offset:34816
    v_mul_f32 v99, v99, v15
    v_mfma_f32_16x16x32_bf16 v[104:107], v[36:39], v[172:175], v[104:107]
    ds_read_b64_tr_b16 v[28:29], v4 offset:36864
    s_waitcnt vmcnt(2)
    buffer_store_dword v10, v11, s[64:67], s101 offen sc1
    v_exp_f32_e64 v16, -v112
    v_mfma_f32_16x16x32_bf16 v[104:107], v[32:35], v[168:171], v[104:107]
    ds_read_b64_tr_b16 v[30:31], v4 offset:38912
    s_waitcnt lgkmcnt(4)
    v_mfma_f32_16x16x32_bf16 v[104:107], v[40:43], v[176:179], v[104:107]
    ds_read_b64_tr_b16 v[32:33], v4 offset:40960
    v_exp_f32_e64 v17, -v113
    v_mfma_f32_16x16x32_bf16 v[104:107], v[44:47], v[180:183], v[104:107]
    ds_read_b64_tr_b16 v[34:35], v4 offset:43008
    v_exp_f32_e64 v18, -v114
    v_mfma_f32_16x16x32_bf16 v[120:123], v[44:47], v[244:247], v[120:123]
    ds_read_b64_tr_b16 v[36:37], v4 offset:45056
    v_mfma_f32_16x16x32_bf16 v[120:123], v[40:43], v[240:243], v[120:123]
    ds_read_b64_tr_b16 v[38:39], v4 offset:47104
    v_exp_f32_e64 v19, -v115
    v_mfma_f32_16x16x32_bf16 v[120:123], v[48:51], v[248:251], v[120:123]
    ds_read_b64_tr_b16 v[40:41], v4 offset:49152
    v_fma_f32 v16, v16, s38, s38
    v_mfma_f32_16x16x32_bf16 v[120:123], v[52:55], v[252:255], v[120:123]
    ds_read_b64_tr_b16 v[42:43], v4 offset:51200
    v_fma_f32 v17, v17, s38, s38
    v_mfma_f32_16x16x32_bf16 v[104:107], v[52:55], v[188:191], v[104:107]
    ds_read_b64_tr_b16 v[44:45], v4 offset:53248
    v_fma_f32 v18, v18, s38, s38
    v_mfma_f32_16x16x32_bf16 v[104:107], v[48:51], v[184:187], v[104:107]
    ds_read_b64_tr_b16 v[46:47], v4 offset:55296
    v_fma_f32 v19, v19, s38, s38
    s_waitcnt lgkmcnt(4)
    v_mfma_f32_16x16x32_bf16 v[108:111], v[24:27], v[160:163], v[108:111]
    ds_read_b64_tr_b16 v[48:49], v4 offset:57344
    v_rcp_f32 v16, v16
    v_mfma_f32_16x16x32_bf16 v[108:111], v[28:31], v[164:167], v[108:111]
    ds_read_b64_tr_b16 v[50:51], v4 offset:59392
    v_rcp_f32 v17, v17
    v_mfma_f32_16x16x32_bf16 v[124:127], v[28:31], v[228:231], v[124:127]
    ds_read_b64_tr_b16 v[52:53], v4 offset:61440
    v_mfma_f32_16x16x32_bf16 v[124:127], v[24:27], v[224:227], v[124:127]
    ds_read_b64_tr_b16 v[54:55], v4 offset:63488
    v_rcp_f32 v18, v18
    v_mfma_f32_16x16x32_bf16 v[124:127], v[32:35], v[232:235], v[124:127]
    v_add_u32 v1, 0x10000, v1
    ds_read_b64_tr_b16 v[24:25], v1 offset:0
    v_rcp_f32 v19, v19
    v_mfma_f32_16x16x32_bf16 v[124:127], v[36:39], v[236:239], v[124:127]
    ds_read_b64_tr_b16 v[26:27], v1 offset:2048
    v_mfma_f32_16x16x32_bf16 v[108:111], v[36:39], v[172:175], v[108:111]
    ds_read_b64_tr_b16 v[28:29], v1 offset:4096
    v_mul_f32 v112, v112, v16
    v_mfma_f32_16x16x32_bf16 v[108:111], v[32:35], v[168:171], v[108:111]
    ds_read_b64_tr_b16 v[30:31], v1 offset:6144
    v_mul_f32 v113, v113, v17
    v_mul_f32 v114, v114, v18
    s_waitcnt lgkmcnt(4)
    v_mfma_f32_16x16x32_bf16 v[108:111], v[40:43], v[176:179], v[108:111]
    ds_read_b64_tr_b16 v[32:33], v1 offset:8192
    v_mul_f32 v115, v115, v19
    v_mfma_f32_16x16x32_bf16 v[108:111], v[44:47], v[180:183], v[108:111]
    ds_read_b64_tr_b16 v[34:35], v1 offset:10240
    v_exp_f32_e64 v12, -v100
    v_mfma_f32_16x16x32_bf16 v[124:127], v[44:47], v[244:247], v[124:127]
    ds_read_b64_tr_b16 v[36:37], v1 offset:12288
    v_mfma_f32_16x16x32_bf16 v[124:127], v[40:43], v[240:243], v[124:127]
    ds_read_b64_tr_b16 v[38:39], v1 offset:14336
    v_exp_f32_e64 v13, -v101
    v_mfma_f32_16x16x32_bf16 v[124:127], v[48:51], v[248:251], v[124:127]
    s_barrier
    ds_read_b64_tr_b16 v[40:41], v1 offset:16384
    v_exp_f32_e64 v14, -v102
    v_mfma_f32_16x16x32_bf16 v[124:127], v[52:55], v[252:255], v[124:127]
    ds_read_b64_tr_b16 v[42:43], v1 offset:18432
    v_mfma_f32_16x16x32_bf16 v[108:111], v[52:55], v[188:191], v[108:111]
    ds_read_b64_tr_b16 v[44:45], v1 offset:20480
    v_exp_f32_e64 v15, -v103
    v_mfma_f32_16x16x32_bf16 v[108:111], v[48:51], v[184:187], v[108:111]
    ds_read_b64_tr_b16 v[46:47], v1 offset:22528
    v_fma_f32 v12, v12, s38, s38
    s_waitcnt lgkmcnt(4)
    v_mfma_f32_16x16x32_bf16 v[64:67], v[24:27], v[128:131], 0
    ds_read_b64_tr_b16 v[48:49], v1 offset:24576
    v_fma_f32 v13, v13, s38, s38
    v_mfma_f32_16x16x32_bf16 v[64:67], v[28:31], v[132:135], v[64:67]
    ds_read_b64_tr_b16 v[50:51], v1 offset:26624
    v_fma_f32 v14, v14, s38, s38
    v_mfma_f32_16x16x32_bf16 v[80:83], v[28:31], v[196:199], 0
    ds_read_b64_tr_b16 v[52:53], v1 offset:28672
    v_fma_f32 v15, v15, s38, s38
    v_rcp_f32 v12, v12
    v_mfma_f32_16x16x32_bf16 v[80:83], v[24:27], v[192:195], v[80:83]
    ds_read_b64_tr_b16 v[54:55], v1 offset:30720
    v_mfma_f32_16x16x32_bf16 v[80:83], v[32:35], v[200:203], v[80:83]
    v_add_u32 v2, 0x10000, v2
    ds_read_b64_tr_b16 v[24:25], v2 offset:0
    v_rcp_f32 v13, v13
    v_mfma_f32_16x16x32_bf16 v[80:83], v[36:39], v[204:207], v[80:83]
    ds_read_b64_tr_b16 v[26:27], v2 offset:2048
    v_mfma_f32_16x16x32_bf16 v[64:67], v[36:39], v[140:143], v[64:67]
    ds_read_b64_tr_b16 v[28:29], v2 offset:4096
    v_rcp_f32 v14, v14
    v_mfma_f32_16x16x32_bf16 v[64:67], v[32:35], v[136:139], v[64:67]
    ds_read_b64_tr_b16 v[30:31], v2 offset:6144
    v_rcp_f32 v15, v15
    s_waitcnt lgkmcnt(4)
    v_mfma_f32_16x16x32_bf16 v[64:67], v[40:43], v[144:147], v[64:67]
    ds_read_b64_tr_b16 v[32:33], v2 offset:8192
    v_mfma_f32_16x16x32_bf16 v[64:67], v[44:47], v[148:151], v[64:67]
    ds_read_b64_tr_b16 v[34:35], v2 offset:10240
    v_mul_f32 v100, v100, v12
    v_mfma_f32_16x16x32_bf16 v[80:83], v[44:47], v[212:215], v[80:83]
    ds_read_b64_tr_b16 v[36:37], v2 offset:12288
    v_mul_f32 v101, v101, v13
    v_mul_f32 v102, v102, v14
    v_mfma_f32_16x16x32_bf16 v[80:83], v[40:43], v[208:211], v[80:83]
    ds_read_b64_tr_b16 v[38:39], v2 offset:14336
    v_mul_f32 v103, v103, v15
    v_mfma_f32_16x16x32_bf16 v[80:83], v[48:51], v[216:219], v[80:83]
    ds_read_b64_tr_b16 v[40:41], v2 offset:16384
    v_exp_f32_e64 v16, -v116
    v_mfma_f32_16x16x32_bf16 v[80:83], v[52:55], v[220:223], v[80:83]
    ds_read_b64_tr_b16 v[42:43], v2 offset:18432
    v_exp_f32_e64 v17, -v117
    v_mfma_f32_16x16x32_bf16 v[64:67], v[52:55], v[156:159], v[64:67]
    ds_read_b64_tr_b16 v[44:45], v2 offset:20480
    v_mfma_f32_16x16x32_bf16 v[64:67], v[48:51], v[152:155], v[64:67]
    ds_read_b64_tr_b16 v[46:47], v2 offset:22528
    v_exp_f32_e64 v18, -v118
    s_waitcnt lgkmcnt(4)
    v_mfma_f32_16x16x32_bf16 v[68:71], v[24:27], v[128:131], 0
    ds_read_b64_tr_b16 v[48:49], v2 offset:24576
    v_mfma_f32_16x16x32_bf16 v[68:71], v[28:31], v[132:135], v[68:71]
    ds_read_b64_tr_b16 v[50:51], v2 offset:26624
    v_exp_f32_e64 v19, -v119
    v_mfma_f32_16x16x32_bf16 v[84:87], v[28:31], v[196:199], 0
    ds_read_b64_tr_b16 v[52:53], v2 offset:28672
    v_fma_f32 v16, v16, s38, s38
    v_mfma_f32_16x16x32_bf16 v[84:87], v[24:27], v[192:195], v[84:87]
    ds_read_b64_tr_b16 v[54:55], v2 offset:30720
    v_fma_f32 v17, v17, s38, s38
    v_mfma_f32_16x16x32_bf16 v[84:87], v[32:35], v[200:203], v[84:87]
    v_add_u32 v3, 0x10000, v3
    ds_read_b64_tr_b16 v[24:25], v3 offset:0
    v_fma_f32 v18, v18, s38, s38
    v_mfma_f32_16x16x32_bf16 v[84:87], v[36:39], v[204:207], v[84:87]
    ds_read_b64_tr_b16 v[26:27], v3 offset:2048
    v_fma_f32 v19, v19, s38, s38
    v_rcp_f32 v16, v16
    v_mfma_f32_16x16x32_bf16 v[68:71], v[36:39], v[140:143], v[68:71]
    ds_read_b64_tr_b16 v[28:29], v3 offset:4096
    v_mfma_f32_16x16x32_bf16 v[68:71], v[32:35], v[136:139], v[68:71]
    ds_read_b64_tr_b16 v[30:31], v3 offset:6144
    v_rcp_f32 v17, v17
    s_waitcnt lgkmcnt(4)
    v_mfma_f32_16x16x32_bf16 v[68:71], v[40:43], v[144:147], v[68:71]
    ds_read_b64_tr_b16 v[32:33], v3 offset:8192
    v_rcp_f32 v18, v18
    v_mfma_f32_16x16x32_bf16 v[68:71], v[44:47], v[148:151], v[68:71]
    ds_read_b64_tr_b16 v[34:35], v3 offset:10240
    v_mfma_f32_16x16x32_bf16 v[84:87], v[44:47], v[212:215], v[84:87]
    ds_read_b64_tr_b16 v[36:37], v3 offset:12288
    v_rcp_f32 v19, v19
    v_mfma_f32_16x16x32_bf16 v[84:87], v[40:43], v[208:211], v[84:87]
    ds_read_b64_tr_b16 v[38:39], v3 offset:14336
    v_mfma_f32_16x16x32_bf16 v[84:87], v[48:51], v[216:219], v[84:87]
    ds_read_b64_tr_b16 v[40:41], v3 offset:16384
    v_mul_f32 v116, v116, v16
    v_mul_f32 v117, v117, v17
    v_mfma_f32_16x16x32_bf16 v[84:87], v[52:55], v[220:223], v[84:87]
    ds_read_b64_tr_b16 v[42:43], v3 offset:18432
    v_mul_f32 v118, v118, v18
    v_mfma_f32_16x16x32_bf16 v[68:71], v[52:55], v[156:159], v[68:71]
    ds_read_b64_tr_b16 v[44:45], v3 offset:20480
    v_mul_f32 v119, v119, v19
    v_mfma_f32_16x16x32_bf16 v[68:71], v[48:51], v[152:155], v[68:71]
    ds_read_b64_tr_b16 v[46:47], v3 offset:22528
    v_exp_f32_e64 v12, -v104
    s_waitcnt lgkmcnt(4)
    v_mfma_f32_16x16x32_bf16 v[72:75], v[24:27], v[128:131], 0
    ds_read_b64_tr_b16 v[48:49], v3 offset:24576
    v_exp_f32_e64 v13, -v105
    v_mfma_f32_16x16x32_bf16 v[72:75], v[28:31], v[132:135], v[72:75]
    ds_read_b64_tr_b16 v[50:51], v3 offset:26624
    v_mfma_f32_16x16x32_bf16 v[88:91], v[28:31], v[196:199], 0
    ds_read_b64_tr_b16 v[52:53], v3 offset:28672
    v_exp_f32_e64 v14, -v106
    v_mfma_f32_16x16x32_bf16 v[88:91], v[24:27], v[192:195], v[88:91]
    ds_read_b64_tr_b16 v[54:55], v3 offset:30720
    v_mfma_f32_16x16x32_bf16 v[88:91], v[32:35], v[200:203], v[88:91]
    v_add_u32 v4, 0x10000, v4
    ds_read_b64_tr_b16 v[24:25], v4 offset:0
    v_exp_f32_e64 v15, -v107
    v_mfma_f32_16x16x32_bf16 v[88:91], v[36:39], v[204:207], v[88:91]
    ds_read_b64_tr_b16 v[26:27], v4 offset:2048
    v_fma_f32 v12, v12, s38, s38
    v_mfma_f32_16x16x32_bf16 v[72:75], v[36:39], v[140:143], v[72:75]
    ds_read_b64_tr_b16 v[28:29], v4 offset:4096
    v_fma_f32 v13, v13, s38, s38
    v_mfma_f32_16x16x32_bf16 v[72:75], v[32:35], v[136:139], v[72:75]
    ds_read_b64_tr_b16 v[30:31], v4 offset:6144
    v_fma_f32 v14, v14, s38, s38
    v_fma_f32 v15, v15, s38, s38
    s_waitcnt lgkmcnt(4)
    v_mfma_f32_16x16x32_bf16 v[72:75], v[40:43], v[144:147], v[72:75]
    ds_read_b64_tr_b16 v[32:33], v4 offset:8192
    v_rcp_f32 v12, v12
    v_mfma_f32_16x16x32_bf16 v[72:75], v[44:47], v[148:151], v[72:75]
    ds_read_b64_tr_b16 v[34:35], v4 offset:10240
    v_mfma_f32_16x16x32_bf16 v[88:91], v[44:47], v[212:215], v[88:91]
    ds_read_b64_tr_b16 v[36:37], v4 offset:12288
    v_rcp_f32 v13, v13
    v_mfma_f32_16x16x32_bf16 v[88:91], v[40:43], v[208:211], v[88:91]
    ds_read_b64_tr_b16 v[38:39], v4 offset:14336
    v_rcp_f32 v14, v14
    v_mfma_f32_16x16x32_bf16 v[88:91], v[48:51], v[216:219], v[88:91]
    ds_read_b64_tr_b16 v[40:41], v4 offset:16384
    v_mfma_f32_16x16x32_bf16 v[88:91], v[52:55], v[220:223], v[88:91]
    ds_read_b64_tr_b16 v[42:43], v4 offset:18432
    v_rcp_f32 v15, v15
    v_mfma_f32_16x16x32_bf16 v[72:75], v[52:55], v[156:159], v[72:75]
    ds_read_b64_tr_b16 v[44:45], v4 offset:20480
    v_mfma_f32_16x16x32_bf16 v[72:75], v[48:51], v[152:155], v[72:75]
    ds_read_b64_tr_b16 v[46:47], v4 offset:22528
    v_mul_f32 v104, v104, v12
    v_mul_f32 v105, v105, v13
    s_waitcnt lgkmcnt(4)
    v_mfma_f32_16x16x32_bf16 v[76:79], v[24:27], v[128:131], 0
    ds_read_b64_tr_b16 v[48:49], v4 offset:24576
    v_mul_f32 v106, v106, v14
    v_mfma_f32_16x16x32_bf16 v[76:79], v[28:31], v[132:135], v[76:79]
    ds_read_b64_tr_b16 v[50:51], v4 offset:26624
    v_mul_f32 v107, v107, v15
    v_mfma_f32_16x16x32_bf16 v[92:95], v[28:31], v[196:199], 0
    ds_read_b64_tr_b16 v[52:53], v4 offset:28672
    v_exp_f32_e64 v16, -v120
    v_mfma_f32_16x16x32_bf16 v[92:95], v[24:27], v[192:195], v[92:95]
    ds_read_b64_tr_b16 v[54:55], v4 offset:30720
    v_exp_f32_e64 v17, -v121
    v_mfma_f32_16x16x32_bf16 v[92:95], v[32:35], v[200:203], v[92:95]
    ds_read_b64_tr_b16 v[24:25], v1 offset:32768
    v_mfma_f32_16x16x32_bf16 v[92:95], v[36:39], v[204:207], v[92:95]
    ds_read_b64_tr_b16 v[26:27], v1 offset:34816
    v_exp_f32_e64 v18, -v122
    v_mfma_f32_16x16x32_bf16 v[76:79], v[36:39], v[140:143], v[76:79]
    ds_read_b64_tr_b16 v[28:29], v1 offset:36864
    v_exp_f32_e64 v19, -v123
    v_mfma_f32_16x16x32_bf16 v[76:79], v[32:35], v[136:139], v[76:79]
    ds_read_b64_tr_b16 v[30:31], v1 offset:38912
    s_waitcnt lgkmcnt(4)
    v_mfma_f32_16x16x32_bf16 v[76:79], v[40:43], v[144:147], v[76:79]
    ds_read_b64_tr_b16 v[32:33], v1 offset:40960
    v_fma_f32 v16, v16, s38, s38
    v_mfma_f32_16x16x32_bf16 v[76:79], v[44:47], v[148:151], v[76:79]
    ds_read_b64_tr_b16 v[34:35], v1 offset:43008
    v_fma_f32 v17, v17, s38, s38
    v_mfma_f32_16x16x32_bf16 v[92:95], v[44:47], v[212:215], v[92:95]
    ds_read_b64_tr_b16 v[36:37], v1 offset:45056
    v_fma_f32 v18, v18, s38, s38
    v_fma_f32 v19, v19, s38, s38
    v_mfma_f32_16x16x32_bf16 v[92:95], v[40:43], v[208:211], v[92:95]
    ds_read_b64_tr_b16 v[38:39], v1 offset:47104
    v_rcp_f32 v16, v16
    v_mfma_f32_16x16x32_bf16 v[92:95], v[48:51], v[216:219], v[92:95]
    s_barrier
    ds_read_b64_tr_b16 v[40:41], v1 offset:49152
    v_mfma_f32_16x16x32_bf16 v[92:95], v[52:55], v[220:223], v[92:95]
    ds_read_b64_tr_b16 v[42:43], v1 offset:51200
    v_rcp_f32 v17, v17
    v_mfma_f32_16x16x32_bf16 v[76:79], v[52:55], v[156:159], v[76:79]
    ds_read_b64_tr_b16 v[44:45], v1 offset:53248
    v_rcp_f32 v18, v18
    v_mfma_f32_16x16x32_bf16 v[76:79], v[48:51], v[152:155], v[76:79]
    ds_read_b64_tr_b16 v[46:47], v1 offset:55296
    s_waitcnt lgkmcnt(4)
    v_mfma_f32_16x16x32_bf16 v[64:67], v[24:27], v[160:163], v[64:67]
    ds_read_b64_tr_b16 v[48:49], v1 offset:57344
    v_rcp_f32 v19, v19
    v_mfma_f32_16x16x32_bf16 v[64:67], v[28:31], v[164:167], v[64:67]
    ds_read_b64_tr_b16 v[50:51], v1 offset:59392
    v_mul_f32 v120, v120, v16
    v_mfma_f32_16x16x32_bf16 v[80:83], v[28:31], v[228:231], v[80:83]
    ds_read_b64_tr_b16 v[52:53], v1 offset:61440
    v_mul_f32 v121, v121, v17
    v_mfma_f32_16x16x32_bf16 v[80:83], v[24:27], v[224:227], v[80:83]
    ds_read_b64_tr_b16 v[54:55], v1 offset:63488
    v_mul_f32 v122, v122, v18
    v_mfma_f32_16x16x32_bf16 v[80:83], v[32:35], v[232:235], v[80:83]
    ds_read_b64_tr_b16 v[24:25], v2 offset:32768
    v_mul_f32 v123, v123, v19
    v_exp_f32_e64 v12, -v108
    v_mfma_f32_16x16x32_bf16 v[80:83], v[36:39], v[236:239], v[80:83]
    ds_read_b64_tr_b16 v[26:27], v2 offset:34816
    v_mfma_f32_16x16x32_bf16 v[64:67], v[36:39], v[172:175], v[64:67]
    ds_read_b64_tr_b16 v[28:29], v2 offset:36864
    v_exp_f32_e64 v13, -v109
    v_mfma_f32_16x16x32_bf16 v[64:67], v[32:35], v[168:171], v[64:67]
    ds_read_b64_tr_b16 v[30:31], v2 offset:38912
    s_waitcnt lgkmcnt(4)
    v_mfma_f32_16x16x32_bf16 v[64:67], v[40:43], v[176:179], v[64:67]
    ds_read_b64_tr_b16 v[32:33], v2 offset:40960
    v_exp_f32_e64 v14, -v110
    v_mfma_f32_16x16x32_bf16 v[64:67], v[44:47], v[180:183], v[64:67]
    ds_read_b64_tr_b16 v[34:35], v2 offset:43008
    v_exp_f32_e64 v15, -v111
    v_mfma_f32_16x16x32_bf16 v[80:83], v[44:47], v[244:247], v[80:83]
    ds_read_b64_tr_b16 v[36:37], v2 offset:45056
    v_mfma_f32_16x16x32_bf16 v[80:83], v[40:43], v[240:243], v[80:83]
    ds_read_b64_tr_b16 v[38:39], v2 offset:47104
    v_fma_f32 v12, v12, s38, s38
    v_mfma_f32_16x16x32_bf16 v[80:83], v[48:51], v[248:251], v[80:83]
    ds_read_b64_tr_b16 v[40:41], v2 offset:49152
    v_fma_f32 v13, v13, s38, s38
    v_fma_f32 v14, v14, s38, s38
    v_mfma_f32_16x16x32_bf16 v[80:83], v[52:55], v[252:255], v[80:83]
    ds_read_b64_tr_b16 v[42:43], v2 offset:51200
    v_fma_f32 v15, v15, s38, s38
    v_mfma_f32_16x16x32_bf16 v[64:67], v[52:55], v[188:191], v[64:67]
    ds_read_b64_tr_b16 v[44:45], v2 offset:53248
    v_rcp_f32 v12, v12
    v_mfma_f32_16x16x32_bf16 v[64:67], v[48:51], v[184:187], v[64:67]
    ds_read_b64_tr_b16 v[46:47], v2 offset:55296
    s_waitcnt lgkmcnt(4)
    v_mfma_f32_16x16x32_bf16 v[68:71], v[24:27], v[160:163], v[68:71]
    ds_read_b64_tr_b16 v[48:49], v2 offset:57344
    v_rcp_f32 v13, v13
    v_mfma_f32_16x16x32_bf16 v[68:71], v[28:31], v[164:167], v[68:71]
    ds_read_b64_tr_b16 v[50:51], v2 offset:59392
    v_rcp_f32 v14, v14
    v_mfma_f32_16x16x32_bf16 v[84:87], v[28:31], v[228:231], v[84:87]
    ds_read_b64_tr_b16 v[52:53], v2 offset:61440
    v_mfma_f32_16x16x32_bf16 v[84:87], v[24:27], v[224:227], v[84:87]
    ds_read_b64_tr_b16 v[54:55], v2 offset:63488
    v_rcp_f32 v15, v15
    v_mfma_f32_16x16x32_bf16 v[84:87], v[32:35], v[232:235], v[84:87]
    ds_read_b64_tr_b16 v[24:25], v3 offset:32768
    s_add_u32 s98, s8, 0
    v_mfma_f32_16x16x32_bf16 v[84:87], v[36:39], v[236:239], v[84:87]
    ds_read_b64_tr_b16 v[26:27], v3 offset:34816
    buffer_load_dwordx4 v[128:131], v21, s[64:67], s98 offen offset:0 sc1
    v_mul_f32 v108, v108, v12
    v_mfma_f32_16x16x32_bf16 v[68:71], v[36:39], v[172:175], v[68:71]
    ds_read_b64_tr_b16 v[28:29], v3 offset:36864
    buffer_load_dwordx4 v[132:135], v21, s[64:67], s98 offen offset:2048 sc1
    v_mfma_f32_16x16x32_bf16 v[68:71], v[32:35], v[168:171], v[68:71]
    ds_read_b64_tr_b16 v[30:31], v3 offset:38912
    v_mul_f32 v109, v109, v13
    v_mul_f32 v110, v110, v14
    s_waitcnt lgkmcnt(4)
    v_mfma_f32_16x16x32_bf16 v[68:71], v[40:43], v[176:179], v[68:71]
    ds_read_b64_tr_b16 v[32:33], v3 offset:40960
    v_mul_f32 v111, v111, v15
    v_mfma_f32_16x16x32_bf16 v[68:71], v[44:47], v[180:183], v[68:71]
    ds_read_b64_tr_b16 v[34:35], v3 offset:43008
    v_exp_f32_e64 v16, -v124
    v_mfma_f32_16x16x32_bf16 v[84:87], v[44:47], v[244:247], v[84:87]
    ds_read_b64_tr_b16 v[36:37], v3 offset:45056
    v_exp_f32_e64 v17, -v125
    v_mfma_f32_16x16x32_bf16 v[84:87], v[40:43], v[240:243], v[84:87]
    ds_read_b64_tr_b16 v[38:39], v3 offset:47104
    v_mfma_f32_16x16x32_bf16 v[84:87], v[48:51], v[248:251], v[84:87]
    ds_read_b64_tr_b16 v[40:41], v3 offset:49152
    v_exp_f32_e64 v18, -v126
    v_mfma_f32_16x16x32_bf16 v[84:87], v[52:55], v[252:255], v[84:87]
    ds_read_b64_tr_b16 v[42:43], v3 offset:51200
    v_exp_f32_e64 v19, -v127
    v_mfma_f32_16x16x32_bf16 v[68:71], v[52:55], v[188:191], v[68:71]
    ds_read_b64_tr_b16 v[44:45], v3 offset:53248
    s_add_u32 s98, s9, 0
    v_mfma_f32_16x16x32_bf16 v[68:71], v[48:51], v[184:187], v[68:71]
    ds_read_b64_tr_b16 v[46:47], v3 offset:55296
    buffer_load_dwordx4 v[136:139], v21, s[64:67], s98 offen offset:0 sc1
    s_waitcnt lgkmcnt(4)
    v_mfma_f32_16x16x32_bf16 v[72:75], v[24:27], v[160:163], v[72:75]
    ds_read_b64_tr_b16 v[48:49], v3 offset:57344
    buffer_load_dwordx4 v[140:143], v21, s[64:67], s98 offen offset:2048 sc1
    v_fma_f32 v16, v16, s38, s38
    v_mfma_f32_16x16x32_bf16 v[72:75], v[28:31], v[164:167], v[72:75]
    ds_read_b64_tr_b16 v[50:51], v3 offset:59392
    v_fma_f32 v17, v17, s38, s38
    v_mfma_f32_16x16x32_bf16 v[88:91], v[28:31], v[228:231], v[88:91]
    ds_read_b64_tr_b16 v[52:53], v3 offset:61440
    v_fma_f32 v18, v18, s38, s38
    v_mfma_f32_16x16x32_bf16 v[88:91], v[24:27], v[224:227], v[88:91]
    ds_read_b64_tr_b16 v[54:55], v3 offset:63488
    v_fma_f32 v19, v19, s38, s38
    v_rcp_f32 v16, v16
    v_mfma_f32_16x16x32_bf16 v[88:91], v[32:35], v[232:235], v[88:91]
    ds_read_b64_tr_b16 v[24:25], v4 offset:32768
    v_mfma_f32_16x16x32_bf16 v[88:91], v[36:39], v[236:239], v[88:91]
    ds_read_b64_tr_b16 v[26:27], v4 offset:34816
    v_rcp_f32 v17, v17
    v_mfma_f32_16x16x32_bf16 v[72:75], v[36:39], v[172:175], v[72:75]
    ds_read_b64_tr_b16 v[28:29], v4 offset:36864
    v_rcp_f32 v18, v18
    v_mfma_f32_16x16x32_bf16 v[72:75], v[32:35], v[168:171], v[72:75]
    ds_read_b64_tr_b16 v[30:31], v4 offset:38912
    s_waitcnt lgkmcnt(4)
    v_mfma_f32_16x16x32_bf16 v[72:75], v[40:43], v[176:179], v[72:75]
    ds_read_b64_tr_b16 v[32:33], v4 offset:40960
    s_add_u32 s98, s8, 16384
    v_rcp_f32 v19, v19
    v_mfma_f32_16x16x32_bf16 v[72:75], v[44:47], v[180:183], v[72:75]
    ds_read_b64_tr_b16 v[34:35], v4 offset:43008
    buffer_load_dwordx4 v[144:147], v21, s[64:67], s98 offen offset:0 sc1
    v_mfma_f32_16x16x32_bf16 v[88:91], v[44:47], v[244:247], v[88:91]
    ds_read_b64_tr_b16 v[36:37], v4 offset:45056
    buffer_load_dwordx4 v[208:211], v21, s[64:67], s98 offen offset:2048 sc1
    v_mfma_f32_16x16x32_bf16 v[88:91], v[40:43], v[240:243], v[88:91]
    ds_read_b64_tr_b16 v[38:39], v4 offset:47104
    v_mul_f32 v124, v124, v16
    v_mul_f32 v125, v125, v17
    v_mfma_f32_16x16x32_bf16 v[88:91], v[48:51], v[248:251], v[88:91]
    ds_read_b64_tr_b16 v[40:41], v4 offset:49152
    v_mul_f32 v126, v126, v18
    v_mul_f32 v127, v127, v19
    v_mfma_f32_16x16x32_bf16 v[88:91], v[52:55], v[252:255], v[88:91]
    ds_read_b64_tr_b16 v[42:43], v4 offset:51200
    v_mul_f32 v64, v64, v96
    v_mfma_f32_16x16x32_bf16 v[72:75], v[52:55], v[188:191], v[72:75]
    ds_read_b64_tr_b16 v[44:45], v4 offset:53248
    v_mul_f32 v65, v65, v97
    v_mul_f32 v66, v66, v98
    v_mfma_f32_16x16x32_bf16 v[72:75], v[48:51], v[184:187], v[72:75]
    ds_read_b64_tr_b16 v[46:47], v4 offset:55296
    v_mul_f32 v67, v67, v99
    s_waitcnt lgkmcnt(4)
    v_mfma_f32_16x16x32_bf16 v[76:79], v[24:27], v[160:163], v[76:79]
    ds_read_b64_tr_b16 v[48:49], v4 offset:57344
    v_mul_f32 v68, v68, v100
    v_mul_f32 v69, v69, v101
    v_mfma_f32_16x16x32_bf16 v[76:79], v[28:31], v[164:167], v[76:79]
    ds_read_b64_tr_b16 v[50:51], v4 offset:59392
    v_mul_f32 v70, v70, v102
    v_mfma_f32_16x16x32_bf16 v[92:95], v[28:31], v[228:231], v[92:95]
    ds_read_b64_tr_b16 v[52:53], v4 offset:61440
    s_add_u32 s98, s9, 16384
    v_mul_f32 v71, v71, v103
    v_mfma_f32_16x16x32_bf16 v[92:95], v[24:27], v[224:227], v[92:95]
    s_branch L_pg5738x
L_pg5738:
    s_setpc_b64 s[30:31]
L_pg5738x:
    ds_read_b64_tr_b16 v[54:55], v4 offset:63488
    buffer_load_dwordx4 v[148:151], v21, s[64:67], s98 offen offset:0 sc1
    v_mul_f32 v80, v80, v112
    v_mfma_f32_16x16x32_bf16 v[92:95], v[32:35], v[232:235], v[92:95]
    buffer_load_dwordx4 v[212:215], v21, s[64:67], s98 offen offset:2048 sc1
    v_mul_f32 v81, v81, v113
    v_mfma_f32_16x16x32_bf16 v[92:95], v[36:39], v[236:239], v[92:95]
    v_mul_f32 v82, v82, v114
    v_mfma_f32_16x16x32_bf16 v[76:79], v[36:39], v[172:175], v[76:79]
    v_mul_f32 v83, v83, v115
    v_mul_f32 v84, v84, v116
    v_mfma_f32_16x16x32_bf16 v[76:79], v[32:35], v[168:171], v[76:79]
    v_mul_f32 v85, v85, v117
    v_mul_f32 v86, v86, v118
    s_waitcnt lgkmcnt(0)
    v_mfma_f32_16x16x32_bf16 v[76:79], v[40:43], v[176:179], v[76:79]
    v_mul_f32 v87, v87, v119
    v_mfma_f32_16x16x32_bf16 v[76:79], v[44:47], v[180:183], v[76:79]
    v_cvt_pk_bf16_f32 v64, v64, v65
    v_cvt_pk_bf16_f32 v65, v66, v67
    v_mfma_f32_16x16x32_bf16 v[92:95], v[44:47], v[244:247], v[92:95]
    v_cvt_pk_bf16_f32 v66, v68, v69
    v_cvt_pk_bf16_f32 v67, v70, v71
    v_mfma_f32_16x16x32_bf16 v[92:95], v[40:43], v[240:243], v[92:95]
    buffer_store_dwordx4 v[64:67], v7, s[64:67], s88 offen offset:0 sc1
    v_cvt_pk_bf16_f32 v80, v80, v81
    v_mfma_f32_16x16x32_bf16 v[92:95], v[48:51], v[248:251], v[92:95]
    s_add_u32 s98, s8, 32768
    v_cvt_pk_bf16_f32 v81, v82, v83
    v_mfma_f32_16x16x32_bf16 v[92:95], v[52:55], v[252:255], v[92:95]
    buffer_load_dwordx4 v[152:155], v21, s[64:67], s98 offen offset:0 sc1
    v_cvt_pk_bf16_f32 v82, v84, v85
    v_mfma_f32_16x16x32_bf16 v[76:79], v[52:55], v[188:191], v[76:79]
    buffer_load_dwordx4 v[216:219], v21, s[64:67], s98 offen offset:2048 sc1
    v_cvt_pk_bf16_f32 v83, v86, v87
    buffer_store_dwordx4 v[80:83], v7, s[64:67], s88 offen offset:1024 sc1
    v_mfma_f32_16x16x32_bf16 v[76:79], v[48:51], v[184:187], v[76:79]
    s_barrier
    v_add_u32 v1, v9, v1
    v_add_u32 v2, v9, v2
    v_add_u32 v3, v9, v3
    v_add_u32 v4, v9, v4
    v_add_u32 v1, 0x10000, v1
    ds_read_b64_tr_b16 v[24:25], v1 offset:0
    ds_read_b64_tr_b16 v[26:27], v1 offset:2048
    ds_read_b64_tr_b16 v[28:29], v1 offset:4096
    ds_read_b64_tr_b16 v[30:31], v1 offset:6144
    v_add_u32 v2, 0x10000, v2
    ds_read_b64_tr_b16 v[32:33], v2 offset:0
    ds_read_b64_tr_b16 v[34:35], v2 offset:2048
    ds_read_b64_tr_b16 v[36:37], v2 offset:4096
    ds_read_b64_tr_b16 v[38:39], v2 offset:6144
    v_add_u32 v3, 0x10000, v3
    ds_read_b64_tr_b16 v[40:41], v3 offset:0
    ds_read_b64_tr_b16 v[42:43], v3 offset:2048
    ds_read_b64_tr_b16 v[44:45], v3 offset:4096
    ds_read_b64_tr_b16 v[46:47], v3 offset:6144
    v_mul_f32 v72, v72, v104
    v_mul_f32 v73, v73, v105
    v_mul_f32 v74, v74, v106
    v_mul_f32 v75, v75, v107
    v_mul_f32 v76, v76, v108
    v_mul_f32 v77, v77, v109
    v_mul_f32 v78, v78, v110
    v_mul_f32 v79, v79, v111
    v_mul_f32 v88, v88, v120
    v_mul_f32 v89, v89, v121
    v_mul_f32 v90, v90, v122
    v_mul_f32 v91, v91, v123
    v_mul_f32 v92, v92, v124
    v_mul_f32 v93, v93, v125
    v_mul_f32 v94, v94, v126
    v_mul_f32 v95, v95, v127
    v_cvt_pk_bf16_f32 v72, v72, v73
    v_cvt_pk_bf16_f32 v73, v74, v75
    v_cvt_pk_bf16_f32 v74, v76, v77
    v_cvt_pk_bf16_f32 v75, v78, v79
    buffer_store_dwordx4 v[72:75], v7, s[64:67], s88 offen offset:2048 sc1
    v_cvt_pk_bf16_f32 v88, v88, v89
    v_cvt_pk_bf16_f32 v89, v90, v91
    v_cvt_pk_bf16_f32 v90, v92, v93
    v_cvt_pk_bf16_f32 v91, v94, v95
    buffer_store_dwordx4 v[88:91], v7, s[64:67], s88 offen offset:3072 sc1
    s_waitcnt vmcnt(10) lgkmcnt(4)
    v_mfma_f32_16x16x32_bf16 v[112:115], v[24:27], v[128:131], 0
    v_add_u32 v4, 0x10000, v4
    ds_read_b64_tr_b16 v[48:49], v4 offset:0
    v_mfma_f32_16x16x32_bf16 v[112:115], v[28:31], v[132:135], v[112:115]
    ds_read_b64_tr_b16 v[50:51], v4 offset:2048
    s_add_u32 s81, s9, 32768
    v_mfma_f32_16x16x32_bf16 v[96:99], v[28:31], v[140:143], 0
    ds_read_b64_tr_b16 v[52:53], v4 offset:4096
    buffer_load_dwordx4 v[156:159], v21, s[64:67], s81 offen offset:0 sc1
    v_mfma_f32_16x16x32_bf16 v[96:99], v[24:27], v[136:139], v[96:99]
    ds_read_b64_tr_b16 v[54:55], v4 offset:6144
    buffer_load_dwordx4 v[220:223], v21, s[64:67], s81 offen offset:2048 sc1
    v_mfma_f32_16x16x32_bf16 v[116:119], v[32:35], v[128:131], 0
    ds_read_b64_tr_b16 v[24:25], v1 offset:8192
    v_mfma_f32_16x16x32_bf16 v[116:119], v[36:39], v[132:135], v[116:119]
    ds_read_b64_tr_b16 v[26:27], v1 offset:10240
    s_add_u32 s81, s8, 49152
    v_mfma_f32_16x16x32_bf16 v[100:103], v[36:39], v[140:143], 0
    ds_read_b64_tr_b16 v[28:29], v1 offset:12288
    buffer_load_dwordx4 v[192:195], v21, s[64:67], s81 offen offset:0 sc1
    v_mfma_f32_16x16x32_bf16 v[100:103], v[32:35], v[136:139], v[100:103]
    ds_read_b64_tr_b16 v[30:31], v1 offset:14336
    buffer_load_dwordx4 v[196:199], v21, s[64:67], s81 offen offset:2048 sc1
    s_waitcnt lgkmcnt(4)
    v_mfma_f32_16x16x32_bf16 v[120:123], v[40:43], v[128:131], 0
    ds_read_b64_tr_b16 v[32:33], v2 offset:8192
    v_mfma_f32_16x16x32_bf16 v[120:123], v[44:47], v[132:135], v[120:123]
    ds_read_b64_tr_b16 v[34:35], v2 offset:10240
    s_add_u32 s81, s9, 49152
    v_mfma_f32_16x16x32_bf16 v[104:107], v[44:47], v[140:143], 0
    ds_read_b64_tr_b16 v[36:37], v2 offset:12288
    buffer_load_dwordx4 v[200:203], v21, s[64:67], s81 offen offset:0 sc1
    v_mfma_f32_16x16x32_bf16 v[104:107], v[40:43], v[136:139], v[104:107]
    ds_read_b64_tr_b16 v[38:39], v2 offset:14336
    buffer_load_dwordx4 v[204:207], v21, s[64:67], s81 offen offset:2048 sc1
    v_mfma_f32_16x16x32_bf16 v[124:127], v[48:51], v[128:131], 0
    ds_read_b64_tr_b16 v[40:41], v3 offset:8192
    v_mfma_f32_16x16x32_bf16 v[124:127], v[52:55], v[132:135], v[124:127]
    ds_read_b64_tr_b16 v[42:43], v3 offset:10240
    v_mfma_f32_16x16x32_bf16 v[108:111], v[52:55], v[140:143], 0
    ds_read_b64_tr_b16 v[44:45], v3 offset:12288
    v_mfma_f32_16x16x32_bf16 v[108:111], v[48:51], v[136:139], v[108:111]
    ds_read_b64_tr_b16 v[46:47], v3 offset:14336
    s_waitcnt lgkmcnt(8)
    s_barrier
    s_waitcnt vmcnt(12) lgkmcnt(4)
    v_mfma_f32_16x16x32_bf16 v[112:115], v[24:27], v[144:147], v[112:115]
    ds_read_b64_tr_b16 v[48:49], v4 offset:8192
    v_mfma_f32_16x16x32_bf16 v[112:115], v[28:31], v[208:211], v[112:115]
    ds_read_b64_tr_b16 v[50:51], v4 offset:10240
    s_add_u32 s81, s8, 196608
    v_mfma_f32_16x16x32_bf16 v[96:99], v[28:31], v[212:215], v[96:99]
    ds_read_b64_tr_b16 v[52:53], v4 offset:12288
    buffer_load_dwordx4 v[128:131], v21, s[64:67], s81 offen offset:0 sc1
    v_mfma_f32_16x16x32_bf16 v[96:99], v[24:27], v[148:151], v[96:99]
    ds_read_b64_tr_b16 v[54:55], v4 offset:14336
    buffer_load_dwordx4 v[132:135], v21, s[64:67], s81 offen offset:2048 sc1
    v_mfma_f32_16x16x32_bf16 v[116:119], v[32:35], v[144:147], v[116:119]
    ds_read_b64_tr_b16 v[24:25], v1 offset:16384
    v_mfma_f32_16x16x32_bf16 v[116:119], v[36:39], v[208:211], v[116:119]
    ds_read_b64_tr_b16 v[26:27], v1 offset:18432
    v_mfma_f32_16x16x32_bf16 v[100:103], v[36:39], v[212:215], v[100:103]
    ds_read_b64_tr_b16 v[28:29], v1 offset:20480
    v_mfma_f32_16x16x32_bf16 v[100:103], v[32:35], v[148:151], v[100:103]
    ds_read_b64_tr_b16 v[30:31], v1 offset:22528
    s_waitcnt lgkmcnt(4)
    v_mfma_f32_16x16x32_bf16 v[120:123], v[40:43], v[144:147], v[120:123]
    ds_read_b64_tr_b16 v[32:33], v2 offset:16384
    v_mfma_f32_16x16x32_bf16 v[120:123], v[44:47], v[208:211], v[120:123]
    ds_read_b64_tr_b16 v[34:35], v2 offset:18432
    s_add_u32 s81, s9, 196608
    v_mfma_f32_16x16x32_bf16 v[104:107], v[44:47], v[212:215], v[104:107]
    ds_read_b64_tr_b16 v[36:37], v2 offset:20480
    buffer_load_dwordx4 v[136:139], v21, s[64:67], s81 offen offset:0 sc1
    v_mfma_f32_16x16x32_bf16 v[104:107], v[40:43], v[148:151], v[104:107]
    ds_read_b64_tr_b16 v[38:39], v2 offset:22528
    buffer_load_dwordx4 v[140:143], v21, s[64:67], s81 offen offset:2048 sc1
    v_mfma_f32_16x16x32_bf16 v[124:127], v[48:51], v[144:147], v[124:127]
    ds_read_b64_tr_b16 v[40:41], v3 offset:16384
    v_mfma_f32_16x16x32_bf16 v[124:127], v[52:55], v[208:211], v[124:127]
    ds_read_b64_tr_b16 v[42:43], v3 offset:18432
    v_mfma_f32_16x16x32_bf16 v[108:111], v[52:55], v[212:215], v[108:111]
    ds_read_b64_tr_b16 v[44:45], v3 offset:20480
    v_mfma_f32_16x16x32_bf16 v[108:111], v[48:51], v[148:151], v[108:111]
    ds_read_b64_tr_b16 v[46:47], v3 offset:22528
    s_add_u32 s81, s45, 4096
    s_waitcnt vmcnt(10)
    buffer_store_dword v10, v11, s[64:67], s81 offen sc1
    s_waitcnt lgkmcnt(8)
    s_barrier
    s_waitcnt vmcnt(9) lgkmcnt(4)
    v_mfma_f32_16x16x32_bf16 v[112:115], v[24:27], v[152:155], v[112:115]
    ds_read_b64_tr_b16 v[48:49], v4 offset:16384
    v_mfma_f32_16x16x32_bf16 v[112:115], v[28:31], v[216:219], v[112:115]
    ds_read_b64_tr_b16 v[50:51], v4 offset:18432
    s_add_u32 s81, s8, 212992
    v_mfma_f32_16x16x32_bf16 v[96:99], v[28:31], v[220:223], v[96:99]
    ds_read_b64_tr_b16 v[52:53], v4 offset:20480
    buffer_load_dwordx4 v[144:147], v21, s[64:67], s81 offen offset:0 sc1
    v_mfma_f32_16x16x32_bf16 v[96:99], v[24:27], v[156:159], v[96:99]
    ds_read_b64_tr_b16 v[54:55], v4 offset:22528
    buffer_load_dwordx4 v[208:211], v21, s[64:67], s81 offen offset:2048 sc1
    v_mfma_f32_16x16x32_bf16 v[116:119], v[32:35], v[152:155], v[116:119]
    v_add_u32 v1, 0xfffde000, v1
    ds_read_b64_tr_b16 v[24:25], v1 offset:0
    v_mfma_f32_16x16x32_bf16 v[116:119], v[36:39], v[216:219], v[116:119]
    ds_read_b64_tr_b16 v[26:27], v1 offset:2048
    v_mfma_f32_16x16x32_bf16 v[100:103], v[36:39], v[220:223], v[100:103]
    ds_read_b64_tr_b16 v[28:29], v1 offset:4096
    v_mfma_f32_16x16x32_bf16 v[100:103], v[32:35], v[156:159], v[100:103]
    ds_read_b64_tr_b16 v[30:31], v1 offset:6144
    s_waitcnt lgkmcnt(4)
    v_mfma_f32_16x16x32_bf16 v[120:123], v[40:43], v[152:155], v[120:123]
    v_add_u32 v2, 0xfffde000, v2
    ds_read_b64_tr_b16 v[32:33], v2 offset:0
    v_mfma_f32_16x16x32_bf16 v[120:123], v[44:47], v[216:219], v[120:123]
    ds_read_b64_tr_b16 v[34:35], v2 offset:2048
    s_add_u32 s81, s9, 212992
    v_mfma_f32_16x16x32_bf16 v[104:107], v[44:47], v[220:223], v[104:107]
    ds_read_b64_tr_b16 v[36:37], v2 offset:4096
    buffer_load_dwordx4 v[148:151], v21, s[64:67], s81 offen offset:0 sc1
    v_mfma_f32_16x16x32_bf16 v[104:107], v[40:43], v[156:159], v[104:107]
    ds_read_b64_tr_b16 v[38:39], v2 offset:6144
    buffer_load_dwordx4 v[212:215], v21, s[64:67], s81 offen offset:2048 sc1
    v_mfma_f32_16x16x32_bf16 v[124:127], v[48:51], v[152:155], v[124:127]
    v_add_u32 v3, 0xfffde000, v3
    ds_read_b64_tr_b16 v[40:41], v3 offset:0
    v_mfma_f32_16x16x32_bf16 v[124:127], v[52:55], v[216:219], v[124:127]
    ds_read_b64_tr_b16 v[42:43], v3 offset:2048
    v_mfma_f32_16x16x32_bf16 v[108:111], v[52:55], v[220:223], v[108:111]
    ds_read_b64_tr_b16 v[44:45], v3 offset:4096
    v_mfma_f32_16x16x32_bf16 v[108:111], v[48:51], v[156:159], v[108:111]
    ds_read_b64_tr_b16 v[46:47], v3 offset:6144
    s_waitcnt lgkmcnt(8)
    s_barrier
    s_waitcnt vmcnt(9) lgkmcnt(4)
    v_mfma_f32_16x16x32_bf16 v[112:115], v[24:27], v[192:195], v[112:115]
    v_add_u32 v4, 0xfffde000, v4
    ds_read_b64_tr_b16 v[48:49], v4 offset:0
    v_permlane16_swap_b32 v56, v58
    v_mfma_f32_16x16x32_bf16 v[112:115], v[28:31], v[196:199], v[112:115]
    ds_read_b64_tr_b16 v[50:51], v4 offset:2048
    s_add_u32 s81, s8, 131072
    v_mfma_f32_16x16x32_bf16 v[96:99], v[28:31], v[204:207], v[96:99]
    ds_read_b64_tr_b16 v[52:53], v4 offset:4096
    buffer_load_dwordx4 v[152:155], v21, s[64:67], s81 offen offset:0 sc1
    v_mfma_f32_16x16x32_bf16 v[96:99], v[24:27], v[200:203], v[96:99]
    ds_read_b64_tr_b16 v[54:55], v4 offset:6144
    buffer_load_dwordx4 v[216:219], v21, s[64:67], s81 offen offset:2048 sc1
    v_mfma_f32_16x16x32_bf16 v[116:119], v[32:35], v[192:195], v[116:119]
    ds_read_b64_tr_b16 v[24:25], v1 offset:8192
    v_permlane16_swap_b32 v57, v59
    v_mfma_f32_16x16x32_bf16 v[116:119], v[36:39], v[196:199], v[116:119]
    ds_read_b64_tr_b16 v[26:27], v1 offset:10240
    v_permlane16_swap_b32 v60, v62
    v_mfma_f32_16x16x32_bf16 v[100:103], v[36:39], v[204:207], v[100:103]
    ds_read_b64_tr_b16 v[28:29], v1 offset:12288
    v_permlane16_swap_b32 v61, v63
    v_mfma_f32_16x16x32_bf16 v[100:103], v[32:35], v[200:203], v[100:103]
    ds_read_b64_tr_b16 v[30:31], v1 offset:14336
    v_lshlrev_b32 v64, 16, v56
    s_waitcnt lgkmcnt(4)
    v_mfma_f32_16x16x32_bf16 v[120:123], v[40:43], v[192:195], v[120:123]
    ds_read_b64_tr_b16 v[32:33], v2 offset:8192
    v_and_b32 v65, s39, v56
    v_mfma_f32_16x16x32_bf16 v[120:123], v[44:47], v[196:199], v[120:123]
    ds_read_b64_tr_b16 v[34:35], v2 offset:10240
    s_add_u32 s81, s9, 131072
    v_mfma_f32_16x16x32_bf16 v[104:107], v[44:47], v[204:207], v[104:107]
    ds_read_b64_tr_b16 v[36:37], v2 offset:12288
    buffer_load_dwordx4 v[156:159], v21, s[64:67], s81 offen offset:0 sc1
    v_mfma_f32_16x16x32_bf16 v[104:107], v[40:43], v[200:203], v[104:107]
    ds_read_b64_tr_b16 v[38:39], v2 offset:14336
    buffer_load_dwordx4 v[220:223], v21, s[64:67], s81 offen offset:2048 sc1
    v_mfma_f32_16x16x32_bf16 v[124:127], v[48:51], v[192:195], v[124:127]
    ds_read_b64_tr_b16 v[40:41], v3 offset:8192
    v_lshlrev_b32 v66, 16, v57
    v_mfma_f32_16x16x32_bf16 v[124:127], v[52:55], v[196:199], v[124:127]
    ds_read_b64_tr_b16 v[42:43], v3 offset:10240
    v_and_b32 v67, s39, v57
    v_mfma_f32_16x16x32_bf16 v[108:111], v[52:55], v[204:207], v[108:111]
    ds_read_b64_tr_b16 v[44:45], v3 offset:12288
    v_lshlrev_b32 v68, 16, v58
    v_mfma_f32_16x16x32_bf16 v[108:111], v[48:51], v[200:203], v[108:111]
    ds_read_b64_tr_b16 v[46:47], v3 offset:14336
    v_and_b32 v69, s39, v58
    s_waitcnt vmcnt(9) lgkmcnt(4)
    v_mfma_f32_16x16x32_bf16 v[112:115], v[24:27], v[128:131], v[112:115]
    ds_read_b64_tr_b16 v[48:49], v4 offset:8192
    v_lshlrev_b32 v70, 16, v59
    v_mfma_f32_16x16x32_bf16 v[112:115], v[28:31], v[132:135], v[112:115]
    ds_read_b64_tr_b16 v[50:51], v4 offset:10240
    s_add_u32 s81, s8, 147456
    v_mfma_f32_16x16x32_bf16 v[96:99], v[28:31], v[140:143], v[96:99]
    ds_read_b64_tr_b16 v[52:53], v4 offset:12288
    buffer_load_dwordx4 v[192:195], v21, s[64:67], s81 offen offset:0 sc1
    v_mfma_f32_16x16x32_bf16 v[96:99], v[24:27], v[136:139], v[96:99]
    ds_read_b64_tr_b16 v[54:55], v4 offset:14336
    buffer_load_dwordx4 v[196:199], v21, s[64:67], s81 offen offset:2048 sc1
    v_mfma_f32_16x16x32_bf16 v[116:119], v[32:35], v[128:131], v[116:119]
    ds_read_b64_tr_b16 v[24:25], v1 offset:16384
    v_and_b32 v71, s39, v59
    v_mfma_f32_16x16x32_bf16 v[116:119], v[36:39], v[132:135], v[116:119]
    ds_read_b64_tr_b16 v[26:27], v1 offset:18432
    v_lshlrev_b32 v72, 16, v60
    v_mfma_f32_16x16x32_bf16 v[100:103], v[36:39], v[140:143], v[100:103]
    ds_read_b64_tr_b16 v[28:29], v1 offset:20480
    v_and_b32 v73, s39, v60
    v_mfma_f32_16x16x32_bf16 v[100:103], v[32:35], v[136:139], v[100:103]
    ds_read_b64_tr_b16 v[30:31], v1 offset:22528
    v_lshlrev_b32 v74, 16, v61
    s_waitcnt lgkmcnt(4)
    v_mfma_f32_16x16x32_bf16 v[120:123], v[40:43], v[128:131], v[120:123]
    ds_read_b64_tr_b16 v[32:33], v2 offset:16384
    v_and_b32 v75, s39, v61
    v_mfma_f32_16x16x32_bf16 v[120:123], v[44:47], v[132:135], v[120:123]
    ds_read_b64_tr_b16 v[34:35], v2 offset:18432
    s_add_u32 s81, s9, 147456
    v_mfma_f32_16x16x32_bf16 v[104:107], v[44:47], v[140:143], v[104:107]
    ds_read_b64_tr_b16 v[36:37], v2 offset:20480
    buffer_load_dwordx4 v[200:203], v21, s[64:67], s81 offen offset:0 sc1
    v_mfma_f32_16x16x32_bf16 v[104:107], v[40:43], v[136:139], v[104:107]
    ds_read_b64_tr_b16 v[38:39], v2 offset:22528
    buffer_load_dwordx4 v[204:207], v21, s[64:67], s81 offen offset:2048 sc1
    v_mfma_f32_16x16x32_bf16 v[124:127], v[48:51], v[128:131], v[124:127]
    ds_read_b64_tr_b16 v[40:41], v3 offset:16384
    v_lshlrev_b32 v76, 16, v62
    v_mfma_f32_16x16x32_bf16 v[124:127], v[52:55], v[132:135], v[124:127]
    ds_read_b64_tr_b16 v[42:43], v3 offset:18432
    v_and_b32 v77, s39, v62
    v_mfma_f32_16x16x32_bf16 v[108:111], v[52:55], v[140:143], v[108:111]
    ds_read_b64_tr_b16 v[44:45], v3 offset:20480
    v_lshlrev_b32 v78, 16, v63
    v_mfma_f32_16x16x32_bf16 v[108:111], v[48:51], v[136:139], v[108:111]
    ds_read_b64_tr_b16 v[46:47], v3 offset:22528
    v_and_b32 v79, s39, v63
    s_waitcnt lgkmcnt(8)
    s_barrier
    s_waitcnt vmcnt(8) lgkmcnt(4)
    v_mfma_f32_16x16x32_bf16 v[112:115], v[24:27], v[144:147], v[112:115]
    ds_read_b64_tr_b16 v[48:49], v4 offset:16384
    v_mov_b32 v12, 0x3f80
    v_mfma_f32_16x16x32_bf16 v[112:115], v[28:31], v[208:211], v[112:115]
    ds_read_b64_tr_b16 v[50:51], v4 offset:18432
    s_add_u32 s81, s8, 163840
    v_mfma_f32_16x16x32_bf16 v[96:99], v[28:31], v[212:215], v[96:99]
    ds_read_b64_tr_b16 v[52:53], v4 offset:20480
    buffer_load_dwordx4 v[128:131], v21, s[64:67], s81 offen offset:0 sc1
    v_mfma_f32_16x16x32_bf16 v[96:99], v[24:27], v[148:151], v[96:99]
    ds_read_b64_tr_b16 v[54:55], v4 offset:22528
    buffer_load_dwordx4 v[132:135], v21, s[64:67], s81 offen offset:2048 sc1
    v_mfma_f32_16x16x32_bf16 v[116:119], v[32:35], v[144:147], v[116:119]
    ds_read_b64_tr_b16 v[24:25], v1 offset:24576
    v_mov_b32 v13, 0x3f800000
    v_mfma_f32_16x16x32_bf16 v[116:119], v[36:39], v[208:211], v[116:119]
    ds_read_b64_tr_b16 v[26:27], v1 offset:26624
    v_lshlrev_b32 v15, 2, v0
    v_mfma_f32_16x16x32_bf16 v[100:103], v[36:39], v[212:215], v[100:103]
    ds_read_b64_tr_b16 v[28:29], v1 offset:28672
    v_mfma_f32_16x16x32_bf16 v[100:103], v[32:35], v[148:151], v[100:103]
    ds_read_b64_tr_b16 v[30:31], v1 offset:30720
    s_waitcnt lgkmcnt(4)
    v_mfma_f32_16x16x32_bf16 v[120:123], v[40:43], v[144:147], v[120:123]
    ds_read_b64_tr_b16 v[32:33], v2 offset:24576
    v_mfma_f32_16x16x32_bf16 v[120:123], v[44:47], v[208:211], v[120:123]
    ds_read_b64_tr_b16 v[34:35], v2 offset:26624
    s_add_u32 s81, s9, 163840
    v_mfma_f32_16x16x32_bf16 v[104:107], v[44:47], v[212:215], v[104:107]
    ds_read_b64_tr_b16 v[36:37], v2 offset:28672
    buffer_load_dwordx4 v[136:139], v21, s[64:67], s81 offen offset:0 sc1
    v_mfma_f32_16x16x32_bf16 v[104:107], v[40:43], v[148:151], v[104:107]
    ds_read_b64_tr_b16 v[38:39], v2 offset:30720
    buffer_load_dwordx4 v[140:143], v21, s[64:67], s81 offen offset:2048 sc1
    v_mfma_f32_16x16x32_bf16 v[124:127], v[48:51], v[144:147], v[124:127]
    ds_read_b64_tr_b16 v[40:41], v3 offset:24576
    v_mfma_f32_16x16x32_bf16 v[124:127], v[52:55], v[208:211], v[124:127]
    ds_read_b64_tr_b16 v[42:43], v3 offset:26624
    v_mfma_f32_16x16x32_bf16 v[108:111], v[52:55], v[212:215], v[108:111]
    ds_read_b64_tr_b16 v[44:45], v3 offset:28672
    v_mfma_f32_16x16x32_bf16 v[108:111], v[48:51], v[148:151], v[108:111]
    ds_read_b64_tr_b16 v[46:47], v3 offset:30720
    s_waitcnt vmcnt(8) lgkmcnt(4)
    v_mfma_f32_16x16x32_bf16 v[112:115], v[24:27], v[152:155], v[112:115]
    ds_read_b64_tr_b16 v[48:49], v4 offset:24576
    v_mfma_f32_16x16x32_bf16 v[112:115], v[28:31], v[216:219], v[112:115]
    ds_read_b64_tr_b16 v[50:51], v4 offset:26624
    s_add_u32 s81, s8, 180224
    v_mfma_f32_16x16x32_bf16 v[96:99], v[28:31], v[220:223], v[96:99]
    ds_read_b64_tr_b16 v[52:53], v4 offset:28672
    buffer_load_dwordx4 v[144:147], v21, s[64:67], s81 offen offset:0 sc1
    v_mfma_f32_16x16x32_bf16 v[96:99], v[24:27], v[156:159], v[96:99]
    ds_read_b64_tr_b16 v[54:55], v4 offset:30720
    buffer_load_dwordx4 v[208:211], v21, s[64:67], s81 offen offset:2048 sc1
    v_mfma_f32_16x16x32_bf16 v[116:119], v[32:35], v[152:155], v[116:119]
    ds_read_b64_tr_b16 v[24:25], v1 offset:32768
    v_mfma_f32_16x16x32_bf16 v[116:119], v[36:39], v[216:219], v[116:119]
    ds_read_b64_tr_b16 v[26:27], v1 offset:34816
    v_mfma_f32_16x16x32_bf16 v[100:103], v[36:39], v[220:223], v[100:103]
    ds_read_b64_tr_b16 v[28:29], v1 offset:36864
    v_mfma_f32_16x16x32_bf16 v[100:103], v[32:35], v[156:159], v[100:103]
    ds_read_b64_tr_b16 v[30:31], v1 offset:38912
    s_waitcnt lgkmcnt(4)
    v_mfma_f32_16x16x32_bf16 v[120:123], v[40:43], v[152:155], v[120:123]
    ds_read_b64_tr_b16 v[32:33], v2 offset:32768
    v_mfma_f32_16x16x32_bf16 v[120:123], v[44:47], v[216:219], v[120:123]
    ds_read_b64_tr_b16 v[34:35], v2 offset:34816
    s_add_u32 s81, s9, 180224
    v_mfma_f32_16x16x32_bf16 v[104:107], v[44:47], v[220:223], v[104:107]
    ds_read_b64_tr_b16 v[36:37], v2 offset:36864
    v_add_f32 v112, v112, v64
    v_add_f32 v113, v113, v65
    v_add_f32 v114, v114, v66
    v_add_f32 v115, v115, v67
    buffer_load_dwordx4 v[148:151], v21, s[64:67], s81 offen offset:0 sc1
    v_mfma_f32_16x16x32_bf16 v[104:107], v[40:43], v[156:159], v[104:107]
    ds_read_b64_tr_b16 v[38:39], v2 offset:38912
    buffer_load_dwordx4 v[212:215], v21, s[64:67], s81 offen offset:2048 sc1
    v_mfma_f32_16x16x32_bf16 v[124:127], v[48:51], v[152:155], v[124:127]
    ds_read_b64_tr_b16 v[40:41], v3 offset:32768
    v_mfma_f32_16x16x32_bf16 v[124:127], v[52:55], v[216:219], v[124:127]
    ds_read_b64_tr_b16 v[42:43], v3 offset:34816
    v_mfma_f32_16x16x32_bf16 v[108:111], v[52:55], v[220:223], v[108:111]
    ds_read_b64_tr_b16 v[44:45], v3 offset:36864
    v_add_f32 v116, v116, v68
    v_add_f32 v117, v117, v69
    v_add_f32 v118, v118, v70
    v_add_f32 v119, v119, v71
    v_mfma_f32_16x16x32_bf16 v[108:111], v[48:51], v[156:159], v[108:111]
    ds_read_b64_tr_b16 v[46:47], v3 offset:38912
    s_waitcnt lgkmcnt(8)
    s_barrier
    s_waitcnt vmcnt(8) lgkmcnt(4)
    v_mfma_f32_16x16x32_bf16 v[112:115], v[24:27], v[192:195], v[112:115]
    ds_read_b64_tr_b16 v[48:49], v4 offset:32768
    v_mfma_f32_16x16x32_bf16 v[112:115], v[28:31], v[196:199], v[112:115]
    ds_read_b64_tr_b16 v[50:51], v4 offset:34816
    s_add_u32 s81, s9, 65536
    v_mfma_f32_16x16x32_bf16 v[96:99], v[28:31], v[204:207], v[96:99]
    ds_read_b64_tr_b16 v[52:53], v4 offset:36864
    v_add_f32 v120, v120, v72
    v_add_f32 v121, v121, v73
    v_add_f32 v122, v122, v74
    v_add_f32 v123, v123, v75
    buffer_load_dwordx4 v[152:155], v21, s[64:67], s81 offen offset:0 sc1
    v_mfma_f32_16x16x32_bf16 v[96:99], v[24:27], v[200:203], v[96:99]
    ds_read_b64_tr_b16 v[54:55], v4 offset:38912
    buffer_load_dwordx4 v[216:219], v21, s[64:67], s81 offen offset:2048 sc1
    v_mfma_f32_16x16x32_bf16 v[116:119], v[32:35], v[192:195], v[116:119]
    ds_read_b64_tr_b16 v[24:25], v1 offset:40960
    v_mfma_f32_16x16x32_bf16 v[116:119], v[36:39], v[196:199], v[116:119]
    ds_read_b64_tr_b16 v[26:27], v1 offset:43008
    v_mfma_f32_16x16x32_bf16 v[100:103], v[36:39], v[204:207], v[100:103]
    ds_read_b64_tr_b16 v[28:29], v1 offset:45056
    v_add_f32 v124, v124, v76
    v_add_f32 v125, v125, v77
    v_add_f32 v126, v126, v78
    v_add_f32 v127, v127, v79
    v_mfma_f32_16x16x32_bf16 v[100:103], v[32:35], v[200:203], v[100:103]
    ds_read_b64_tr_b16 v[30:31], v1 offset:47104
    s_waitcnt lgkmcnt(4)
    v_mfma_f32_16x16x32_bf16 v[120:123], v[40:43], v[192:195], v[120:123]
    ds_read_b64_tr_b16 v[32:33], v2 offset:40960
    v_mfma_f32_16x16x32_bf16 v[120:123], v[44:47], v[196:199], v[120:123]
    ds_read_b64_tr_b16 v[34:35], v2 offset:43008
    s_add_u32 s81, s9, 81920
    v_mfma_f32_16x16x32_bf16 v[104:107], v[44:47], v[204:207], v[104:107]
    ds_read_b64_tr_b16 v[36:37], v2 offset:45056
    buffer_load_dwordx4 v[156:159], v21, s[64:67], s81 offen offset:0 sc1
    v_mfma_f32_16x16x32_bf16 v[104:107], v[40:43], v[200:203], v[104:107]
    ds_read_b64_tr_b16 v[38:39], v2 offset:47104
    buffer_load_dwordx4 v[220:223], v21, s[64:67], s81 offen offset:2048 sc1
    v_mfma_f32_16x16x32_bf16 v[124:127], v[48:51], v[192:195], v[124:127]
    ds_read_b64_tr_b16 v[40:41], v3 offset:40960
    v_mfma_f32_16x16x32_bf16 v[124:127], v[52:55], v[196:199], v[124:127]
    ds_read_b64_tr_b16 v[42:43], v3 offset:43008
    v_mfma_f32_16x16x32_bf16 v[108:111], v[52:55], v[204:207], v[108:111]
    ds_read_b64_tr_b16 v[44:45], v3 offset:45056
    v_mfma_f32_16x16x32_bf16 v[108:111], v[48:51], v[200:203], v[108:111]
    ds_read_b64_tr_b16 v[46:47], v3 offset:47104
    s_waitcnt vmcnt(8) lgkmcnt(4)
    v_mfma_f32_16x16x32_bf16 v[112:115], v[24:27], v[128:131], v[112:115]
    ds_read_b64_tr_b16 v[48:49], v4 offset:40960
    v_mfma_f32_16x16x32_bf16 v[112:115], v[28:31], v[132:135], v[112:115]
    ds_read_b64_tr_b16 v[50:51], v4 offset:43008
    s_add_u32 s81, s9, 98304
    v_mfma_f32_16x16x32_bf16 v[96:99], v[28:31], v[140:143], v[96:99]
    ds_read_b64_tr_b16 v[52:53], v4 offset:45056
    buffer_load_dwordx4 v[192:195], v21, s[64:67], s81 offen offset:0 sc1
    v_mfma_f32_16x16x32_bf16 v[96:99], v[24:27], v[136:139], v[96:99]
    ds_read_b64_tr_b16 v[54:55], v4 offset:47104
    buffer_load_dwordx4 v[196:199], v21, s[64:67], s81 offen offset:2048 sc1
    v_mfma_f32_16x16x32_bf16 v[116:119], v[32:35], v[128:131], v[116:119]
    ds_read_b64_tr_b16 v[24:25], v1 offset:49152
    v_mfma_f32_16x16x32_bf16 v[116:119], v[36:39], v[132:135], v[116:119]
    ds_read_b64_tr_b16 v[26:27], v1 offset:51200
    v_mfma_f32_16x16x32_bf16 v[100:103], v[36:39], v[140:143], v[100:103]
    ds_read_b64_tr_b16 v[28:29], v1 offset:53248
    v_mfma_f32_16x16x32_bf16 v[100:103], v[32:35], v[136:139], v[100:103]
    ds_read_b64_tr_b16 v[30:31], v1 offset:55296
    s_waitcnt lgkmcnt(4)
    v_mfma_f32_16x16x32_bf16 v[120:123], v[40:43], v[128:131], v[120:123]
    ds_read_b64_tr_b16 v[32:33], v2 offset:49152
    v_mfma_f32_16x16x32_bf16 v[120:123], v[44:47], v[132:135], v[120:123]
    ds_read_b64_tr_b16 v[34:35], v2 offset:51200
    s_add_u32 s81, s9, 114688
    v_mfma_f32_16x16x32_bf16 v[104:107], v[44:47], v[140:143], v[104:107]
    ds_read_b64_tr_b16 v[36:37], v2 offset:53248
    buffer_load_dwordx4 v[200:203], v21, s[64:67], s81 offen offset:0 sc1
    v_mfma_f32_16x16x32_bf16 v[104:107], v[40:43], v[136:139], v[104:107]
    ds_read_b64_tr_b16 v[38:39], v2 offset:55296
    buffer_load_dwordx4 v[204:207], v21, s[64:67], s81 offen offset:2048 sc1
    v_mfma_f32_16x16x32_bf16 v[124:127], v[48:51], v[128:131], v[124:127]
    ds_read_b64_tr_b16 v[40:41], v3 offset:49152
    v_mfma_f32_16x16x32_bf16 v[124:127], v[52:55], v[132:135], v[124:127]
    ds_read_b64_tr_b16 v[42:43], v3 offset:51200
    v_mfma_f32_16x16x32_bf16 v[108:111], v[52:55], v[140:143], v[108:111]
    ds_read_b64_tr_b16 v[44:45], v3 offset:53248
    v_mfma_f32_16x16x32_bf16 v[108:111], v[48:51], v[136:139], v[108:111]
    ds_read_b64_tr_b16 v[46:47], v3 offset:55296
    s_waitcnt vmcnt(8) lgkmcnt(4)
    v_mfma_f32_16x16x32_bf16 v[112:115], v[24:27], v[144:147], v[112:115]
    ds_read_b64_tr_b16 v[48:49], v4 offset:49152
    v_mfma_f32_16x16x32_bf16 v[112:115], v[28:31], v[208:211], v[112:115]
    ds_read_b64_tr_b16 v[50:51], v4 offset:51200
    s_add_u32 s81, s8, 65536
    v_mfma_f32_16x16x32_bf16 v[96:99], v[28:31], v[212:215], v[96:99]
    ds_read_b64_tr_b16 v[52:53], v4 offset:53248
    buffer_load_dwordx4 v[128:131], v21, s[64:67], s81 offen offset:0 sc1
    v_mfma_f32_16x16x32_bf16 v[96:99], v[24:27], v[148:151], v[96:99]
    ds_read_b64_tr_b16 v[54:55], v4 offset:55296
    buffer_load_dwordx4 v[132:135], v21, s[64:67], s81 offen offset:2048 sc1
    v_mfma_f32_16x16x32_bf16 v[116:119], v[32:35], v[144:147], v[116:119]
    ds_read_b64_tr_b16 v[24:25], v1 offset:57344
    v_mfma_f32_16x16x32_bf16 v[116:119], v[36:39], v[208:211], v[116:119]
    ds_read_b64_tr_b16 v[26:27], v1 offset:59392
    v_mfma_f32_16x16x32_bf16 v[100:103], v[36:39], v[212:215], v[100:103]
    ds_read_b64_tr_b16 v[28:29], v1 offset:61440
    v_mfma_f32_16x16x32_bf16 v[100:103], v[32:35], v[148:151], v[100:103]
    ds_read_b64_tr_b16 v[30:31], v1 offset:63488
    s_waitcnt lgkmcnt(4)
    v_mfma_f32_16x16x32_bf16 v[120:123], v[40:43], v[144:147], v[120:123]
    ds_read_b64_tr_b16 v[32:33], v2 offset:57344
    v_mfma_f32_16x16x32_bf16 v[120:123], v[44:47], v[208:211], v[120:123]
    ds_read_b64_tr_b16 v[34:35], v2 offset:59392
    s_add_u32 s81, s8, 81920
    v_mfma_f32_16x16x32_bf16 v[104:107], v[44:47], v[212:215], v[104:107]
    ds_read_b64_tr_b16 v[36:37], v2 offset:61440
    buffer_load_dwordx4 v[136:139], v21, s[64:67], s81 offen offset:0 sc1
    v_mfma_f32_16x16x32_bf16 v[104:107], v[40:43], v[148:151], v[104:107]
    ds_read_b64_tr_b16 v[38:39], v2 offset:63488
    buffer_load_dwordx4 v[140:143], v21, s[64:67], s81 offen offset:2048 sc1
    v_mfma_f32_16x16x32_bf16 v[124:127], v[48:51], v[144:147], v[124:127]
    ds_read_b64_tr_b16 v[40:41], v3 offset:57344
    v_mfma_f32_16x16x32_bf16 v[124:127], v[52:55], v[208:211], v[124:127]
    ds_read_b64_tr_b16 v[42:43], v3 offset:59392
    v_mfma_f32_16x16x32_bf16 v[108:111], v[52:55], v[212:215], v[108:111]
    ds_read_b64_tr_b16 v[44:45], v3 offset:61440
    v_mfma_f32_16x16x32_bf16 v[108:111], v[48:51], v[148:151], v[108:111]
    ds_read_b64_tr_b16 v[46:47], v3 offset:63488
    s_waitcnt lgkmcnt(8)
    s_barrier
    s_waitcnt vmcnt(10)
    v_mfma_f32_16x16x32_bf16 v[96:99], v[24:27], v[152:155], v[96:99]
    ds_read_b64_tr_b16 v[48:49], v4 offset:57344
    ds_read_b64_tr_b16 v[50:51], v4 offset:59392
    v_mfma_f32_16x16x32_bf16 v[96:99], v[28:31], v[216:219], v[96:99]
    ds_read_b64_tr_b16 v[52:53], v4 offset:61440
    ds_read_b64_tr_b16 v[54:55], v4 offset:63488
    s_add_u32 s81, s10, 229376
    buffer_load_dwordx4 v[144:147], v21, s[64:67], s81 offen offset:0 sc1
    buffer_load_dwordx4 v[208:211], v21, s[64:67], s81 offen offset:2048 sc1
    s_waitcnt lgkmcnt(8)
    v_mfma_f32_16x16x32_bf16 v[100:103], v[32:35], v[152:155], v[100:103]
    v_add_u32 v1, 0x10000, v1
    ds_read_b64_tr_b16 v[24:25], v1 offset:0
    ds_read_b64_tr_b16 v[26:27], v1 offset:2048
    v_mfma_f32_16x16x32_bf16 v[100:103], v[36:39], v[216:219], v[100:103]
    ds_read_b64_tr_b16 v[28:29], v1 offset:4096
    ds_read_b64_tr_b16 v[30:31], v1 offset:6144
    s_waitcnt lgkmcnt(8)
    v_mfma_f32_16x16x32_bf16 v[104:107], v[40:43], v[152:155], v[104:107]
    s_branch L_pg6307x
L_pg6307:
    s_setpc_b64 s[30:31]
L_pg6307x:
    v_add_u32 v2, 0x10000, v2
    ds_read_b64_tr_b16 v[32:33], v2 offset:0
    ds_read_b64_tr_b16 v[34:35], v2 offset:2048
    v_mfma_f32_16x16x32_bf16 v[104:107], v[44:47], v[216:219], v[104:107]
    ds_read_b64_tr_b16 v[36:37], v2 offset:4096
    ds_read_b64_tr_b16 v[38:39], v2 offset:6144
    s_waitcnt lgkmcnt(8)
    v_mfma_f32_16x16x32_bf16 v[108:111], v[48:51], v[152:155], v[108:111]
    v_add_u32 v3, 0x10000, v3
    ds_read_b64_tr_b16 v[40:41], v3 offset:0
    ds_read_b64_tr_b16 v[42:43], v3 offset:2048
    v_mfma_f32_16x16x32_bf16 v[108:111], v[52:55], v[216:219], v[108:111]
    ds_read_b64_tr_b16 v[44:45], v3 offset:4096
    ds_read_b64_tr_b16 v[46:47], v3 offset:6144
    s_waitcnt vmcnt(10) lgkmcnt(8)
    v_mfma_f32_16x16x32_bf16 v[96:99], v[24:27], v[156:159], v[96:99]
    v_add_u32 v4, 0x10000, v4
    ds_read_b64_tr_b16 v[48:49], v4 offset:0
    ds_read_b64_tr_b16 v[50:51], v4 offset:2048
    v_mfma_f32_16x16x32_bf16 v[96:99], v[28:31], v[220:223], v[96:99]
    ds_read_b64_tr_b16 v[52:53], v4 offset:4096
    ds_read_b64_tr_b16 v[54:55], v4 offset:6144
    s_add_u32 s81, s10, 237568
    buffer_load_dwordx4 v[148:151], v21, s[64:67], s81 offen offset:0 sc1
    buffer_load_dwordx4 v[212:215], v21, s[64:67], s81 offen offset:2048 sc1
    s_waitcnt lgkmcnt(8)
    v_mfma_f32_16x16x32_bf16 v[100:103], v[32:35], v[156:159], v[100:103]
    ds_read_b64_tr_b16 v[160:161], v1 offset:8192
    ds_read_b64_tr_b16 v[162:163], v1 offset:10240
    v_mfma_f32_16x16x32_bf16 v[100:103], v[36:39], v[220:223], v[100:103]
    ds_read_b64_tr_b16 v[224:225], v1 offset:12288
    ds_read_b64_tr_b16 v[226:227], v1 offset:14336
    s_waitcnt lgkmcnt(8)
    v_mfma_f32_16x16x32_bf16 v[104:107], v[40:43], v[156:159], v[104:107]
    ds_read_b64_tr_b16 v[164:165], v2 offset:8192
    ds_read_b64_tr_b16 v[166:167], v2 offset:10240
    v_mfma_f32_16x16x32_bf16 v[104:107], v[44:47], v[220:223], v[104:107]
    ds_read_b64_tr_b16 v[228:229], v2 offset:12288
    ds_read_b64_tr_b16 v[230:231], v2 offset:14336
    s_waitcnt lgkmcnt(8)
    v_mfma_f32_16x16x32_bf16 v[108:111], v[48:51], v[156:159], v[108:111]
    ds_read_b64_tr_b16 v[168:169], v3 offset:8192
    ds_read_b64_tr_b16 v[170:171], v3 offset:10240
    v_mfma_f32_16x16x32_bf16 v[108:111], v[52:55], v[220:223], v[108:111]
    ds_read_b64_tr_b16 v[232:233], v3 offset:12288
    ds_read_b64_tr_b16 v[234:235], v3 offset:14336
    s_waitcnt vmcnt(10) lgkmcnt(8)
    v_mfma_f32_16x16x32_bf16 v[96:99], v[160:163], v[192:195], v[96:99]
    ds_read_b64_tr_b16 v[172:173], v4 offset:8192
    ds_read_b64_tr_b16 v[174:175], v4 offset:10240
    v_mfma_f32_16x16x32_bf16 v[96:99], v[224:227], v[196:199], v[96:99]
    ds_read_b64_tr_b16 v[236:237], v4 offset:12288
    ds_read_b64_tr_b16 v[238:239], v4 offset:14336
    s_add_u32 s81, s10, 245760
    buffer_load_dwordx4 v[152:155], v21, s[64:67], s81 offen offset:0 sc1
    buffer_load_dwordx4 v[216:219], v21, s[64:67], s81 offen offset:2048 sc1
    s_waitcnt lgkmcnt(8)
    v_mfma_f32_16x16x32_bf16 v[100:103], v[164:167], v[192:195], v[100:103]
    ds_read_b64_tr_b16 v[176:177], v1 offset:16384
    ds_read_b64_tr_b16 v[178:179], v1 offset:18432
    v_mfma_f32_16x16x32_bf16 v[100:103], v[228:231], v[196:199], v[100:103]
    ds_read_b64_tr_b16 v[240:241], v1 offset:20480
    ds_read_b64_tr_b16 v[242:243], v1 offset:22528
    s_waitcnt lgkmcnt(8)
    v_mfma_f32_16x16x32_bf16 v[104:107], v[168:171], v[192:195], v[104:107]
    ds_read_b64_tr_b16 v[180:181], v2 offset:16384
    ds_read_b64_tr_b16 v[182:183], v2 offset:18432
    v_mfma_f32_16x16x32_bf16 v[104:107], v[232:235], v[196:199], v[104:107]
    ds_read_b64_tr_b16 v[244:245], v2 offset:20480
    ds_read_b64_tr_b16 v[246:247], v2 offset:22528
    s_waitcnt lgkmcnt(8)
    v_mfma_f32_16x16x32_bf16 v[108:111], v[172:175], v[192:195], v[108:111]
    ds_read_b64_tr_b16 v[184:185], v3 offset:16384
    ds_read_b64_tr_b16 v[186:187], v3 offset:18432
    v_mfma_f32_16x16x32_bf16 v[108:111], v[236:239], v[196:199], v[108:111]
    ds_read_b64_tr_b16 v[248:249], v3 offset:20480
    ds_read_b64_tr_b16 v[250:251], v3 offset:22528
    s_waitcnt vmcnt(10) lgkmcnt(8)
    v_mfma_f32_16x16x32_bf16 v[96:99], v[176:179], v[200:203], v[96:99]
    ds_read_b64_tr_b16 v[188:189], v4 offset:16384
    ds_read_b64_tr_b16 v[190:191], v4 offset:18432
    v_mfma_f32_16x16x32_bf16 v[96:99], v[240:243], v[204:207], v[96:99]
    ds_read_b64_tr_b16 v[252:253], v4 offset:20480
    ds_read_b64_tr_b16 v[254:255], v4 offset:22528
    s_add_u32 s81, s10, 253952
    buffer_load_dwordx4 v[156:159], v21, s[64:67], s81 offen offset:0 sc1
    buffer_load_dwordx4 v[220:223], v21, s[64:67], s81 offen offset:2048 sc1
    s_waitcnt lgkmcnt(8)
    v_mfma_f32_16x16x32_bf16 v[100:103], v[180:183], v[200:203], v[100:103]
    v_add_u32 v1, 0xffffe000, v1
    ds_read_b64_tr_b16 v[24:25], v1 offset:0
    ds_read_b64_tr_b16 v[26:27], v1 offset:2048
    v_mfma_f32_16x16x32_bf16 v[100:103], v[244:247], v[204:207], v[100:103]
    ds_read_b64_tr_b16 v[28:29], v1 offset:4096
    ds_read_b64_tr_b16 v[30:31], v1 offset:6144
    s_waitcnt lgkmcnt(8)
    v_mfma_f32_16x16x32_bf16 v[104:107], v[184:187], v[200:203], v[104:107]
    v_add_u32 v2, 0xffffe000, v2
    ds_read_b64_tr_b16 v[32:33], v2 offset:0
    ds_read_b64_tr_b16 v[34:35], v2 offset:2048
    v_mfma_f32_16x16x32_bf16 v[104:107], v[248:251], v[204:207], v[104:107]
    ds_read_b64_tr_b16 v[36:37], v2 offset:4096
    ds_read_b64_tr_b16 v[38:39], v2 offset:6144
    v_cvt_pk_bf16_f32 v96, v96, v97
    v_cvt_pk_bf16_f32 v97, v98, v99
    v_add3_u32 v14, v10, v96, v97
    s_waitcnt lgkmcnt(8)
    v_mfma_f32_16x16x32_bf16 v[108:111], v[188:191], v[200:203], v[108:111]
    v_add_u32 v3, 0xffffe000, v3
    ds_read_b64_tr_b16 v[40:41], v3 offset:0
    ds_read_b64_tr_b16 v[42:43], v3 offset:2048
    v_mfma_f32_16x16x32_bf16 v[108:111], v[252:255], v[204:207], v[108:111]
    ds_read_b64_tr_b16 v[44:45], v3 offset:4096
    ds_read_b64_tr_b16 v[46:47], v3 offset:6144
    v_cvt_pk_bf16_f32 v98, v100, v101
    v_cvt_pk_bf16_f32 v99, v102, v103
    v_add3_u32 v14, v14, v98, v99
    buffer_store_dwordx4 v[96:99], v7, s[64:67], s11 offen offset:0 sc1
    s_waitcnt vmcnt(11) lgkmcnt(8)
    v_mfma_f32_16x16x32_bf16 v[112:115], v[24:27], v[128:131], v[112:115]
    v_add_u32 v4, 0xffffe000, v4
    ds_read_b64_tr_b16 v[48:49], v4 offset:0
    ds_read_b64_tr_b16 v[50:51], v4 offset:2048
    v_mfma_f32_16x16x32_bf16 v[112:115], v[28:31], v[132:135], v[112:115]
    ds_read_b64_tr_b16 v[52:53], v4 offset:4096
    ds_read_b64_tr_b16 v[54:55], v4 offset:6144
    s_add_u32 s81, s10, 262144
    buffer_load_dwordx4 v[192:195], v21, s[64:67], s81 offen offset:0 sc1
    buffer_load_dwordx4 v[196:199], v21, s[64:67], s81 offen offset:2048 sc1
    v_cvt_pk_bf16_f32 v100, v104, v105
    v_cvt_pk_bf16_f32 v101, v106, v107
    v_add3_u32 v14, v14, v100, v101
    s_waitcnt lgkmcnt(8)
    v_mfma_f32_16x16x32_bf16 v[116:119], v[32:35], v[128:131], v[116:119]
    ds_read_b64_tr_b16 v[24:25], v1 offset:8192
    ds_read_b64_tr_b16 v[26:27], v1 offset:10240
    v_mfma_f32_16x16x32_bf16 v[116:119], v[36:39], v[132:135], v[116:119]
    ds_read_b64_tr_b16 v[28:29], v1 offset:12288
    ds_read_b64_tr_b16 v[30:31], v1 offset:14336
    v_cvt_pk_bf16_f32 v102, v108, v109
    v_cvt_pk_bf16_f32 v103, v110, v111
    v_add3_u32 v14, v14, v102, v103
    buffer_store_dwordx4 v[100:103], v7, s[64:67], s11 offen offset:1024 sc1
    buffer_store_dword v14, v15, s[64:67], s11 offen offset:2048 sc1
    s_waitcnt lgkmcnt(8)
    v_mfma_f32_16x16x32_bf16 v[120:123], v[40:43], v[128:131], v[120:123]
    ds_read_b64_tr_b16 v[32:33], v2 offset:8192
    ds_read_b64_tr_b16 v[34:35], v2 offset:10240
    v_mfma_f32_16x16x32_bf16 v[120:123], v[44:47], v[132:135], v[120:123]
    ds_read_b64_tr_b16 v[36:37], v2 offset:12288
    ds_read_b64_tr_b16 v[38:39], v2 offset:14336
    s_waitcnt lgkmcnt(8)
    v_mfma_f32_16x16x32_bf16 v[124:127], v[48:51], v[128:131], v[124:127]
    ds_read_b64_tr_b16 v[40:41], v3 offset:8192
    ds_read_b64_tr_b16 v[42:43], v3 offset:10240
    v_mfma_f32_16x16x32_bf16 v[124:127], v[52:55], v[132:135], v[124:127]
    ds_read_b64_tr_b16 v[44:45], v3 offset:12288
    ds_read_b64_tr_b16 v[46:47], v3 offset:14336
    s_waitcnt vmcnt(13) lgkmcnt(8)
    v_mfma_f32_16x16x32_bf16 v[112:115], v[24:27], v[136:139], v[112:115]
    ds_read_b64_tr_b16 v[48:49], v4 offset:8192
    ds_read_b64_tr_b16 v[50:51], v4 offset:10240
    v_mfma_f32_16x16x32_bf16 v[112:115], v[28:31], v[140:143], v[112:115]
    ds_read_b64_tr_b16 v[52:53], v4 offset:12288
    ds_read_b64_tr_b16 v[54:55], v4 offset:14336
    s_add_u32 s81, s10, 270336
    buffer_load_dwordx4 v[200:203], v21, s[64:67], s81 offen offset:0 sc1
    buffer_load_dwordx4 v[204:207], v21, s[64:67], s81 offen offset:2048 sc1
    s_waitcnt lgkmcnt(8)
    v_mfma_f32_16x16x32_bf16 v[116:119], v[32:35], v[136:139], v[116:119]
    ds_read_b64_tr_b16 v[24:25], v1 offset:32768
    ds_read_b64_tr_b16 v[26:27], v1 offset:34816
    v_mfma_f32_16x16x32_bf16 v[116:119], v[36:39], v[140:143], v[116:119]
    ds_read_b64_tr_b16 v[28:29], v1 offset:36864
    ds_read_b64_tr_b16 v[30:31], v1 offset:38912
    s_waitcnt lgkmcnt(8)
    v_mfma_f32_16x16x32_bf16 v[120:123], v[40:43], v[136:139], v[120:123]
    ds_read_b64_tr_b16 v[32:33], v2 offset:32768
    ds_read_b64_tr_b16 v[34:35], v2 offset:34816
    v_mfma_f32_16x16x32_bf16 v[120:123], v[44:47], v[140:143], v[120:123]
    ds_read_b64_tr_b16 v[36:37], v2 offset:36864
    ds_read_b64_tr_b16 v[38:39], v2 offset:38912
    s_waitcnt lgkmcnt(8)
    v_mfma_f32_16x16x32_bf16 v[124:127], v[48:51], v[136:139], v[124:127]
    ds_read_b64_tr_b16 v[40:41], v3 offset:32768
    ds_read_b64_tr_b16 v[42:43], v3 offset:34816
    v_mfma_f32_16x16x32_bf16 v[124:127], v[52:55], v[140:143], v[124:127]
    ds_read_b64_tr_b16 v[44:45], v3 offset:36864
    ds_read_b64_tr_b16 v[46:47], v3 offset:38912
    s_waitcnt vmcnt(13) lgkmcnt(8)
    v_mfma_f32_16x16x32_bf16 v[112:115], v[24:27], v[144:147], v[112:115]
    ds_read_b64_tr_b16 v[48:49], v4 offset:32768
    ds_read_b64_tr_b16 v[50:51], v4 offset:34816
    v_mfma_f32_16x16x32_bf16 v[112:115], v[28:31], v[208:211], v[112:115]
    ds_read_b64_tr_b16 v[52:53], v4 offset:36864
    ds_read_b64_tr_b16 v[54:55], v4 offset:38912
    s_add_u32 s81, s10, 278528
    buffer_load_dwordx4 v[128:131], v21, s[64:67], s81 offen offset:0 sc1
    buffer_load_dwordx4 v[132:135], v21, s[64:67], s81 offen offset:2048 sc1
    s_waitcnt lgkmcnt(8)
    v_mfma_f32_16x16x32_bf16 v[116:119], v[32:35], v[144:147], v[116:119]
    ds_read_b64_tr_b16 v[24:25], v1 offset:40960
    ds_read_b64_tr_b16 v[26:27], v1 offset:43008
    v_mfma_f32_16x16x32_bf16 v[116:119], v[36:39], v[208:211], v[116:119]
    ds_read_b64_tr_b16 v[28:29], v1 offset:45056
    ds_read_b64_tr_b16 v[30:31], v1 offset:47104
    s_waitcnt lgkmcnt(8)
    v_mfma_f32_16x16x32_bf16 v[120:123], v[40:43], v[144:147], v[120:123]
    ds_read_b64_tr_b16 v[32:33], v2 offset:40960
    ds_read_b64_tr_b16 v[34:35], v2 offset:43008
    v_mfma_f32_16x16x32_bf16 v[120:123], v[44:47], v[208:211], v[120:123]
    ds_read_b64_tr_b16 v[36:37], v2 offset:45056
    ds_read_b64_tr_b16 v[38:39], v2 offset:47104
    s_waitcnt lgkmcnt(8)
    v_mfma_f32_16x16x32_bf16 v[124:127], v[48:51], v[144:147], v[124:127]
    ds_read_b64_tr_b16 v[40:41], v3 offset:40960
    ds_read_b64_tr_b16 v[42:43], v3 offset:43008
    v_mfma_f32_16x16x32_bf16 v[124:127], v[52:55], v[208:211], v[124:127]
    ds_read_b64_tr_b16 v[44:45], v3 offset:45056
    ds_read_b64_tr_b16 v[46:47], v3 offset:47104
    s_waitcnt vmcnt(13) lgkmcnt(8)
    v_mfma_f32_16x16x32_bf16 v[112:115], v[24:27], v[148:151], v[112:115]
    ds_read_b64_tr_b16 v[48:49], v4 offset:40960
    ds_read_b64_tr_b16 v[50:51], v4 offset:43008
    v_mfma_f32_16x16x32_bf16 v[112:115], v[28:31], v[212:215], v[112:115]
    ds_read_b64_tr_b16 v[52:53], v4 offset:45056
    ds_read_b64_tr_b16 v[54:55], v4 offset:47104
    s_add_u32 s81, s10, 286720
    buffer_load_dwordx4 v[136:139], v21, s[64:67], s81 offen offset:0 sc1
    buffer_load_dwordx4 v[140:143], v21, s[64:67], s81 offen offset:2048 sc1
    s_waitcnt lgkmcnt(8)
    v_mfma_f32_16x16x32_bf16 v[116:119], v[32:35], v[148:151], v[116:119]
    ds_read_b64_tr_b16 v[24:25], v1 offset:49152
    ds_read_b64_tr_b16 v[26:27], v1 offset:51200
    v_mfma_f32_16x16x32_bf16 v[116:119], v[36:39], v[212:215], v[116:119]
    ds_read_b64_tr_b16 v[28:29], v1 offset:53248
    ds_read_b64_tr_b16 v[30:31], v1 offset:55296
    s_waitcnt lgkmcnt(8)
    v_mfma_f32_16x16x32_bf16 v[120:123], v[40:43], v[148:151], v[120:123]
    ds_read_b64_tr_b16 v[32:33], v2 offset:49152
    ds_read_b64_tr_b16 v[34:35], v2 offset:51200
    v_mfma_f32_16x16x32_bf16 v[120:123], v[44:47], v[212:215], v[120:123]
    ds_read_b64_tr_b16 v[36:37], v2 offset:53248
    ds_read_b64_tr_b16 v[38:39], v2 offset:55296
    s_waitcnt lgkmcnt(8)
    v_mfma_f32_16x16x32_bf16 v[124:127], v[48:51], v[148:151], v[124:127]
    ds_read_b64_tr_b16 v[40:41], v3 offset:49152
    ds_read_b64_tr_b16 v[42:43], v3 offset:51200
    v_mfma_f32_16x16x32_bf16 v[124:127], v[52:55], v[212:215], v[124:127]
    ds_read_b64_tr_b16 v[44:45], v3 offset:53248
    ds_read_b64_tr_b16 v[46:47], v3 offset:55296
    s_waitcnt vmcnt(13) lgkmcnt(8)
    v_mfma_f32_16x16x32_bf16 v[112:115], v[24:27], v[152:155], v[112:115]
    ds_read_b64_tr_b16 v[48:49], v4 offset:49152
    ds_read_b64_tr_b16 v[50:51], v4 offset:51200
    v_mfma_f32_16x16x32_bf16 v[112:115], v[28:31], v[216:219], v[112:115]
    ds_read_b64_tr_b16 v[52:53], v4 offset:53248
    ds_read_b64_tr_b16 v[54:55], v4 offset:55296
    s_add_u32 s81, s8, 98304
    buffer_load_dwordx4 v[144:147], v21, s[64:67], s81 offen offset:0 sc1
    buffer_load_dwordx4 v[208:211], v21, s[64:67], s81 offen offset:2048 sc1
    s_waitcnt lgkmcnt(8)
    v_mfma_f32_16x16x32_bf16 v[116:119], v[32:35], v[152:155], v[116:119]
    ds_read_b64_tr_b16 v[24:25], v1 offset:57344
    ds_read_b64_tr_b16 v[26:27], v1 offset:59392
    v_mfma_f32_16x16x32_bf16 v[116:119], v[36:39], v[216:219], v[116:119]
    ds_read_b64_tr_b16 v[28:29], v1 offset:61440
    ds_read_b64_tr_b16 v[30:31], v1 offset:63488
    s_waitcnt lgkmcnt(8)
    v_mfma_f32_16x16x32_bf16 v[120:123], v[40:43], v[152:155], v[120:123]
    ds_read_b64_tr_b16 v[32:33], v2 offset:57344
    ds_read_b64_tr_b16 v[34:35], v2 offset:59392
    v_mfma_f32_16x16x32_bf16 v[120:123], v[44:47], v[216:219], v[120:123]
    ds_read_b64_tr_b16 v[36:37], v2 offset:61440
    ds_read_b64_tr_b16 v[38:39], v2 offset:63488
    s_waitcnt lgkmcnt(8)
    v_mfma_f32_16x16x32_bf16 v[124:127], v[48:51], v[152:155], v[124:127]
    ds_read_b64_tr_b16 v[40:41], v3 offset:57344
    ds_read_b64_tr_b16 v[42:43], v3 offset:59392
    v_mfma_f32_16x16x32_bf16 v[124:127], v[52:55], v[216:219], v[124:127]
    ds_read_b64_tr_b16 v[44:45], v3 offset:61440
    ds_read_b64_tr_b16 v[46:47], v3 offset:63488
    s_waitcnt vmcnt(13) lgkmcnt(8)
    v_mfma_f32_16x16x32_bf16 v[112:115], v[24:27], v[156:159], v[112:115]
    ds_read_b64_tr_b16 v[48:49], v4 offset:57344
    ds_read_b64_tr_b16 v[50:51], v4 offset:59392
    v_mfma_f32_16x16x32_bf16 v[112:115], v[28:31], v[220:223], v[112:115]
    ds_read_b64_tr_b16 v[52:53], v4 offset:61440
    ds_read_b64_tr_b16 v[54:55], v4 offset:63488
    s_add_u32 s81, s8, 114688
    buffer_load_dwordx4 v[148:151], v21, s[64:67], s81 offen offset:0 sc1
    buffer_load_dwordx4 v[212:215], v21, s[64:67], s81 offen offset:2048 sc1
    s_waitcnt lgkmcnt(8)
    v_mfma_f32_16x16x32_bf16 v[116:119], v[32:35], v[156:159], v[116:119]
    v_add_u32 v1, 0x10000, v1
    ds_read_b64_tr_b16 v[24:25], v1 offset:0
    ds_read_b64_tr_b16 v[26:27], v1 offset:2048
    v_mfma_f32_16x16x32_bf16 v[116:119], v[36:39], v[220:223], v[116:119]
    ds_read_b64_tr_b16 v[28:29], v1 offset:4096
    ds_read_b64_tr_b16 v[30:31], v1 offset:6144
    s_waitcnt lgkmcnt(8)
    v_mfma_f32_16x16x32_bf16 v[120:123], v[40:43], v[156:159], v[120:123]
    v_add_u32 v2, 0x10000, v2
    ds_read_b64_tr_b16 v[32:33], v2 offset:0
    ds_read_b64_tr_b16 v[34:35], v2 offset:2048
    v_mfma_f32_16x16x32_bf16 v[120:123], v[44:47], v[220:223], v[120:123]
    ds_read_b64_tr_b16 v[36:37], v2 offset:4096
    ds_read_b64_tr_b16 v[38:39], v2 offset:6144
    s_waitcnt lgkmcnt(8)
    v_mfma_f32_16x16x32_bf16 v[124:127], v[48:51], v[156:159], v[124:127]
    v_add_u32 v3, 0x10000, v3
    ds_read_b64_tr_b16 v[40:41], v3 offset:0
    ds_read_b64_tr_b16 v[42:43], v3 offset:2048
    v_mfma_f32_16x16x32_bf16 v[124:127], v[52:55], v[220:223], v[124:127]
    ds_read_b64_tr_b16 v[44:45], v3 offset:4096
    ds_read_b64_tr_b16 v[46:47], v3 offset:6144
    s_waitcnt vmcnt(12) lgkmcnt(8)
    v_mfma_f32_16x16x32_bf16 v[112:115], v[24:27], v[192:195], v[112:115]
    v_add_u32 v4, 0x10000, v4
    ds_read_b64_tr_b16 v[48:49], v4 offset:0
    ds_read_b64_tr_b16 v[50:51], v4 offset:2048
    v_mfma_f32_16x16x32_bf16 v[112:115], v[28:31], v[196:199], v[112:115]
    ds_read_b64_tr_b16 v[52:53], v4 offset:4096
    ds_read_b64_tr_b16 v[54:55], v4 offset:6144
    s_waitcnt lgkmcnt(8)
    v_mfma_f32_16x16x32_bf16 v[116:119], v[32:35], v[192:195], v[116:119]
    ds_read_b64_tr_b16 v[24:25], v1 offset:8192
    ds_read_b64_tr_b16 v[26:27], v1 offset:10240
    v_mfma_f32_16x16x32_bf16 v[116:119], v[36:39], v[196:199], v[116:119]
    ds_read_b64_tr_b16 v[28:29], v1 offset:12288
    ds_read_b64_tr_b16 v[30:31], v1 offset:14336
    s_waitcnt lgkmcnt(8)
    v_mfma_f32_16x16x32_bf16 v[120:123], v[40:43], v[192:195], v[120:123]
    ds_read_b64_tr_b16 v[32:33], v2 offset:8192
    ds_read_b64_tr_b16 v[34:35], v2 offset:10240
    v_mfma_f32_16x16x32_bf16 v[120:123], v[44:47], v[196:199], v[120:123]
    ds_read_b64_tr_b16 v[36:37], v2 offset:12288
    ds_read_b64_tr_b16 v[38:39], v2 offset:14336
    s_waitcnt lgkmcnt(8)
    v_mfma_f32_16x16x32_bf16 v[124:127], v[48:51], v[192:195], v[124:127]
    ds_read_b64_tr_b16 v[40:41], v3 offset:8192
    ds_read_b64_tr_b16 v[42:43], v3 offset:10240
    v_mfma_f32_16x16x32_bf16 v[124:127], v[52:55], v[196:199], v[124:127]
    ds_read_b64_tr_b16 v[44:45], v3 offset:12288
    ds_read_b64_tr_b16 v[46:47], v3 offset:14336
    s_waitcnt vmcnt(8) lgkmcnt(8)
    v_mfma_f32_16x16x32_bf16 v[112:115], v[24:27], v[200:203], v[112:115]
    ds_read_b64_tr_b16 v[48:49], v4 offset:8192
    ds_read_b64_tr_b16 v[50:51], v4 offset:10240
    v_mfma_f32_16x16x32_bf16 v[112:115], v[28:31], v[204:207], v[112:115]
    ds_read_b64_tr_b16 v[52:53], v4 offset:12288
    ds_read_b64_tr_b16 v[54:55], v4 offset:14336
    s_waitcnt lgkmcnt(8)
    v_mfma_f32_16x16x32_bf16 v[116:119], v[32:35], v[200:203], v[116:119]
    ds_read_b64_tr_b16 v[24:25], v1 offset:16384
    ds_read_b64_tr_b16 v[26:27], v1 offset:18432
    v_mfma_f32_16x16x32_bf16 v[116:119], v[36:39], v[204:207], v[116:119]
    ds_read_b64_tr_b16 v[28:29], v1 offset:20480
    ds_read_b64_tr_b16 v[30:31], v1 offset:22528
    s_waitcnt lgkmcnt(8)
    v_mfma_f32_16x16x32_bf16 v[120:123], v[40:43], v[200:203], v[120:123]
    ds_read_b64_tr_b16 v[32:33], v2 offset:16384
    ds_read_b64_tr_b16 v[34:35], v2 offset:18432
    v_mfma_f32_16x16x32_bf16 v[120:123], v[44:47], v[204:207], v[120:123]
    ds_read_b64_tr_b16 v[36:37], v2 offset:20480
    ds_read_b64_tr_b16 v[38:39], v2 offset:22528
    buffer_load_dwordx4 v[64:67], v7, s[64:67], s12 offen offset:0 sc1
    buffer_load_dwordx4 v[68:71], v7, s[64:67], s12 offen offset:1024 sc1
    buffer_load_dword v72, v15, s[64:67], s12 offen offset:2048 sc1
    s_waitcnt lgkmcnt(8)
    v_mfma_f32_16x16x32_bf16 v[124:127], v[48:51], v[200:203], v[124:127]
    ds_read_b64_tr_b16 v[40:41], v3 offset:16384
    ds_read_b64_tr_b16 v[42:43], v3 offset:18432
    v_mfma_f32_16x16x32_bf16 v[124:127], v[52:55], v[204:207], v[124:127]
    ds_read_b64_tr_b16 v[44:45], v3 offset:20480
    ds_read_b64_tr_b16 v[46:47], v3 offset:22528
    s_waitcnt vmcnt(9) lgkmcnt(8)
    v_mfma_f32_16x16x32_bf16 v[112:115], v[24:27], v[128:131], v[112:115]
    ds_read_b64_tr_b16 v[48:49], v4 offset:16384
    ds_read_b64_tr_b16 v[50:51], v4 offset:18432
    v_mfma_f32_16x16x32_bf16 v[112:115], v[28:31], v[132:135], v[112:115]
    ds_read_b64_tr_b16 v[52:53], v4 offset:20480
    ds_read_b64_tr_b16 v[54:55], v4 offset:22528
    s_waitcnt lgkmcnt(8)
    v_mfma_f32_16x16x32_bf16 v[116:119], v[32:35], v[128:131], v[116:119]
    ds_read_b64_tr_b16 v[24:25], v1 offset:24576
    ds_read_b64_tr_b16 v[26:27], v1 offset:26624
    v_mfma_f32_16x16x32_bf16 v[116:119], v[36:39], v[132:135], v[116:119]
    ds_read_b64_tr_b16 v[28:29], v1 offset:28672
    ds_read_b64_tr_b16 v[30:31], v1 offset:30720
    s_waitcnt lgkmcnt(8)
    v_mfma_f32_16x16x32_bf16 v[120:123], v[40:43], v[128:131], v[120:123]
    ds_read_b64_tr_b16 v[32:33], v2 offset:24576
    ds_read_b64_tr_b16 v[34:35], v2 offset:26624
    v_mfma_f32_16x16x32_bf16 v[120:123], v[44:47], v[132:135], v[120:123]
    ds_read_b64_tr_b16 v[36:37], v2 offset:28672
    ds_read_b64_tr_b16 v[38:39], v2 offset:30720
    s_waitcnt lgkmcnt(8)
    v_mfma_f32_16x16x32_bf16 v[124:127], v[48:51], v[128:131], v[124:127]
    ds_read_b64_tr_b16 v[40:41], v3 offset:24576
    ds_read_b64_tr_b16 v[42:43], v3 offset:26624
    v_mfma_f32_16x16x32_bf16 v[124:127], v[52:55], v[132:135], v[124:127]
    ds_read_b64_tr_b16 v[44:45], v3 offset:28672
    ds_read_b64_tr_b16 v[46:47], v3 offset:30720
    s_waitcnt vmcnt(7) lgkmcnt(8)
    v_mfma_f32_16x16x32_bf16 v[112:115], v[24:27], v[136:139], v[112:115]
    ds_read_b64_tr_b16 v[48:49], v4 offset:24576
    ds_read_b64_tr_b16 v[50:51], v4 offset:26624
    v_mfma_f32_16x16x32_bf16 v[112:115], v[28:31], v[140:143], v[112:115]
    ds_read_b64_tr_b16 v[52:53], v4 offset:28672
    ds_read_b64_tr_b16 v[54:55], v4 offset:30720
    s_waitcnt lgkmcnt(8)
    v_mfma_f32_16x16x32_bf16 v[116:119], v[32:35], v[136:139], v[116:119]
    v_mfma_f32_16x16x32_bf16 v[116:119], v[36:39], v[140:143], v[116:119]
    s_waitcnt lgkmcnt(4)
    v_mfma_f32_16x16x32_bf16 v[120:123], v[40:43], v[136:139], v[120:123]
    v_mfma_f32_16x16x32_bf16 v[120:123], v[44:47], v[140:143], v[120:123]
    s_waitcnt lgkmcnt(0)
    v_mfma_f32_16x16x32_bf16 v[124:127], v[48:51], v[136:139], v[124:127]
    v_mfma_f32_16x16x32_bf16 v[124:127], v[52:55], v[140:143], v[124:127]
    s_waitcnt vmcnt(5)
    v_mfma_f32_16x16x32_bf16 v[112:115], v[160:163], v[144:147], v[112:115]
    v_mfma_f32_16x16x32_bf16 v[112:115], v[224:227], v[208:211], v[112:115]
    v_mfma_f32_16x16x32_bf16 v[116:119], v[164:167], v[144:147], v[116:119]
    v_mfma_f32_16x16x32_bf16 v[116:119], v[228:231], v[208:211], v[116:119]
    v_mfma_f32_16x16x32_bf16 v[120:123], v[168:171], v[144:147], v[120:123]
    v_mfma_f32_16x16x32_bf16 v[120:123], v[232:235], v[208:211], v[120:123]
    v_mfma_f32_16x16x32_bf16 v[124:127], v[172:175], v[144:147], v[124:127]
    v_mfma_f32_16x16x32_bf16 v[124:127], v[236:239], v[208:211], v[124:127]
    s_waitcnt vmcnt(3)
    v_mfma_f32_16x16x32_bf16 v[112:115], v[176:179], v[148:151], v[112:115]
    v_mfma_f32_16x16x32_bf16 v[112:115], v[240:243], v[212:215], v[112:115]
    v_mfma_f32_16x16x32_bf16 v[116:119], v[180:183], v[148:151], v[116:119]
    v_mfma_f32_16x16x32_bf16 v[116:119], v[244:247], v[212:215], v[116:119]
    v_mfma_f32_16x16x32_bf16 v[120:123], v[184:187], v[148:151], v[120:123]
    v_mfma_f32_16x16x32_bf16 v[120:123], v[248:251], v[212:215], v[120:123]
    v_mfma_f32_16x16x32_bf16 v[124:127], v[188:191], v[148:151], v[124:127]
    v_mfma_f32_16x16x32_bf16 v[124:127], v[252:255], v[212:215], v[124:127]
    s_waitcnt vmcnt(0)
    v_add3_u32 v14, v10, v64, v65
    v_add3_u32 v14, v14, v66, v67
    v_add3_u32 v14, v14, v68, v69
    v_add3_u32 v14, v14, v70, v71
    v_cmp_ne_u32 vcc, v14, v72
    s_cbranch_vccnz Lx_2003
Lc_2004:
    v_dot2_f32_bf16 v112, v64, v12, v112
    v_dot2_f32_bf16 v113, v64, v13, v113
    v_dot2_f32_bf16 v114, v65, v12, v114
    v_dot2_f32_bf16 v115, v65, v13, v115
    v_dot2_f32_bf16 v116, v66, v12, v116
    v_dot2_f32_bf16 v117, v66, v13, v117
    v_dot2_f32_bf16 v118, v67, v12, v118
    v_dot2_f32_bf16 v119, v67, v13, v119
    v_dot2_f32_bf16 v120, v68, v12, v120
    v_dot2_f32_bf16 v121, v68, v13, v121
    v_dot2_f32_bf16 v122, v69, v12, v122
    v_dot2_f32_bf16 v123, v69, v13, v123
    v_cvt_pk_bf16_f32 v56, v112, v113
    v_cvt_pk_bf16_f32 v57, v114, v115
    v_cvt_pk_bf16_f32 v58, v116, v117
    v_cvt_pk_bf16_f32 v59, v118, v119
    v_dot2_f32_bf16 v124, v70, v12, v124
    v_dot2_f32_bf16 v125, v70, v13, v125
    v_dot2_f32_bf16 v126, v71, v12, v126
    v_dot2_f32_bf16 v127, v71, v13, v127
    v_permlane16_swap_b32 v56, v58
    v_permlane16_swap_b32 v57, v59
    buffer_store_dwordx4 v[56:59], v8, s[68:71], s99 offen offset:0 sc1
    v_cvt_pk_bf16_f32 v60, v120, v121
    v_cvt_pk_bf16_f32 v61, v122, v123
    v_cvt_pk_bf16_f32 v62, v124, v125
    v_cvt_pk_bf16_f32 v63, v126, v127
    s_nop 0
    v_permlane16_swap_b32 v60, v62
    v_permlane16_swap_b32 v61, v63
    buffer_store_dwordx4 v[60:63], v8, s[68:71], s99 offen offset:64 sc1
    s_endpgm
Ln_2001:
    buffer_load_dword v10, off, s[72:75], 0 sc1
    s_sub_u32 s37, s37, 1
    s_cbranch_scc1 L_end
    s_waitcnt vmcnt(0)
    v_cmp_eq_u32 vcc, 0, v10
    s_cbranch_vccnz Ln_2001
    s_branch Lc_2002
Lx_2003:
    buffer_load_dwordx4 v[64:67], v7, s[64:67], s12 offen offset:0 sc1
    buffer_load_dwordx4 v[68:71], v7, s[64:67], s12 offen offset:1024 sc1
    buffer_load_dword v72, v15, s[64:67], s12 offen offset:2048 sc1
    s_sub_u32 s37, s37, 1
    s_cbranch_scc1 L_end
    s_waitcnt vmcnt(0)
    v_add3_u32 v14, v10, v64, v65
    v_add3_u32 v14, v14, v66, v67
    v_add3_u32 v14, v14, v68, v69
    v_add3_u32 v14, v14, v70, v71
    v_cmp_ne_u32 vcc, v14, v72
    s_cbranch_vccnz Lx_2003
    s_branch Lc_2004
L_last:
    s_endpgm
.section .rodata,"a"
.p2align 6
.amdhsa_kernel parallel_sum__linear_attn_block__swiglu_ffn__prompt_kernel
  .amdhsa_next_free_vgpr 256
  .amdhsa_next_free_sgpr 102
  .amdhsa_accum_offset 256
  .amdhsa_group_segment_fixed_size 0
  .amdhsa_kernarg_size 80
  .amdhsa_user_sgpr_count 2
  .amdhsa_user_sgpr_kernarg_segment_ptr 1
  .amdhsa_system_sgpr_workgroup_id_x 1
.end_amdhsa_kernel
```
